```python
import torch

def _softmax(x, axis=-1):
    return torch.softmax(x, dim=axis)
def _gelu(x):
    return torch.nn.functional.gelu(x, approximate="tanh")
def _silu(x):
    return torch.nn.functional.silu(x)
def _sigmoid(x):
    return torch.sigmoid(x)
def _layernorm(x, axis=-1, eps=1e-5):
    m = x.mean(dim=axis, keepdim=True)
    v = x.var(dim=axis, keepdim=True, unbiased=False)
    return (x - m) / torch.sqrt(v + eps)
def _scatter_add(tgt, idx, src, axis=0):
    return tgt.clone().index_add_(axis, idx, src)
def _segment_sum(src, seg, n):
    out = torch.zeros((n,) + src.shape[1:], dtype=src.dtype)
    return out.index_add_(0, seg, src)
def _pad(x, pw):
    flat = tuple(v for pair in reversed(pw) for v in pair)
    return torch.nn.functional.pad(x, flat)

kernel_name = 'standalone__gqa_softmax__near_ridge'

def setup_inputs():

    _w = (lambda a: (lambda t: t.to(torch.bfloat16) if t.is_floating_point() else t)(torch.as_tensor(a)))
    B, Hq, Hkv, Sq, Sk, D = 8, 32, 16, 336, 1024, 128
    return {
        "q": _w((lambda *s: torch.randn(*s, dtype=torch.bfloat16) * 0.8)(B, Hq, Sq, D)),
        "k": _w((lambda *s: torch.randn(*s, dtype=torch.bfloat16) * 0.8)(B, Hkv, Sk, D)),
        "v": _w((lambda *s: torch.randn(*s, dtype=torch.bfloat16) * 0.05)(B, Hkv, Sk, D)),
    }

def reference(q, k, v):
    B, Hq, Sq, D = q.shape
    Hkv = k.shape[1]
    rep = Hq // Hkv
    k = (lambda x, n, axis: torch.repeat_interleave(x, n, dim=axis))(k, rep, axis=1)
    v = (lambda x, n, axis: torch.repeat_interleave(x, n, dim=axis))(v, rep, axis=1)
    scale = D ** -0.5
    scores = torch.einsum("bhqd,bhkd->bhqk", q, k) * scale
    p = _softmax(scores, axis=-1)
    return torch.einsum("bhqk,bhkd->bhqd", p, v)
```

```asm
; @launch grid=(256,1,1) block=(256,1,1) lds=163840
.amdgcn_target "amdgcn-amd-amdhsa--gfx950"
.text
.globl standalone__gqa_softmax__near_ridge_kernel
.p2align 8
.type standalone__gqa_softmax__near_ridge_kernel,@function
standalone__gqa_softmax__near_ridge_kernel:
    s_cmp_ge_u32 s2, 256
    s_cbranch_scc1 L_end
    s_load_dwordx8 s[36:43], s[0:1], 0
    s_getpc_b64 s[62:63]
L_pc:
    s_bfe_u32 s32, s2, 131075
    s_lshl_b32 s32, s32, 7
    v_lshrrev_b32 v251, 1, v0
    v_lshlrev_b32 v251, 9, v251
    v_add_u32 v251, s32, v251
    v_min_u32 v251, L_end-L_pc, v251
    global_load_dword v252, v251, s[62:63]
    v_and_b32 v218, 63, v0
    v_lshrrev_b32 v244, 6, v0
    v_and_b32 v245, 15, v0
    v_readfirstlane_b32 s20, v244
    v_lshrrev_b32 v246, 4, v218
    v_lshrrev_b32 v247, 3, v218
    v_and_b32 v248, 7, v218
    s_and_b32 s32, s2, 7
    s_lshr_b32 s33, s2, 4
    s_lshl_b32 s33, s33, 3
    s_add_u32 s32, s32, s33
    s_lshr_b32 s33, s2, 3
    s_and_b32 s33, s33, 1
    s_lshl_b32 s34, s32, 1
    s_add_u32 s34, s34, s33
    s_mul_i32 s35, s34, 86016
    s_lshl_b32 s33, s32, 18
    s_mul_i32 s56, s20, 20480
    s_add_u32 s57, s56, 4096
    s_add_u32 s58, s56, 8192
    s_add_u32 s59, s56, 12288
    s_add_u32 s60, s56, 16384
    s_lshl_b32 s61, s20, 6
    s_add_u32 s61, s61, 81920
    s_and_b32 s26, s20, 1
    s_lshl_b32 s26, s26, 13
    s_lshr_b32 s34, s20, 1
    s_lshl_b32 s34, s34, 7
    s_add_u32 s26, s26, s34
    s_lshl_b32 s24, s20, 12
    s_add_u32 s25, s24, 65536
    s_mov_b32 s6, 86016
    s_mov_b32 s7, 0x00020000
    s_mov_b32 s10, 262144
    s_mov_b32 s11, 0x00020000
    s_mov_b32 s14, 262144
    s_mov_b32 s15, 0x00020000
    s_mov_b32 s18, 86016
    s_mov_b32 s19, 0x00020000
    v_lshlrev_b32 v233, 8, v245
    v_lshl_add_u32 v232, v246, 4, v233
    v_lshrrev_b32 v249, 1, v246
    v_xor_b32 v244, v246, v249
    v_xor_b32 v210, v248, v244
    v_lshlrev_b32 v210, 4, v210
    v_lshl_add_u32 v210, v247, 8, v210
    v_add_u32 v210, s26, v210
    v_xor_b32 v244, 5, v244
    v_xor_b32 v211, v248, v244
    v_lshlrev_b32 v211, 4, v211
    v_lshl_add_u32 v211, v247, 8, v211
    v_add_u32 v211, s26, v211
    v_add_u32 v212, 2048, v210
    v_add_u32 v213, 3072, v211
    v_add_u32 v211, 1024, v211
    s_waitcnt lgkmcnt(0)
    s_add_u32 s4, s36, s35
    s_addc_u32 s5, s37, 0
    s_and_b32 s5, s5, 0xffff
    s_add_u32 s8, s38, s33
    s_addc_u32 s9, s39, 0
    s_and_b32 s9, s9, 0xffff
    buffer_load_dwordx4 v[0:3], v232, s[4:7], s56 offen offset:0 nt
    buffer_load_dwordx4 v[4:7], v232, s[4:7], s56 offen offset:64 nt
    buffer_load_dwordx4 v[8:11], v232, s[4:7], s56 offen offset:128 nt
    buffer_load_dwordx4 v[12:15], v232, s[4:7], s56 offen offset:192 nt
    buffer_load_dwordx4 v[80:83], v232, s[4:7], s61 offen offset:0 nt
    s_mov_b32 s21, 0
    s_add_u32 m0, s24, 0
    s_nop 0
    buffer_load_dwordx4 v210, s[8:11], s21 offen offset:0 nt lds
    buffer_load_dwordx4 v211, s[8:11], s21 offen offset:1024 nt lds
    buffer_load_dwordx4 v212, s[8:11], s21 offen offset:2048 nt lds
    buffer_load_dwordx4 v213, s[8:11], s21 offen offset:3072 nt lds
    s_add_u32 s12, s40, s33
    s_addc_u32 s13, s41, 0
    s_and_b32 s13, s13, 0xffff
    s_add_u32 s16, s42, s35
    s_addc_u32 s17, s43, 0
    s_and_b32 s17, s17, 0xffff
    v_bfe_u32 v244, v218, 1, 2
    v_and_b32 v249, 1, v246
    v_xor_b32 v244, v244, v249
    v_lshlrev_b32 v244, 6, v244
    v_lshrrev_b32 v249, 5, v218
    v_lshl_add_u32 v244, v249, 5, v244
    v_and_b32 v249, 1, v218
    v_lshl_add_u32 v244, v249, 4, v244
    v_and_b32 v249, 3, v247
    v_lshl_add_u32 v244, v249, 8, v244
    v_add_u32 v214, s24, v244
    v_xor_b32 v215, 128, v214
    s_mov_b32 s28, 0x3e0293ee
    s_mov_b32 s29, 0x3e0293ee
    s_mov_b32 s54, 0x33800000
    s_mov_b32 s55, 0x5f800000
    v_lshrrev_b32 v244, 1, v246
    v_lshl_add_u32 v233, v244, 4, v233
    v_and_b32 v244, 1, v246
    v_lshl_add_u32 v233, v244, 5, v233
    s_lshl_b32 s32, s20, 6
    v_add_u32 v238, s32, v233
    v_xor_b32 v241, 64, v238
    v_xor_b32 v242, 128, v238
    v_xor_b32 v243, 192, v238
    s_mul_i32 s33, s20, 4352
    s_add_u32 s33, s33, 143360
    v_mul_u32_u24 v244, 272, v245
    v_lshl_add_u32 v244, v246, 3, v244
    s_xor_b32 s34, s32, 0
    s_add_u32 s34, s34, s33
    v_add_u32 v216, s34, v244
    s_xor_b32 s34, s32, 64
    s_add_u32 s34, s34, s33
    v_add_u32 v217, s34, v244
    s_xor_b32 s34, s32, 128
    s_add_u32 s34, s34, s33
    v_add_u32 v222, s34, v244
    s_xor_b32 s34, s32, 192
    s_add_u32 s34, s34, s33
    v_add_u32 v223, s34, v244
    v_mul_u32_u24 v244, 272, v246
    v_lshl_add_u32 v244, v245, 4, v244
    v_add_u32 v236, s33, v244
    v_lshlrev_b32 v237, 4, v218
    v_lshrrev_b32 v244, 1, v245
    v_lshrrev_b32 v249, 1, v244
    v_lshrrev_b32 v247, 2, v244
    v_xor_b32 v249, v249, v247
    v_and_b32 v249, 1, v249
    v_xor_b32 v244, v244, v249
    v_xor_b32 v244, v244, v246
    s_xor_b32 s32, s20, 0
    s_lshl_b32 s32, s32, 11
    s_xor_b32 s33, s20, 1
    s_lshl_b32 s33, s33, 11
    s_xor_b32 s34, s20, 2
    s_lshl_b32 s34, s34, 11
    s_xor_b32 s35, s20, 3
    s_lshl_b32 s35, s35, 11
    v_lshlrev_b32 v249, 4, v244
    v_lshl_add_u32 v249, v245, 7, v249
    v_add_u32 v186, s32, v249
    v_add_u32 v188, s33, v249
    v_add_u32 v190, s34, v249
    v_add_u32 v192, s35, v249
    v_xor_b32 v244, 4, v244
    v_lshlrev_b32 v249, 4, v244
    v_lshl_add_u32 v249, v245, 7, v249
    v_add_u32 v187, s32, v249
    v_add_u32 v189, s33, v249
    v_add_u32 v191, s34, v249
    v_add_u32 v193, s35, v249
    s_lshl_b32 s32, s32, 1
    s_lshl_b32 s33, s33, 1
    s_lshl_b32 s34, s34, 1
    s_lshl_b32 s35, s35, 1
    v_lshrrev_b32 v244, 2, v245
    v_lshl_add_u32 v244, v246, 3, v244
    v_lshlrev_b32 v244, 7, v244
    v_and_b32 v249, 3, v245
    v_lshl_add_u32 v244, v249, 3, v244
    v_add_u32 v244, 65536, v244
    v_lshrrev_b32 v249, 3, v245
    v_lshl_add_u32 v249, v246, 1, v249
    v_xor_b32 v249, s20, v249
    v_and_b32 v249, 3, v249
    v_xor_b32 v247, 0, v249
    v_lshl_add_u32 v247, v247, 5, v244
    v_add_u32 v194, s32, v247
    v_add_u32 v198, s33, v247
    v_add_u32 v202, s34, v247
    v_add_u32 v206, s35, v247
    v_xor_b32 v247, 1, v249
    v_lshl_add_u32 v247, v247, 5, v244
    v_add_u32 v195, s32, v247
    v_add_u32 v199, s33, v247
    v_add_u32 v203, s34, v247
    v_add_u32 v207, s35, v247
    v_xor_b32 v247, 2, v249
    v_lshl_add_u32 v247, v247, 5, v244
    v_add_u32 v196, s32, v247
    v_add_u32 v200, s33, v247
    v_add_u32 v204, s34, v247
    v_add_u32 v208, s35, v247
    v_xor_b32 v247, 3, v249
    v_lshl_add_u32 v247, v247, 5, v244
    v_add_u32 v197, s32, v247
    v_add_u32 v201, s33, v247
    v_add_u32 v205, s34, v247
    v_add_u32 v209, s35, v247
    s_lshr_b32 s32, s20, 1
    s_lshl_b32 s32, s32, 11
    s_and_b32 s33, s20, 1
    s_lshl_b32 s33, s33, 9
    s_add_u32 s32, s32, s33
    s_add_u32 s32, s32, 131072
    s_xor_b32 s33, s32, 2048
    v_lshlrev_b32 v244, 3, v218
    v_add_u32 v220, s32, v244
    v_add_u32 v221, s33, v244
    v_lshlrev_b32 v234, 4, v218
    v_add_u32 v234, 143360, v234
    s_lshl_b32 s32, s20, 10
    v_add_u32 v235, s32, v234
    v_mov_b32 v224, 0
    v_mov_b32 v225, 0
    v_mov_b32 v226, 0
    v_mov_b32 v227, 0
    v_mov_b32 v228, 0
    v_mov_b32 v229, 0
    v_mov_b32 v230, 0
    v_mov_b32 v231, 0
    v_mov_b32 v180, 0
    v_mov_b32 v181, 0
    v_mov_b32 v182, 0
    v_mov_b32 v183, 0
    v_mov_b32 v184, 0
    v_mov_b32 v185, 0
    s_lshl_b32 s32, s20, 12
    s_add_u32 s32, s32, L_r2-L_pc
    v_lshlrev_b32 v249, 7, v218
    v_add_u32 v249, s32, v249
    v_min_u32 v253, L_end-L_pc, v249
    v_mov_b32 v244, 0x3f803f80
    v_mov_b32 v245, 0x3f803f80
    v_mov_b32 v246, 0x3f803f80
    v_mov_b32 v247, 0x3f803f80
    v_mov_b32 v239, 1.0
    v_mov_b32 v240, 1.0
    v_accvgpr_write_b32 a184, 0
    v_accvgpr_write_b32 a185, 0
    v_accvgpr_write_b32 a186, 0
    v_accvgpr_write_b32 a187, 0
    v_accvgpr_write_b32 a128, 0
    v_accvgpr_write_b32 a129, 0
    v_accvgpr_write_b32 a130, 0
    v_accvgpr_write_b32 a131, 0
    v_accvgpr_write_b32 a132, 0
    v_accvgpr_write_b32 a133, 0
    v_accvgpr_write_b32 a134, 0
    v_accvgpr_write_b32 a135, 0
    v_accvgpr_write_b32 a136, 0
    v_accvgpr_write_b32 a137, 0
    v_accvgpr_write_b32 a138, 0
    v_accvgpr_write_b32 a139, 0
    v_accvgpr_write_b32 a140, 0
    v_accvgpr_write_b32 a141, 0
    v_accvgpr_write_b32 a142, 0
    v_accvgpr_write_b32 a143, 0
    v_accvgpr_write_b32 a144, 0
    v_accvgpr_write_b32 a145, 0
    v_accvgpr_write_b32 a146, 0
    v_accvgpr_write_b32 a147, 0
    v_accvgpr_write_b32 a148, 0
    v_accvgpr_write_b32 a149, 0
    v_accvgpr_write_b32 a150, 0
    v_accvgpr_write_b32 a151, 0
    v_accvgpr_write_b32 a152, 0
    v_accvgpr_write_b32 a153, 0
    v_accvgpr_write_b32 a154, 0
    v_accvgpr_write_b32 a155, 0
    v_accvgpr_write_b32 a156, 0
    v_accvgpr_write_b32 a157, 0
    v_accvgpr_write_b32 a158, 0
    v_accvgpr_write_b32 a159, 0
    s_mov_b32 s21, 0
    s_add_u32 m0, s25, 0
    s_nop 0
    buffer_load_dwordx4 v214, s[12:15], s21 offen offset:0 nt lds
    buffer_load_dwordx4 v215, s[12:15], s21 offen offset:1024 nt lds
    buffer_load_dwordx4 v214, s[12:15], s21 offen offset:2048 nt lds
    buffer_load_dwordx4 v215, s[12:15], s21 offen offset:3072 nt lds
    s_waitcnt vmcnt(12)
    v_lshlrev_b32 v96, 16, v0
    v_and_b32 v97, 0xffff0000, v0
    v_pk_mul_f32 v[96:97], v[96:97], s[28:29]
    v_cvt_pk_bf16_f32 v0, v96, v97
    v_lshlrev_b32 v98, 16, v1
    v_and_b32 v99, 0xffff0000, v1
    v_pk_mul_f32 v[98:99], v[98:99], s[28:29]
    v_cvt_pk_bf16_f32 v1, v98, v99
    v_lshlrev_b32 v100, 16, v2
    v_and_b32 v101, 0xffff0000, v2
    v_pk_mul_f32 v[100:101], v[100:101], s[28:29]
    v_cvt_pk_bf16_f32 v2, v100, v101
    v_lshlrev_b32 v102, 16, v3
    v_and_b32 v103, 0xffff0000, v3
    v_pk_mul_f32 v[102:103], v[102:103], s[28:29]
    v_cvt_pk_bf16_f32 v3, v102, v103
    s_waitcnt vmcnt(11)
    v_lshlrev_b32 v96, 16, v4
    v_and_b32 v97, 0xffff0000, v4
    v_pk_mul_f32 v[96:97], v[96:97], s[28:29]
    v_cvt_pk_bf16_f32 v4, v96, v97
    v_lshlrev_b32 v98, 16, v5
    v_and_b32 v99, 0xffff0000, v5
    v_pk_mul_f32 v[98:99], v[98:99], s[28:29]
    v_cvt_pk_bf16_f32 v5, v98, v99
    v_lshlrev_b32 v100, 16, v6
    v_and_b32 v101, 0xffff0000, v6
    v_pk_mul_f32 v[100:101], v[100:101], s[28:29]
    v_cvt_pk_bf16_f32 v6, v100, v101
    v_lshlrev_b32 v102, 16, v7
    v_and_b32 v103, 0xffff0000, v7
    v_pk_mul_f32 v[102:103], v[102:103], s[28:29]
    v_cvt_pk_bf16_f32 v7, v102, v103
    s_waitcnt vmcnt(10)
    v_lshlrev_b32 v96, 16, v8
    v_and_b32 v97, 0xffff0000, v8
    v_pk_mul_f32 v[96:97], v[96:97], s[28:29]
    v_cvt_pk_bf16_f32 v8, v96, v97
    v_lshlrev_b32 v98, 16, v9
    v_and_b32 v99, 0xffff0000, v9
    v_pk_mul_f32 v[98:99], v[98:99], s[28:29]
    v_cvt_pk_bf16_f32 v9, v98, v99
    v_lshlrev_b32 v100, 16, v10
    v_and_b32 v101, 0xffff0000, v10
    v_pk_mul_f32 v[100:101], v[100:101], s[28:29]
    v_cvt_pk_bf16_f32 v10, v100, v101
    v_lshlrev_b32 v102, 16, v11
    v_and_b32 v103, 0xffff0000, v11
    v_pk_mul_f32 v[102:103], v[102:103], s[28:29]
    v_cvt_pk_bf16_f32 v11, v102, v103
    s_waitcnt vmcnt(9)
    v_lshlrev_b32 v96, 16, v12
    v_and_b32 v97, 0xffff0000, v12
    v_pk_mul_f32 v[96:97], v[96:97], s[28:29]
    v_cvt_pk_bf16_f32 v12, v96, v97
    v_lshlrev_b32 v98, 16, v13
    v_and_b32 v99, 0xffff0000, v13
    v_pk_mul_f32 v[98:99], v[98:99], s[28:29]
    v_cvt_pk_bf16_f32 v13, v98, v99
    v_lshlrev_b32 v100, 16, v14
    v_and_b32 v101, 0xffff0000, v14
    v_pk_mul_f32 v[100:101], v[100:101], s[28:29]
    v_cvt_pk_bf16_f32 v14, v100, v101
    v_lshlrev_b32 v102, 16, v15
    v_and_b32 v103, 0xffff0000, v15
    v_pk_mul_f32 v[102:103], v[102:103], s[28:29]
    v_cvt_pk_bf16_f32 v15, v102, v103
    s_waitcnt vmcnt(8)
    v_lshlrev_b32 v136, 16, v80
    v_and_b32 v137, 0xffff0000, v80
    v_pk_mul_f32 v[136:137], v[136:137], s[28:29]
    v_cvt_pk_bf16_f32 v80, v136, v137
    v_lshlrev_b32 v138, 16, v81
    v_and_b32 v139, 0xffff0000, v81
    v_pk_mul_f32 v[138:139], v[138:139], s[28:29]
    v_cvt_pk_bf16_f32 v81, v138, v139
    v_lshlrev_b32 v140, 16, v82
    v_and_b32 v141, 0xffff0000, v82
    v_pk_mul_f32 v[140:141], v[140:141], s[28:29]
    v_cvt_pk_bf16_f32 v82, v140, v141
    v_lshlrev_b32 v142, 16, v83
    v_and_b32 v143, 0xffff0000, v83
    v_pk_mul_f32 v[142:143], v[142:143], s[28:29]
    v_cvt_pk_bf16_f32 v83, v142, v143
    ds_write_b128 v235, v[80:83]
    s_mov_b32 s61, 81920
    buffer_load_dwordx4 v[16:19], v232, s[4:7], s57 offen offset:0 nt
    s_waitcnt vmcnt(5) lgkmcnt(0)
    s_barrier
    ds_read_b128 a[192:195], v186 offset:0
    ds_read_b128 a[196:199], v187 offset:0
    ds_read_b128 a[200:203], v186 offset:8192
    ds_read_b128 a[204:207], v187 offset:8192
    ds_read_b128 a[208:211], v188 offset:0
    ds_read_b128 a[212:215], v189 offset:0
    ds_read_b128 a[216:219], v188 offset:8192
    ds_read_b128 a[220:223], v189 offset:8192
    ds_read_b128 v[80:83], v234 offset:0
    ds_read_b128 v[84:87], v234 offset:1024
    s_waitcnt lgkmcnt(6)
    v_mfma_f32_16x16x32_bf16 v[96:99], a[192:195], v[0:3], 0
    buffer_load_dwordx4 v[20:23], v232, s[4:7], s57 offen offset:64 nt
    ds_read_b128 v[88:91], v234 offset:2048
    ds_read_b128 v[92:95], v234 offset:3072
    v_mfma_f32_16x16x32_bf16 v[96:99], a[196:199], v[4:7], v[96:99]
    buffer_load_dwordx4 v[24:27], v232, s[4:7], s57 offen offset:128 nt
    v_mfma_f32_16x16x32_bf16 v[96:99], a[200:203], v[8:11], v[96:99]
    buffer_load_dwordx4 v[28:31], v232, s[4:7], s57 offen offset:192 nt
    v_mfma_f32_16x16x32_bf16 v[96:99], a[204:207], v[12:15], v[96:99]
    s_waitcnt lgkmcnt(0)
    v_mfma_f32_16x16x32_bf16 v[176:179], a[204:207], v[92:95], 0
    buffer_load_dwordx4 v[32:35], v232, s[4:7], s58 offen offset:0 nt
    ds_read_b128 a[204:207], v191 offset:8192
    v_mfma_f32_16x16x32_bf16 v[176:179], a[200:203], v[88:91], v[176:179]
    ds_read_b128 a[200:203], v190 offset:8192
    v_mfma_f32_16x16x32_bf16 v[176:179], a[196:199], v[84:87], v[176:179]
    ds_read_b128 a[196:199], v191 offset:0
    v_mfma_f32_16x16x32_bf16 v[176:179], a[192:195], v[80:83], v[176:179]
    ds_read_b128 a[192:195], v190 offset:0
    v_mfma_f32_16x16x32_bf16 v[140:143], a[208:211], v[0:3], 0
    ds_read_b128 a[208:211], v192 offset:0
    v_mfma_f32_16x16x32_bf16 v[140:143], a[212:215], v[4:7], v[140:143]
    ds_read_b128 a[212:215], v193 offset:0
    v_mfma_f32_16x16x32_bf16 v[140:143], a[216:219], v[8:11], v[140:143]
    ds_read_b128 a[216:219], v192 offset:8192
    v_mfma_f32_16x16x32_bf16 v[140:143], a[220:223], v[12:15], v[140:143]
    s_waitcnt lgkmcnt(3)
    ds_read_b128 a[220:223], v193 offset:8192
    v_exp_f32 v96, v96
    v_exp_f32 v97, v97
    v_exp_f32 v98, v98
    v_exp_f32 v99, v99
    v_mfma_f32_16x16x32_bf16 v[136:139], a[192:195], v[0:3], 0
    buffer_load_dwordx4 v[36:39], v232, s[4:7], s58 offen offset:64 nt
    v_add_f32 v180, v180, v96
    v_add_f32 v180, v180, v97
    v_add_f32 v180, v180, v98
    v_add_f32 v180, v180, v99
    v_mfma_f32_16x16x32_bf16 v[136:139], a[196:199], v[4:7], v[136:139]
    ds_read_b128 a[192:195], v186 offset:0
    ds_read_b128 a[196:199], v187 offset:0
    v_cvt_pk_bf16_f32 v96, v96, v97
    v_mfma_f32_16x16x32_bf16 v[136:139], a[200:203], v[8:11], v[136:139]
    ds_read_b128 a[200:203], v186 offset:8192
    v_cvt_pk_bf16_f32 v97, v98, v99
    v_mfma_f32_16x16x32_bf16 v[136:139], a[204:207], v[12:15], v[136:139]
    v_exp_f32 v176, v176
    v_exp_f32 v177, v177
    v_exp_f32 v178, v178
    v_exp_f32 v179, v179
    v_exp_f32 v140, v140
    v_exp_f32 v141, v141
    v_exp_f32 v142, v142
    v_exp_f32 v143, v143
    v_add_f32 v180, v180, v140
    buffer_load_dwordx4 v[40:43], v232, s[4:7], s58 offen offset:128 nt
    v_add_f32 v180, v180, v141
    v_add_f32 v180, v180, v142
    v_add_f32 v180, v180, v143
    v_cvt_pk_bf16_f32 v98, v140, v141
    v_cvt_pk_bf16_f32 v99, v142, v143
    s_waitcnt lgkmcnt(3)
    v_mfma_f32_16x16x32_bf16 v[140:143], a[208:211], v[0:3], 0
    v_add_f32 v185, v185, v176
    v_add_f32 v185, v185, v177
    v_add_f32 v185, v185, v178
    v_add_f32 v185, v185, v179
    v_mfma_f32_16x16x32_bf16 v[140:143], a[212:215], v[4:7], v[140:143]
    ds_read_b128 a[208:211], v188 offset:0
    ds_read_b128 a[212:215], v189 offset:0
    v_cvt_pk_bf16_f32 v176, v176, v177
    v_mfma_f32_16x16x32_bf16 v[140:143], a[216:219], v[8:11], v[140:143]
    ds_read_b128 a[216:219], v188 offset:8192
    ds_read_b128 a[204:207], v187 offset:8192
    v_cvt_pk_bf16_f32 v177, v178, v179
    v_mfma_f32_16x16x32_bf16 v[140:143], a[220:223], v[12:15], v[140:143]
    ds_write2st64_b64 v220, v[176:177], v[176:177] offset0:0 offset1:2
    v_exp_f32 v136, v136
    v_exp_f32 v137, v137
    v_exp_f32 v138, v138
    v_exp_f32 v139, v139
    v_add_f32 v180, v180, v136
    buffer_load_dwordx4 v[44:47], v232, s[4:7], s58 offen offset:192 nt
    v_add_f32 v180, v180, v137
    v_add_f32 v180, v180, v138
    v_add_f32 v180, v180, v139
    v_exp_f32 v140, v140
    v_exp_f32 v141, v141
    v_exp_f32 v142, v142
    v_exp_f32 v143, v143
    v_cvt_pk_bf16_f32 v136, v136, v137
    v_cvt_pk_bf16_f32 v137, v138, v139
    v_add_f32 v180, v180, v140
    v_add_f32 v180, v180, v141
    v_add_f32 v180, v180, v142
    v_add_f32 v180, v180, v143
    v_cvt_pk_bf16_f32 v138, v140, v141
    v_cvt_pk_bf16_f32 v139, v142, v143
    s_waitcnt vmcnt(8) lgkmcnt(0)
    s_barrier
    ds_read_b64_tr_b16 a[224:225], v194 offset:0
    ds_read_b64_tr_b16 a[226:227], v198 offset:0
    ds_read_b64_tr_b16 a[232:233], v194 offset:512
    ds_read_b64_tr_b16 a[234:235], v198 offset:512
    ds_read_b64_tr_b16 a[240:241], v195 offset:0
    ds_read_b64_tr_b16 a[242:243], v199 offset:0
    ds_read_b64_tr_b16 a[248:249], v195 offset:512
    ds_read_b64_tr_b16 a[250:251], v199 offset:512
    s_waitcnt lgkmcnt(0)
    v_mfma_f32_16x16x32_bf16 a[0:3], a[224:227], v[96:99], 0
    ds_read_b64_tr_b16 a[228:229], v202 offset:0
    ds_read2st64_b64 a[168:171], v220 offset0:0 offset1:1
    ds_read_b64_tr_b16 a[230:231], v206 offset:0
    ds_read2st64_b64 a[172:175], v221 offset0:0 offset1:1
    ds_read_b64_tr_b16 a[236:237], v202 offset:512
    ds_read_b64_tr_b16 a[238:239], v206 offset:512
    ds_read_b64_tr_b16 a[244:245], v203 offset:0
    ds_read_b64_tr_b16 a[246:247], v207 offset:0
    ds_read_b64_tr_b16 a[252:253], v203 offset:512
    ds_read_b64_tr_b16 a[254:255], v207 offset:512
    s_waitcnt lgkmcnt(8)
    v_mfma_f32_16x16x32_bf16 a[160:163], a[224:227], a[168:171], 0
    ds_read_b64_tr_b16 a[224:225], v196 offset:0
    ds_read_b64_tr_b16 a[226:227], v200 offset:0
    v_mfma_f32_16x16x32_bf16 a[16:19], a[232:235], v[96:99], 0
    ds_read_b128 a[220:223], v189 offset:8192
    v_mfma_f32_16x16x32_bf16 a[164:167], a[232:235], a[168:171], 0
    ds_read_b64_tr_b16 a[232:233], v196 offset:512
    ds_read_b64_tr_b16 a[234:235], v200 offset:512
    v_mfma_f32_16x16x32_bf16 a[4:7], a[240:243], v[96:99], 0
    ds_read_b64_tr_b16 a[240:241], v197 offset:0
    ds_read_b64_tr_b16 a[242:243], v201 offset:0
    v_mfma_f32_16x16x32_bf16 a[20:23], a[248:251], v[96:99], 0
    s_mov_b32 s21, 16384
    s_add_u32 m0, s24, 16384
    s_nop 0
    buffer_load_dwordx4 v210, s[8:11], s21 offen offset:0 nt lds
    ds_read_b64_tr_b16 a[248:249], v197 offset:512
    ds_read_b64_tr_b16 a[250:251], v201 offset:512
    s_waitcnt lgkmcnt(9)
    v_mfma_f32_16x16x32_bf16 a[0:3], a[228:231], v[136:139], a[0:3]
    v_mfma_f32_16x16x32_bf16 a[160:163], a[228:231], a[172:175], a[160:163]
    ds_read_b64_tr_b16 a[228:229], v204 offset:0
    ds_read_b64_tr_b16 a[230:231], v208 offset:0
    v_mfma_f32_16x16x32_bf16 a[16:19], a[236:239], v[136:139], a[16:19]
    v_mfma_f32_16x16x32_bf16 a[164:167], a[236:239], a[172:175], a[164:167]
    ds_read_b64_tr_b16 a[236:237], v204 offset:512
    ds_read_b64_tr_b16 a[238:239], v208 offset:512
    v_mfma_f32_16x16x32_bf16 a[4:7], a[244:247], v[136:139], a[4:7]
    ds_read_b64_tr_b16 a[244:245], v205 offset:0
    ds_read_b64_tr_b16 a[246:247], v209 offset:0
    v_mfma_f32_16x16x32_bf16 a[20:23], a[252:255], v[136:139], a[20:23]
    s_waitcnt lgkmcnt(6)
    ds_read_b64_tr_b16 a[252:253], v205 offset:512
    ds_read_b64_tr_b16 a[254:255], v209 offset:512
    v_mfma_f32_16x16x32_bf16 a[8:11], a[224:227], v[96:99], 0
    ds_read_b64_tr_b16 a[224:225], v194 offset:0
    ds_read_b64_tr_b16 a[226:227], v198 offset:0
    v_mfma_f32_16x16x32_bf16 a[24:27], a[232:235], v[96:99], 0
    ds_read_b64_tr_b16 a[232:233], v194 offset:512
    ds_read_b64_tr_b16 a[234:235], v198 offset:512
    v_mfma_f32_16x16x32_bf16 a[12:15], a[240:243], v[96:99], 0
    ds_read_b64_tr_b16 a[240:241], v195 offset:0
    ds_read_b64_tr_b16 a[242:243], v199 offset:0
    v_mfma_f32_16x16x32_bf16 a[28:31], a[248:251], v[96:99], 0
    s_waitcnt lgkmcnt(6)
    ds_read_b64_tr_b16 a[248:249], v195 offset:512
    ds_read_b64_tr_b16 a[250:251], v199 offset:512
    v_mfma_f32_16x16x32_bf16 a[8:11], a[228:231], v[136:139], a[8:11]
    ds_read_b64_tr_b16 a[228:229], v202 offset:0
    ds_read_b64_tr_b16 a[230:231], v206 offset:0
    v_mfma_f32_16x16x32_bf16 a[24:27], a[236:239], v[136:139], a[24:27]
    ds_read_b64_tr_b16 a[236:237], v202 offset:512
    ds_read_b64_tr_b16 a[238:239], v206 offset:512
    v_mfma_f32_16x16x32_bf16 a[12:15], a[244:247], v[136:139], a[12:15]
    ds_read_b64_tr_b16 a[244:245], v203 offset:0
    ds_read_b64_tr_b16 a[246:247], v207 offset:0
    v_mfma_f32_16x16x32_bf16 a[28:31], a[252:255], v[136:139], a[28:31]
    ds_read_b64_tr_b16 a[252:253], v203 offset:512
    ds_read_b64_tr_b16 a[254:255], v207 offset:512
    s_waitcnt vmcnt(8)
    v_lshlrev_b32 v104, 16, v16
    v_and_b32 v105, 0xffff0000, v16
    v_pk_mul_f32 v[104:105], v[104:105], s[28:29]
    v_cvt_pk_bf16_f32 v16, v104, v105
    buffer_load_dwordx4 v211, s[8:11], s21 offen offset:1024 nt lds
    v_lshlrev_b32 v106, 16, v17
    v_and_b32 v107, 0xffff0000, v17
    v_pk_mul_f32 v[106:107], v[106:107], s[28:29]
    v_cvt_pk_bf16_f32 v17, v106, v107
    v_lshlrev_b32 v108, 16, v18
    v_and_b32 v109, 0xffff0000, v18
    v_pk_mul_f32 v[108:109], v[108:109], s[28:29]
    v_cvt_pk_bf16_f32 v18, v108, v109
    v_lshlrev_b32 v110, 16, v19
    v_and_b32 v111, 0xffff0000, v19
    v_pk_mul_f32 v[110:111], v[110:111], s[28:29]
    v_cvt_pk_bf16_f32 v19, v110, v111
    s_waitcnt vmcnt(8)
    v_lshlrev_b32 v104, 16, v20
    v_and_b32 v105, 0xffff0000, v20
    v_pk_mul_f32 v[104:105], v[104:105], s[28:29]
    v_cvt_pk_bf16_f32 v20, v104, v105
    v_lshlrev_b32 v106, 16, v21
    v_and_b32 v107, 0xffff0000, v21
    v_pk_mul_f32 v[106:107], v[106:107], s[28:29]
    v_cvt_pk_bf16_f32 v21, v106, v107
    v_lshlrev_b32 v108, 16, v22
    v_and_b32 v109, 0xffff0000, v22
    v_pk_mul_f32 v[108:109], v[108:109], s[28:29]
    v_cvt_pk_bf16_f32 v22, v108, v109
    v_lshlrev_b32 v110, 16, v23
    v_and_b32 v111, 0xffff0000, v23
    v_pk_mul_f32 v[110:111], v[110:111], s[28:29]
    v_cvt_pk_bf16_f32 v23, v110, v111
    s_waitcnt vmcnt(7)
    v_lshlrev_b32 v104, 16, v24
    buffer_load_dwordx4 v212, s[8:11], s21 offen offset:2048 nt lds
    v_and_b32 v105, 0xffff0000, v24
    v_pk_mul_f32 v[104:105], v[104:105], s[28:29]
    v_cvt_pk_bf16_f32 v24, v104, v105
    v_lshlrev_b32 v106, 16, v25
    v_and_b32 v107, 0xffff0000, v25
    v_pk_mul_f32 v[106:107], v[106:107], s[28:29]
    v_cvt_pk_bf16_f32 v25, v106, v107
    v_lshlrev_b32 v108, 16, v26
    v_and_b32 v109, 0xffff0000, v26
    v_pk_mul_f32 v[108:109], v[108:109], s[28:29]
    v_cvt_pk_bf16_f32 v26, v108, v109
    v_lshlrev_b32 v110, 16, v27
    v_and_b32 v111, 0xffff0000, v27
    v_pk_mul_f32 v[110:111], v[110:111], s[28:29]
    v_cvt_pk_bf16_f32 v27, v110, v111
    s_waitcnt vmcnt(7)
    v_lshlrev_b32 v104, 16, v28
    buffer_load_dwordx4 v213, s[8:11], s21 offen offset:3072 nt lds
    v_and_b32 v105, 0xffff0000, v28
    v_pk_mul_f32 v[104:105], v[104:105], s[28:29]
    v_cvt_pk_bf16_f32 v28, v104, v105
    v_lshlrev_b32 v106, 16, v29
    v_and_b32 v107, 0xffff0000, v29
    v_pk_mul_f32 v[106:107], v[106:107], s[28:29]
    v_cvt_pk_bf16_f32 v29, v106, v107
    v_lshlrev_b32 v108, 16, v30
    v_and_b32 v109, 0xffff0000, v30
    v_pk_mul_f32 v[108:109], v[108:109], s[28:29]
    v_cvt_pk_bf16_f32 v30, v108, v109
    v_lshlrev_b32 v110, 16, v31
    v_and_b32 v111, 0xffff0000, v31
    v_pk_mul_f32 v[110:111], v[110:111], s[28:29]
    v_cvt_pk_bf16_f32 v31, v110, v111
    s_nop 1
    v_mfma_f32_16x16x32_bf16 v[104:107], a[204:207], v[28:31], 0
    ds_read_b128 a[204:207], v191 offset:8192
    v_mfma_f32_16x16x32_bf16 v[104:107], a[200:203], v[24:27], v[104:107]
    ds_read_b128 a[200:203], v190 offset:8192
    v_mfma_f32_16x16x32_bf16 v[104:107], a[196:199], v[20:23], v[104:107]
    ds_read_b128 a[196:199], v191 offset:0
    v_mfma_f32_16x16x32_bf16 v[104:107], a[192:195], v[16:19], v[104:107]
    ds_read_b128 a[192:195], v190 offset:0
    v_mfma_f32_16x16x32_bf16 v[148:151], a[220:223], v[28:31], 0
    ds_read_b128 a[220:223], v193 offset:8192
    v_mfma_f32_16x16x32_bf16 v[148:151], a[216:219], v[24:27], v[148:151]
    ds_read_b128 a[216:219], v192 offset:8192
    v_mfma_f32_16x16x32_bf16 v[148:151], a[212:215], v[20:23], v[148:151]
    ds_read_b128 a[212:215], v193 offset:0
    v_mfma_f32_16x16x32_bf16 v[148:151], a[208:211], v[16:19], v[148:151]
    s_waitcnt lgkmcnt(3)
    ds_read_b128 a[208:211], v192 offset:0
    v_mfma_f32_16x16x32_bf16 v[144:147], a[204:207], v[28:31], 0
    ds_read_b128 a[204:207], v187 offset:8192
    v_mfma_f32_16x16x32_bf16 v[144:147], a[200:203], v[24:27], v[144:147]
    ds_read_b128 a[200:203], v186 offset:8192
    v_mfma_f32_16x16x32_bf16 v[144:147], a[196:199], v[20:23], v[144:147]
    ds_read_b128 a[196:199], v187 offset:0
    v_mfma_f32_16x16x32_bf16 v[144:147], a[192:195], v[16:19], v[144:147]
    v_exp_f32 v104, v104
    v_exp_f32 v105, v105
    v_exp_f32 v106, v106
    v_exp_f32 v107, v107
    v_add_f32 v181, v181, v104
    s_mov_b32 s21, 16384
    s_add_u32 m0, s25, 16384
    s_nop 0
    buffer_load_dwordx4 v214, s[12:15], s21 offen offset:0 nt lds
    v_add_f32 v181, v181, v105
    v_add_f32 v181, v181, v106
    v_add_f32 v181, v181, v107
    v_exp_f32 v148, v148
    v_exp_f32 v149, v149
    v_exp_f32 v150, v150
    v_exp_f32 v151, v151
    v_cvt_pk_bf16_f32 v104, v104, v105
    v_cvt_pk_bf16_f32 v105, v106, v107
    v_add_f32 v181, v181, v148
    v_add_f32 v181, v181, v149
    v_add_f32 v181, v181, v150
    v_add_f32 v181, v181, v151
    v_cvt_pk_bf16_f32 v106, v148, v149
    v_cvt_pk_bf16_f32 v107, v150, v151
    s_nop 1
    v_mfma_f32_16x16x32_bf16 a[32:35], a[224:227], v[104:107], 0
    ds_read_b64_tr_b16 a[224:225], v196 offset:0
    ds_read_b64_tr_b16 a[226:227], v200 offset:0
    v_mfma_f32_16x16x32_bf16 a[48:51], a[232:235], v[104:107], 0
    ds_read_b64_tr_b16 a[232:233], v196 offset:512
    ds_read_b64_tr_b16 a[234:235], v200 offset:512
    v_mfma_f32_16x16x32_bf16 a[36:39], a[240:243], v[104:107], 0
    ds_read_b64_tr_b16 a[240:241], v197 offset:0
    ds_read_b64_tr_b16 a[242:243], v201 offset:0
    v_mfma_f32_16x16x32_bf16 a[52:55], a[248:251], v[104:107], 0
    s_waitcnt lgkmcnt(9)
    ds_read_b64_tr_b16 a[248:249], v197 offset:512
    ds_read_b64_tr_b16 a[250:251], v201 offset:512
    v_mfma_f32_16x16x32_bf16 v[148:151], a[220:223], v[28:31], 0
    ds_read_b128 a[192:195], v186 offset:0
    ds_read_b128 a[220:223], v189 offset:8192
    v_mfma_f32_16x16x32_bf16 v[148:151], a[216:219], v[24:27], v[148:151]
    ds_read_b128 a[216:219], v188 offset:8192
    v_mfma_f32_16x16x32_bf16 v[148:151], a[212:215], v[20:23], v[148:151]
    ds_read_b128 a[212:215], v189 offset:0
    v_mfma_f32_16x16x32_bf16 v[148:151], a[208:211], v[16:19], v[148:151]
    v_exp_f32 v144, v144
    v_exp_f32 v145, v145
    v_exp_f32 v146, v146
    v_exp_f32 v147, v147
    v_add_f32 v181, v181, v144
    v_add_f32 v181, v181, v145
    buffer_load_dwordx4 v215, s[12:15], s21 offen offset:1024 nt lds
    v_add_f32 v181, v181, v146
    v_add_f32 v181, v181, v147
    v_exp_f32 v148, v148
    v_exp_f32 v149, v149
    v_exp_f32 v150, v150
    v_exp_f32 v151, v151
    v_cvt_pk_bf16_f32 v144, v144, v145
    v_cvt_pk_bf16_f32 v145, v146, v147
    v_add_f32 v181, v181, v148
    v_add_f32 v181, v181, v149
    v_add_f32 v181, v181, v150
    v_add_f32 v181, v181, v151
    v_cvt_pk_bf16_f32 v146, v148, v149
    v_cvt_pk_bf16_f32 v147, v150, v151
    s_nop 1
    v_mfma_f32_16x16x32_bf16 a[32:35], a[228:231], v[144:147], a[32:35]
    ds_read_b64_tr_b16 a[228:229], v204 offset:0
    ds_read_b64_tr_b16 a[230:231], v208 offset:0
    ds_read_b128 a[208:211], v188 offset:0
    v_mfma_f32_16x16x32_bf16 a[48:51], a[236:239], v[144:147], a[48:51]
    ds_read_b64_tr_b16 a[236:237], v204 offset:512
    ds_read_b64_tr_b16 a[238:239], v208 offset:512
    v_mfma_f32_16x16x32_bf16 a[36:39], a[244:247], v[144:147], a[36:39]
    ds_read_b64_tr_b16 a[244:245], v205 offset:0
    ds_read_b64_tr_b16 a[246:247], v209 offset:0
    v_mfma_f32_16x16x32_bf16 a[52:55], a[252:255], v[144:147], a[52:55]
    s_waitcnt lgkmcnt(11)
    ds_read_b64_tr_b16 a[252:253], v205 offset:512
    ds_read_b64_tr_b16 a[254:255], v209 offset:512
    v_mfma_f32_16x16x32_bf16 a[40:43], a[224:227], v[104:107], 0
    ds_read_b64_tr_b16 a[224:225], v194 offset:0
    ds_read_b64_tr_b16 a[226:227], v198 offset:0
    v_mfma_f32_16x16x32_bf16 a[56:59], a[232:235], v[104:107], 0
    ds_read_b64_tr_b16 a[232:233], v194 offset:512
    ds_read_b64_tr_b16 a[234:235], v198 offset:512
    v_mfma_f32_16x16x32_bf16 a[44:47], a[240:243], v[104:107], 0
    ds_read_b64_tr_b16 a[240:241], v195 offset:0
    ds_read_b64_tr_b16 a[242:243], v199 offset:0
    v_mfma_f32_16x16x32_bf16 a[60:63], a[248:251], v[104:107], 0
    s_waitcnt lgkmcnt(6)
    ds_read_b64_tr_b16 a[248:249], v195 offset:512
    ds_read_b64_tr_b16 a[250:251], v199 offset:512
    v_mfma_f32_16x16x32_bf16 a[40:43], a[228:231], v[144:147], a[40:43]
    ds_read_b64_tr_b16 a[228:229], v202 offset:0
    ds_read_b64_tr_b16 a[230:231], v206 offset:0
    v_mfma_f32_16x16x32_bf16 a[56:59], a[236:239], v[144:147], a[56:59]
    ds_read_b64_tr_b16 a[236:237], v202 offset:512
    ds_read_b64_tr_b16 a[238:239], v206 offset:512
    v_mfma_f32_16x16x32_bf16 a[44:47], a[244:247], v[144:147], a[44:47]
    ds_read_b64_tr_b16 a[244:245], v203 offset:0
    ds_read_b64_tr_b16 a[246:247], v207 offset:0
    v_mfma_f32_16x16x32_bf16 a[60:63], a[252:255], v[144:147], a[60:63]
    buffer_load_dwordx4 v214, s[12:15], s21 offen offset:2048 nt lds
    ds_read_b64_tr_b16 a[252:253], v203 offset:512
    ds_read_b64_tr_b16 a[254:255], v207 offset:512
    s_waitcnt vmcnt(10)
    v_lshlrev_b32 v112, 16, v32
    v_and_b32 v113, 0xffff0000, v32
    v_pk_mul_f32 v[112:113], v[112:113], s[28:29]
    v_cvt_pk_bf16_f32 v32, v112, v113
    v_lshlrev_b32 v114, 16, v33
    v_and_b32 v115, 0xffff0000, v33
    v_pk_mul_f32 v[114:115], v[114:115], s[28:29]
    v_cvt_pk_bf16_f32 v33, v114, v115
    v_lshlrev_b32 v116, 16, v34
    v_and_b32 v117, 0xffff0000, v34
    v_pk_mul_f32 v[116:117], v[116:117], s[28:29]
    v_cvt_pk_bf16_f32 v34, v116, v117
    v_lshlrev_b32 v118, 16, v35
    v_and_b32 v119, 0xffff0000, v35
    v_pk_mul_f32 v[118:119], v[118:119], s[28:29]
    v_cvt_pk_bf16_f32 v35, v118, v119
    s_waitcnt vmcnt(9)
    v_lshlrev_b32 v112, 16, v36
    v_and_b32 v113, 0xffff0000, v36
    v_pk_mul_f32 v[112:113], v[112:113], s[28:29]
    v_cvt_pk_bf16_f32 v36, v112, v113
    v_lshlrev_b32 v114, 16, v37
    v_and_b32 v115, 0xffff0000, v37
    v_pk_mul_f32 v[114:115], v[114:115], s[28:29]
    v_cvt_pk_bf16_f32 v37, v114, v115
    v_lshlrev_b32 v116, 16, v38
    v_and_b32 v117, 0xffff0000, v38
    v_pk_mul_f32 v[116:117], v[116:117], s[28:29]
    v_cvt_pk_bf16_f32 v38, v116, v117
    v_lshlrev_b32 v118, 16, v39
    v_and_b32 v119, 0xffff0000, v39
    v_pk_mul_f32 v[118:119], v[118:119], s[28:29]
    v_cvt_pk_bf16_f32 v39, v118, v119
    s_waitcnt vmcnt(8)
    v_lshlrev_b32 v112, 16, v40
    v_and_b32 v113, 0xffff0000, v40
    v_pk_mul_f32 v[112:113], v[112:113], s[28:29]
    v_cvt_pk_bf16_f32 v40, v112, v113
    v_lshlrev_b32 v114, 16, v41
    v_and_b32 v115, 0xffff0000, v41
    v_pk_mul_f32 v[114:115], v[114:115], s[28:29]
    v_cvt_pk_bf16_f32 v41, v114, v115
    v_lshlrev_b32 v116, 16, v42
    v_and_b32 v117, 0xffff0000, v42
    v_pk_mul_f32 v[116:117], v[116:117], s[28:29]
    v_cvt_pk_bf16_f32 v42, v116, v117
    v_lshlrev_b32 v118, 16, v43
    v_and_b32 v119, 0xffff0000, v43
    v_pk_mul_f32 v[118:119], v[118:119], s[28:29]
    v_cvt_pk_bf16_f32 v43, v118, v119
    s_waitcnt vmcnt(7)
    v_lshlrev_b32 v112, 16, v44
    buffer_load_dwordx4 v215, s[12:15], s21 offen offset:3072 nt lds
    v_and_b32 v113, 0xffff0000, v44
    v_pk_mul_f32 v[112:113], v[112:113], s[28:29]
    v_cvt_pk_bf16_f32 v44, v112, v113
    v_lshlrev_b32 v114, 16, v45
    v_and_b32 v115, 0xffff0000, v45
    v_pk_mul_f32 v[114:115], v[114:115], s[28:29]
    v_cvt_pk_bf16_f32 v45, v114, v115
    v_lshlrev_b32 v116, 16, v46
    v_and_b32 v117, 0xffff0000, v46
    v_pk_mul_f32 v[116:117], v[116:117], s[28:29]
    v_cvt_pk_bf16_f32 v46, v116, v117
    v_lshlrev_b32 v118, 16, v47
    v_and_b32 v119, 0xffff0000, v47
    v_pk_mul_f32 v[118:119], v[118:119], s[28:29]
    v_cvt_pk_bf16_f32 v47, v118, v119
    v_mfma_f32_16x16x32_bf16 v[112:115], a[192:195], v[32:35], 0
    ds_read_b128 a[192:195], v190 offset:0
    v_mfma_f32_16x16x32_bf16 v[112:115], a[196:199], v[36:39], v[112:115]
    ds_read_b128 a[196:199], v191 offset:0
    v_mfma_f32_16x16x32_bf16 v[112:115], a[200:203], v[40:43], v[112:115]
    ds_read_b128 a[200:203], v190 offset:8192
    v_mfma_f32_16x16x32_bf16 v[112:115], a[204:207], v[44:47], v[112:115]
    ds_read_b128 a[204:207], v191 offset:8192
    v_mfma_f32_16x16x32_bf16 v[156:159], a[208:211], v[32:35], 0
    ds_read_b128 a[208:211], v192 offset:0
    v_mfma_f32_16x16x32_bf16 v[156:159], a[212:215], v[36:39], v[156:159]
    buffer_load_dwordx4 v[48:51], v232, s[4:7], s59 offen offset:0 nt
    ds_read_b128 a[212:215], v193 offset:0
    v_mfma_f32_16x16x32_bf16 v[156:159], a[216:219], v[40:43], v[156:159]
    ds_read_b128 a[216:219], v192 offset:8192
    v_mfma_f32_16x16x32_bf16 v[156:159], a[220:223], v[44:47], v[156:159]
    s_waitcnt lgkmcnt(3)
    ds_read_b128 a[220:223], v193 offset:8192
    v_mfma_f32_16x16x32_bf16 v[152:155], a[192:195], v[32:35], 0
    v_mfma_f32_16x16x32_bf16 v[152:155], a[196:199], v[36:39], v[152:155]
    v_mfma_f32_16x16x32_bf16 v[152:155], a[200:203], v[40:43], v[152:155]
    v_mfma_f32_16x16x32_bf16 v[152:155], a[204:207], v[44:47], v[152:155]
    v_exp_f32 v112, v112
    v_exp_f32 v113, v113
    v_exp_f32 v114, v114
    v_exp_f32 v115, v115
    v_exp_f32 v156, v156
    v_exp_f32 v157, v157
    v_exp_f32 v158, v158
    v_exp_f32 v159, v159
    v_cvt_pk_bf16_f32 v112, v112, v113
    buffer_load_dwordx4 v[52:55], v232, s[4:7], s59 offen offset:64 nt
    v_cvt_pk_bf16_f32 v113, v114, v115
    v_cvt_pk_bf16_f32 v114, v156, v157
    v_cvt_pk_bf16_f32 v115, v158, v159
    s_waitcnt lgkmcnt(0)
    v_mfma_f32_16x16x32_bf16 v[156:159], a[208:211], v[32:35], 0
    v_mfma_f32_16x16x32_bf16 v[156:159], a[212:215], v[36:39], v[156:159]
    v_mfma_f32_16x16x32_bf16 v[156:159], a[216:219], v[40:43], v[156:159]
    v_mfma_f32_16x16x32_bf16 v[156:159], a[220:223], v[44:47], v[156:159]
    s_waitcnt vmcnt(6)
    s_barrier
    ds_read_b128 a[192:195], v186 offset:16384
    ds_read_b128 a[196:199], v187 offset:16384
    ds_read_b128 a[200:203], v186 offset:24576
    ds_read_b128 a[204:207], v187 offset:24576
    s_waitcnt lgkmcnt(0)
    v_mfma_f32_16x16x32_bf16 v[100:103], a[192:195], v[0:3], 0
    buffer_load_dwordx4 v[56:59], v232, s[4:7], s59 offen offset:128 nt
    ds_read_b128 a[208:211], v188 offset:16384
    ds_read_b128 a[212:215], v189 offset:16384
    v_mfma_f32_16x16x32_bf16 v[100:103], a[196:199], v[4:7], v[100:103]
    buffer_load_dwordx4 v[60:63], v232, s[4:7], s59 offen offset:192 nt
    ds_read_b128 a[216:219], v188 offset:24576
    ds_read_b128 a[220:223], v189 offset:24576
    v_mfma_f32_16x16x32_bf16 v[100:103], a[200:203], v[8:11], v[100:103]
    v_mfma_f32_16x16x32_bf16 v[100:103], a[204:207], v[12:15], v[100:103]
    v_exp_f32 v152, v152
    v_mfma_f32_16x16x32_bf16 v[108:111], a[204:207], v[28:31], 0
    v_exp_f32 v153, v153
    v_mfma_f32_16x16x32_bf16 v[108:111], a[200:203], v[24:27], v[108:111]
    buffer_load_dwordx4 v[64:67], v232, s[4:7], s60 offen offset:0 nt
    v_exp_f32 v154, v154
    v_exp_f32 v155, v155
    v_mfma_f32_16x16x32_bf16 v[108:111], a[196:199], v[20:23], v[108:111]
    v_cvt_pk_bf16_f32 v152, v152, v153
    v_mfma_f32_16x16x32_bf16 v[108:111], a[192:195], v[16:19], v[108:111]
    v_exp_f32 v156, v156
    v_cvt_pk_bf16_f32 v153, v154, v155
    v_mfma_f32_16x16x32_bf16 v[116:119], a[192:195], v[32:35], 0
    v_exp_f32 v157, v157
    v_mfma_f32_16x16x32_bf16 v[116:119], a[196:199], v[36:39], v[116:119]
    v_exp_f32 v158, v158
    v_cvt_pk_bf16_f32 v154, v156, v157
    v_mfma_f32_16x16x32_bf16 v[116:119], a[200:203], v[40:43], v[116:119]
    v_exp_f32 v159, v159
    v_mfma_f32_16x16x32_bf16 v[116:119], a[204:207], v[44:47], v[116:119]
    v_exp_f32 v100, v100
    v_cvt_pk_bf16_f32 v155, v158, v159
    v_mfma_f32_16x16x32_bf16 v[176:179], a[204:207], v[92:95], 0
    buffer_load_dwordx4 v[68:71], v232, s[4:7], s60 offen offset:64 nt
    ds_read_b128 a[204:207], v191 offset:24576
    v_exp_f32 v101, v101
    v_mfma_f32_16x16x32_bf16 v[176:179], a[200:203], v[88:91], v[176:179]
    ds_read_b128 a[200:203], v190 offset:24576
    v_exp_f32 v102, v102
    v_mfma_f32_16x16x32_bf16 v[176:179], a[196:199], v[84:87], v[176:179]
    ds_read_b128 a[196:199], v191 offset:16384
    v_exp_f32 v103, v103
    v_mfma_f32_16x16x32_bf16 v[176:179], a[192:195], v[80:83], v[176:179]
    ds_read_b128 a[192:195], v190 offset:16384
    v_add_f32 v180, v180, v100
    v_add_f32 v180, v180, v101
    v_mfma_f32_16x16x32_bf16 a[64:67], a[224:227], v[112:115], 0
    ds_read_b64_tr_b16 a[224:225], v196 offset:0
    ds_read_b64_tr_b16 a[226:227], v200 offset:0
    v_add_f32 v180, v180, v102
    v_add_f32 v180, v180, v103
    v_mfma_f32_16x16x32_bf16 a[64:67], a[228:231], v[152:155], a[64:67]
    ds_read_b64_tr_b16 a[228:229], v204 offset:0
    ds_read_b64_tr_b16 a[230:231], v208 offset:0
    v_cvt_pk_bf16_f32 v100, v100, v101
    v_mfma_f32_16x16x32_bf16 a[80:83], a[236:239], v[152:155], 0
    ds_read_b64_tr_b16 a[236:237], v204 offset:512
    ds_read_b64_tr_b16 a[238:239], v208 offset:512
    v_cvt_pk_bf16_f32 v101, v102, v103
    buffer_load_dwordx4 v[72:75], v232, s[4:7], s60 offen offset:128 nt
    v_mfma_f32_16x16x32_bf16 a[80:83], a[232:235], v[112:115], a[80:83]
    ds_read_b64_tr_b16 a[232:233], v196 offset:512
    ds_read_b64_tr_b16 a[234:235], v200 offset:512
    v_mfma_f32_16x16x32_bf16 a[176:179], v[244:247], v[112:115], 0
    v_exp_f32 v108, v108
    v_mfma_f32_16x16x32_bf16 a[176:179], v[244:247], v[152:155], a[176:179]
    v_exp_f32 v109, v109
    v_exp_f32 v110, v110
    v_mfma_f32_16x16x32_bf16 a[68:71], a[240:243], v[112:115], 0
    ds_read_b64_tr_b16 a[240:241], v197 offset:0
    ds_read_b64_tr_b16 a[242:243], v201 offset:0
    v_add_f32 v181, v181, v108
    v_mfma_f32_16x16x32_bf16 a[68:71], a[244:247], v[152:155], a[68:71]
    ds_read_b64_tr_b16 a[244:245], v205 offset:0
    ds_read_b64_tr_b16 a[246:247], v209 offset:0
    v_add_f32 v181, v181, v109
    v_mfma_f32_16x16x32_bf16 a[84:87], a[252:255], v[152:155], 0
    ds_read_b64_tr_b16 a[252:253], v205 offset:512
    ds_read_b64_tr_b16 a[254:255], v209 offset:512
    v_add_f32 v181, v181, v110
    v_mfma_f32_16x16x32_bf16 a[84:87], a[248:251], v[112:115], a[84:87]
    s_waitcnt lgkmcnt(6)
    ds_read_b64_tr_b16 a[248:249], v197 offset:512
    ds_read_b64_tr_b16 a[250:251], v201 offset:512
    v_cvt_pk_bf16_f32 v108, v108, v109
    buffer_load_dwordx4 v[76:79], v232, s[4:7], s60 offen offset:192 nt
    v_mfma_f32_16x16x32_bf16 v[140:143], a[208:211], v[0:3], 0
    v_exp_f32 v176, v176
    v_exp_f32 v177, v177
    v_mfma_f32_16x16x32_bf16 v[140:143], a[212:215], v[4:7], v[140:143]
    v_exp_f32 v178, v178
    v_add_f32 v185, v185, v176
    v_mfma_f32_16x16x32_bf16 v[140:143], a[216:219], v[8:11], v[140:143]
    v_exp_f32 v179, v179
    v_add_f32 v185, v185, v177
    v_mfma_f32_16x16x32_bf16 v[140:143], a[220:223], v[12:15], v[140:143]
    v_add_f32 v185, v185, v178
    v_add_f32 v185, v185, v179
    v_cvt_pk_bf16_f32 v176, v176, v177
    v_mfma_f32_16x16x32_bf16 v[148:151], a[220:223], v[28:31], 0
    v_exp_f32 v111, v111
    v_cvt_pk_bf16_f32 v177, v178, v179
    v_mfma_f32_16x16x32_bf16 v[148:151], a[216:219], v[24:27], v[148:151]
    ds_write2st64_b64 v220, v[176:177], v[176:177] offset0:8 offset1:10
    v_exp_f32 v116, v116
    v_mfma_f32_16x16x32_bf16 v[148:151], a[212:215], v[20:23], v[148:151]
    v_exp_f32 v117, v117
    v_add_f32 v181, v181, v111
    v_mfma_f32_16x16x32_bf16 v[148:151], a[208:211], v[16:19], v[148:151]
    v_exp_f32 v118, v118
    v_cvt_pk_bf16_f32 v109, v110, v111
    v_mfma_f32_16x16x32_bf16 v[156:159], a[208:211], v[32:35], 0
    ds_read_b128 a[208:211], v192 offset:16384
    v_exp_f32 v119, v119
    v_mfma_f32_16x16x32_bf16 v[156:159], a[212:215], v[36:39], v[156:159]
    ds_read_b128 a[212:215], v193 offset:16384
    v_cvt_pk_bf16_f32 v116, v116, v117
    v_mfma_f32_16x16x32_bf16 v[156:159], a[216:219], v[40:43], v[156:159]
    ds_read_b128 a[216:219], v192 offset:24576
    v_cvt_pk_bf16_f32 v117, v118, v119
    v_mfma_f32_16x16x32_bf16 v[156:159], a[220:223], v[44:47], v[156:159]
    ds_read_b128 a[220:223], v193 offset:24576
    v_exp_f32 v140, v140
    v_mfma_f32_16x16x32_bf16 a[72:75], a[224:227], v[112:115], 0
    v_exp_f32 v141, v141
    v_add_f32 v180, v180, v140
    v_mfma_f32_16x16x32_bf16 a[72:75], a[228:231], v[152:155], a[72:75]
    s_mov_b32 s21, 32768
    s_add_u32 m0, s24, 32768
    s_nop 0
    buffer_load_dwordx4 v210, s[8:11], s21 offen offset:0 nt lds
    v_exp_f32 v142, v142
    v_add_f32 v180, v180, v141
    v_mfma_f32_16x16x32_bf16 a[88:91], a[236:239], v[152:155], 0
    v_exp_f32 v143, v143
    v_add_f32 v180, v180, v142
    v_mfma_f32_16x16x32_bf16 a[88:91], a[232:235], v[112:115], a[88:91]
    s_waitcnt lgkmcnt(0)
    v_exp_f32 v148, v148
    v_add_f32 v180, v180, v143
    v_mfma_f32_16x16x32_bf16 a[76:79], a[240:243], v[112:115], 0
    v_exp_f32 v149, v149
    v_cvt_pk_bf16_f32 v102, v140, v141
    v_mfma_f32_16x16x32_bf16 a[76:79], a[244:247], v[152:155], a[76:79]
    v_exp_f32 v150, v150
    v_cvt_pk_bf16_f32 v103, v142, v143
    v_add_f32 v181, v181, v148
    v_mfma_f32_16x16x32_bf16 a[92:95], a[252:255], v[152:155], 0
    v_exp_f32 v151, v151
    v_add_f32 v181, v181, v149
    v_mfma_f32_16x16x32_bf16 a[92:95], a[248:251], v[112:115], a[92:95]
    s_waitcnt vmcnt(9)
    v_add_f32 v181, v181, v150
    s_barrier
    v_mfma_f32_16x16x32_bf16 v[136:139], a[192:195], v[0:3], 0
    ds_read_b64_tr_b16 a[224:225], v194 offset:16384
    ds_read_b64_tr_b16 a[226:227], v198 offset:16384
    ds_read_b64_tr_b16 a[228:229], v202 offset:16384
    ds_read_b64_tr_b16 a[230:231], v206 offset:16384
    ds_read_b64_tr_b16 a[236:237], v202 offset:16896
    ds_read_b64_tr_b16 a[238:239], v206 offset:16896
    v_mfma_f32_16x16x32_bf16 v[136:139], a[196:199], v[4:7], v[136:139]
    ds_read_b64_tr_b16 a[232:233], v194 offset:16896
    ds_read_b64_tr_b16 a[234:235], v198 offset:16896
    v_add_f32 v181, v181, v151
    v_mfma_f32_16x16x32_bf16 v[136:139], a[200:203], v[8:11], v[136:139]
    ds_read_b64_tr_b16 a[240:241], v195 offset:16384
    ds_read_b64_tr_b16 a[242:243], v199 offset:16384
    v_exp_f32 v156, v156
    v_mfma_f32_16x16x32_bf16 v[136:139], a[204:207], v[12:15], v[136:139]
    ds_read_b64_tr_b16 a[244:245], v203 offset:16384
    ds_read_b64_tr_b16 a[246:247], v207 offset:16384
    v_cvt_pk_bf16_f32 v110, v148, v149
    buffer_load_dwordx4 v211, s[8:11], s21 offen offset:1024 nt lds
    v_mfma_f32_16x16x32_bf16 v[144:147], a[204:207], v[28:31], 0
    ds_read_b64_tr_b16 a[252:253], v203 offset:16896
    ds_read_b64_tr_b16 a[254:255], v207 offset:16896
    v_cvt_pk_bf16_f32 v111, v150, v151
    v_mfma_f32_16x16x32_bf16 v[144:147], a[200:203], v[24:27], v[144:147]
    ds_read_b64_tr_b16 a[248:249], v195 offset:16896
    v_exp_f32 v157, v157
    v_mfma_f32_16x16x32_bf16 v[144:147], a[196:199], v[20:23], v[144:147]
    ds_read_b64_tr_b16 a[250:251], v199 offset:16896
    ds_read2st64_b64 a[168:171], v220 offset0:8 offset1:9
    v_cvt_pk_bf16_f32 v118, v156, v157
    v_mfma_f32_16x16x32_bf16 v[144:147], a[192:195], v[16:19], v[144:147]
    ds_read2st64_b64 a[172:175], v221 offset0:8 offset1:9
    v_exp_f32 v158, v158
    v_mfma_f32_16x16x32_bf16 v[152:155], a[192:195], v[32:35], 0
    ds_read_b128 a[192:195], v186 offset:16384
    v_exp_f32 v159, v159
    v_mfma_f32_16x16x32_bf16 v[152:155], a[196:199], v[36:39], v[152:155]
    ds_read_b128 a[196:199], v187 offset:16384
    v_cvt_pk_bf16_f32 v119, v158, v159
    v_mfma_f32_16x16x32_bf16 v[152:155], a[200:203], v[40:43], v[152:155]
    ds_read_b128 a[200:203], v186 offset:24576
    v_mfma_f32_16x16x32_bf16 v[152:155], a[204:207], v[44:47], v[152:155]
    ds_read_b128 a[204:207], v187 offset:24576
    v_exp_f32 v136, v136
    v_mfma_f32_16x16x32_bf16 v[140:143], a[208:211], v[0:3], 0
    v_exp_f32 v137, v137
    v_add_f32 v180, v180, v136
    v_mfma_f32_16x16x32_bf16 v[140:143], a[212:215], v[4:7], v[140:143]
    v_exp_f32 v138, v138
    v_exp_f32 v139, v139
    v_mfma_f32_16x16x32_bf16 v[140:143], a[216:219], v[8:11], v[140:143]
    v_add_f32 v180, v180, v137
    v_add_f32 v180, v180, v138
    v_add_f32 v180, v180, v139
    v_mfma_f32_16x16x32_bf16 v[140:143], a[220:223], v[12:15], v[140:143]
    v_exp_f32 v144, v144
    v_cvt_pk_bf16_f32 v136, v136, v137
    v_mfma_f32_16x16x32_bf16 v[148:151], a[220:223], v[28:31], 0
    v_exp_f32 v145, v145
    v_cvt_pk_bf16_f32 v137, v138, v139
    v_mfma_f32_16x16x32_bf16 v[148:151], a[216:219], v[24:27], v[148:151]
    buffer_load_dwordx4 v212, s[8:11], s21 offen offset:2048 nt lds
    v_exp_f32 v146, v146
    v_add_f32 v181, v181, v144
    v_mfma_f32_16x16x32_bf16 v[148:151], a[212:215], v[20:23], v[148:151]
    v_exp_f32 v147, v147
    v_add_f32 v181, v181, v145
    v_add_f32 v181, v181, v146
    v_mfma_f32_16x16x32_bf16 v[148:151], a[208:211], v[16:19], v[148:151]
    v_exp_f32 v152, v152
    v_add_f32 v181, v181, v147
    v_mfma_f32_16x16x32_bf16 v[156:159], a[208:211], v[32:35], 0
    v_exp_f32 v153, v153
    v_cvt_pk_bf16_f32 v144, v144, v145
    v_mfma_f32_16x16x32_bf16 v[156:159], a[212:215], v[36:39], v[156:159]
    v_exp_f32 v154, v154
    v_cvt_pk_bf16_f32 v145, v146, v147
    v_mfma_f32_16x16x32_bf16 v[156:159], a[216:219], v[40:43], v[156:159]
    v_exp_f32 v155, v155
    v_cvt_pk_bf16_f32 v152, v152, v153
    v_mfma_f32_16x16x32_bf16 v[156:159], a[220:223], v[44:47], v[156:159]
    v_exp_f32 v140, v140
    v_exp_f32 v141, v141
    s_waitcnt vmcnt(10)
    v_lshlrev_b32 v120, 16, v48
    v_and_b32 v121, 0xffff0000, v48
    v_pk_mul_f32 v[120:121], v[120:121], s[28:29]
    v_cvt_pk_bf16_f32 v48, v120, v121
    v_lshlrev_b32 v122, 16, v49
    v_and_b32 v123, 0xffff0000, v49
    v_pk_mul_f32 v[122:123], v[122:123], s[28:29]
    v_cvt_pk_bf16_f32 v49, v122, v123
    v_lshlrev_b32 v124, 16, v50
    v_and_b32 v125, 0xffff0000, v50
    v_pk_mul_f32 v[124:125], v[124:125], s[28:29]
    v_cvt_pk_bf16_f32 v50, v124, v125
    v_lshlrev_b32 v126, 16, v51
    v_and_b32 v127, 0xffff0000, v51
    v_pk_mul_f32 v[126:127], v[126:127], s[28:29]
    v_cvt_pk_bf16_f32 v51, v126, v127
    s_waitcnt vmcnt(9)
    v_lshlrev_b32 v120, 16, v52
    v_and_b32 v121, 0xffff0000, v52
    v_pk_mul_f32 v[120:121], v[120:121], s[28:29]
    v_cvt_pk_bf16_f32 v52, v120, v121
    v_lshlrev_b32 v122, 16, v53
    v_and_b32 v123, 0xffff0000, v53
    v_pk_mul_f32 v[122:123], v[122:123], s[28:29]
    v_cvt_pk_bf16_f32 v53, v122, v123
    v_lshlrev_b32 v124, 16, v54
    v_and_b32 v125, 0xffff0000, v54
    v_pk_mul_f32 v[124:125], v[124:125], s[28:29]
    v_cvt_pk_bf16_f32 v54, v124, v125
    buffer_load_dwordx4 v213, s[8:11], s21 offen offset:3072 nt lds
    v_lshlrev_b32 v126, 16, v55
    v_and_b32 v127, 0xffff0000, v55
    v_pk_mul_f32 v[126:127], v[126:127], s[28:29]
    v_cvt_pk_bf16_f32 v55, v126, v127
    s_waitcnt vmcnt(9)
    v_lshlrev_b32 v120, 16, v56
    v_and_b32 v121, 0xffff0000, v56
    v_pk_mul_f32 v[120:121], v[120:121], s[28:29]
    v_cvt_pk_bf16_f32 v56, v120, v121
    v_lshlrev_b32 v122, 16, v57
    v_and_b32 v123, 0xffff0000, v57
    v_pk_mul_f32 v[122:123], v[122:123], s[28:29]
    v_cvt_pk_bf16_f32 v57, v122, v123
    v_lshlrev_b32 v124, 16, v58
    v_and_b32 v125, 0xffff0000, v58
    v_pk_mul_f32 v[124:125], v[124:125], s[28:29]
    v_cvt_pk_bf16_f32 v58, v124, v125
    v_lshlrev_b32 v126, 16, v59
    v_and_b32 v127, 0xffff0000, v59
    v_pk_mul_f32 v[126:127], v[126:127], s[28:29]
    v_cvt_pk_bf16_f32 v59, v126, v127
    s_waitcnt vmcnt(8)
    v_lshlrev_b32 v120, 16, v60
    v_and_b32 v121, 0xffff0000, v60
    v_pk_mul_f32 v[120:121], v[120:121], s[28:29]
    v_cvt_pk_bf16_f32 v60, v120, v121
    v_lshlrev_b32 v122, 16, v61
    v_and_b32 v123, 0xffff0000, v61
    v_pk_mul_f32 v[122:123], v[122:123], s[28:29]
    v_cvt_pk_bf16_f32 v61, v122, v123
    v_lshlrev_b32 v124, 16, v62
    v_and_b32 v125, 0xffff0000, v62
    v_pk_mul_f32 v[124:125], v[124:125], s[28:29]
    v_cvt_pk_bf16_f32 v62, v124, v125
    v_lshlrev_b32 v126, 16, v63
    v_and_b32 v127, 0xffff0000, v63
    v_pk_mul_f32 v[126:127], v[126:127], s[28:29]
    v_cvt_pk_bf16_f32 v63, v126, v127
    s_waitcnt lgkmcnt(0)
    s_nop 0
    v_mfma_f32_16x16x32_bf16 v[124:127], a[204:207], v[60:63], 0
    v_exp_f32 v142, v142
    v_mfma_f32_16x16x32_bf16 v[124:127], a[200:203], v[56:59], v[124:127]
    v_exp_f32 v143, v143
    v_mfma_f32_16x16x32_bf16 v[124:127], a[196:199], v[52:55], v[124:127]
    v_add_f32 v180, v180, v140
    v_add_f32 v180, v180, v141
    v_mfma_f32_16x16x32_bf16 v[124:127], a[192:195], v[48:51], v[124:127]
    v_add_f32 v180, v180, v142
    v_add_f32 v180, v180, v143
    v_mfma_f32_16x16x32_bf16 a[160:163], a[224:227], a[168:171], a[160:163]
    v_cvt_pk_bf16_f32 v138, v140, v141
    v_cvt_pk_bf16_f32 v153, v154, v155
    v_mfma_f32_16x16x32_bf16 a[160:163], a[228:231], a[172:175], a[160:163]
    ds_read_b128 a[208:211], v188 offset:16384
    v_cvt_pk_bf16_f32 v139, v142, v143
    v_mfma_f32_16x16x32_bf16 a[164:167], a[236:239], a[172:175], a[164:167]
    v_exp_f32 v148, v148
    v_exp_f32 v149, v149
    v_exp_f32 v150, v150
    v_exp_f32 v151, v151
    v_mfma_f32_16x16x32_bf16 a[164:167], a[232:235], a[168:171], a[164:167]
    s_mov_b32 s21, 32768
    s_add_u32 m0, s25, 32768
    s_nop 0
    buffer_load_dwordx4 v214, s[12:15], s21 offen offset:0 nt lds
    v_add_f32 v181, v181, v148
    v_add_f32 v181, v181, v149
    v_mfma_f32_16x16x32_bf16 a[16:19], a[232:235], v[100:103], a[16:19]
    v_add_f32 v181, v181, v150
    v_add_f32 v181, v181, v151
    v_mfma_f32_16x16x32_bf16 a[16:19], a[236:239], v[136:139], a[16:19]
    ds_read_b128 a[212:215], v189 offset:16384
    v_cvt_pk_bf16_f32 v146, v148, v149
    v_mfma_f32_16x16x32_bf16 a[0:3], a[228:231], v[136:139], a[0:3]
    v_exp_f32 v156, v156
    v_exp_f32 v157, v157
    v_exp_f32 v158, v158
    v_exp_f32 v159, v159
    v_cvt_pk_bf16_f32 v147, v150, v151
    v_mfma_f32_16x16x32_bf16 a[0:3], a[224:227], v[100:103], a[0:3]
    ds_read_b128 a[216:219], v188 offset:24576
    v_cvt_pk_bf16_f32 v154, v156, v157
    v_mfma_f32_16x16x32_bf16 a[32:35], a[224:227], v[108:111], a[32:35]
    ds_read_b128 a[220:223], v189 offset:24576
    v_cvt_pk_bf16_f32 v155, v158, v159
    v_mfma_f32_16x16x32_bf16 a[32:35], a[228:231], v[144:147], a[32:35]
    v_exp_f32 v124, v124
    v_mfma_f32_16x16x32_bf16 a[48:51], a[236:239], v[144:147], a[48:51]
    v_exp_f32 v125, v125
    v_mfma_f32_16x16x32_bf16 a[48:51], a[232:235], v[108:111], a[48:51]
    ds_read_b128 a[192:195], v190 offset:16384
    v_cvt_pk_bf16_f32 v124, v124, v125
    v_mfma_f32_16x16x32_bf16 a[80:83], a[232:235], v[116:119], a[80:83]
    v_exp_f32 v126, v126
    v_mfma_f32_16x16x32_bf16 a[80:83], a[236:239], v[152:155], a[80:83]
    v_exp_f32 v127, v127
    v_mfma_f32_16x16x32_bf16 a[64:67], a[228:231], v[152:155], a[64:67]
    ds_read_b64_tr_b16 a[228:229], v204 offset:16384
    v_cvt_pk_bf16_f32 v125, v126, v127
    v_mfma_f32_16x16x32_bf16 a[64:67], a[224:227], v[116:119], a[64:67]
    ds_read_b64_tr_b16 a[224:225], v196 offset:16384
    ds_read_b64_tr_b16 a[226:227], v200 offset:16384
    v_mfma_f32_16x16x32_bf16 a[176:179], v[244:247], v[116:119], a[176:179]
    buffer_load_dwordx4 v215, s[12:15], s21 offen offset:1024 nt lds
    ds_read_b64_tr_b16 a[230:231], v208 offset:16384
    v_mfma_f32_16x16x32_bf16 a[176:179], v[244:247], v[152:155], a[176:179]
    ds_read_b64_tr_b16 a[236:237], v204 offset:16896
    v_mfma_f32_16x16x32_bf16 a[68:71], a[240:243], v[116:119], a[68:71]
    ds_read_b64_tr_b16 a[238:239], v208 offset:16896
    v_mfma_f32_16x16x32_bf16 a[68:71], a[244:247], v[152:155], a[68:71]
    ds_read_b64_tr_b16 a[232:233], v196 offset:16896
    v_mfma_f32_16x16x32_bf16 a[84:87], a[252:255], v[152:155], a[84:87]
    ds_read_b64_tr_b16 a[234:235], v200 offset:16896
    v_mfma_f32_16x16x32_bf16 a[84:87], a[248:251], v[116:119], a[84:87]
    ds_read_b128 a[196:199], v191 offset:16384
    v_mfma_f32_16x16x32_bf16 a[52:55], a[248:251], v[108:111], a[52:55]
    ds_read_b128 a[200:203], v190 offset:24576
    v_mfma_f32_16x16x32_bf16 a[52:55], a[252:255], v[144:147], a[52:55]
    ds_read_b128 a[204:207], v191 offset:24576
    v_mfma_f32_16x16x32_bf16 a[36:39], a[244:247], v[144:147], a[36:39]
    v_mfma_f32_16x16x32_bf16 a[36:39], a[240:243], v[108:111], a[36:39]
    v_mfma_f32_16x16x32_bf16 a[4:7], a[240:243], v[100:103], a[4:7]
    ds_read_b64_tr_b16 a[240:241], v197 offset:16384
    v_mfma_f32_16x16x32_bf16 a[4:7], a[244:247], v[136:139], a[4:7]
    ds_read_b64_tr_b16 a[242:243], v201 offset:16384
    v_mfma_f32_16x16x32_bf16 a[20:23], a[252:255], v[136:139], a[20:23]
    ds_read_b64_tr_b16 a[244:245], v205 offset:16384
    v_mfma_f32_16x16x32_bf16 a[20:23], a[248:251], v[100:103], a[20:23]
    s_waitcnt lgkmcnt(6)
    ds_read_b64_tr_b16 a[246:247], v209 offset:16384
    v_mfma_f32_16x16x32_bf16 v[164:167], a[220:223], v[60:63], 0
    ds_read_b128 a[220:223], v193 offset:24576
    v_mfma_f32_16x16x32_bf16 v[164:167], a[216:219], v[56:59], v[164:167]
    ds_read_b128 a[216:219], v192 offset:24576
    v_mfma_f32_16x16x32_bf16 v[164:167], a[212:215], v[52:55], v[164:167]
    ds_read_b128 a[212:215], v193 offset:16384
    v_mfma_f32_16x16x32_bf16 v[164:167], a[208:211], v[48:51], v[164:167]
    buffer_load_dwordx4 v214, s[12:15], s21 offen offset:2048 nt lds
    ds_read_b128 a[208:211], v192 offset:16384
    v_mfma_f32_16x16x32_bf16 a[8:11], a[224:227], v[100:103], a[8:11]
    ds_read_b64_tr_b16 a[252:253], v205 offset:16896
    v_mfma_f32_16x16x32_bf16 a[8:11], a[228:231], v[136:139], a[8:11]
    ds_read_b64_tr_b16 a[254:255], v209 offset:16896
    v_mfma_f32_16x16x32_bf16 a[24:27], a[236:239], v[136:139], a[24:27]
    ds_read_b64_tr_b16 a[248:249], v197 offset:16896
    v_mfma_f32_16x16x32_bf16 a[24:27], a[232:235], v[100:103], a[24:27]
    ds_read_b64_tr_b16 a[250:251], v201 offset:16896
    v_mfma_f32_16x16x32_bf16 a[56:59], a[232:235], v[108:111], a[56:59]
    v_mfma_f32_16x16x32_bf16 a[56:59], a[236:239], v[144:147], a[56:59]
    v_mfma_f32_16x16x32_bf16 a[40:43], a[228:231], v[144:147], a[40:43]
    v_mfma_f32_16x16x32_bf16 a[40:43], a[224:227], v[108:111], a[40:43]
    v_exp_f32 v164, v164
    v_mfma_f32_16x16x32_bf16 a[72:75], a[224:227], v[116:119], a[72:75]
    ds_read_b64_tr_b16 a[224:225], v194 offset:16384
    ds_read_b64_tr_b16 a[226:227], v198 offset:16384
    v_mfma_f32_16x16x32_bf16 a[72:75], a[228:231], v[152:155], a[72:75]
    ds_read_b64_tr_b16 a[228:229], v202 offset:16384
    ds_read_b64_tr_b16 a[230:231], v206 offset:16384
    v_mfma_f32_16x16x32_bf16 a[88:91], a[236:239], v[152:155], a[88:91]
    ds_read_b64_tr_b16 a[236:237], v202 offset:16896
    ds_read_b64_tr_b16 a[238:239], v206 offset:16896
    v_mfma_f32_16x16x32_bf16 a[88:91], a[232:235], v[116:119], a[88:91]
    s_waitcnt lgkmcnt(6)
    ds_read_b64_tr_b16 a[232:233], v194 offset:16896
    ds_read_b64_tr_b16 a[234:235], v198 offset:16896
    v_mfma_f32_16x16x32_bf16 a[76:79], a[240:243], v[116:119], a[76:79]
    v_exp_f32 v165, v165
    v_mfma_f32_16x16x32_bf16 a[76:79], a[244:247], v[152:155], a[76:79]
    v_exp_f32 v166, v166
    v_mfma_f32_16x16x32_bf16 a[92:95], a[252:255], v[152:155], a[92:95]
    v_exp_f32 v167, v167
    v_mfma_f32_16x16x32_bf16 a[92:95], a[248:251], v[116:119], a[92:95]
    buffer_load_dwordx4 v215, s[12:15], s21 offen offset:3072 nt lds
    v_cvt_pk_bf16_f32 v126, v164, v165
    v_mfma_f32_16x16x32_bf16 a[60:63], a[248:251], v[108:111], a[60:63]
    v_cvt_pk_bf16_f32 v127, v166, v167
    v_mfma_f32_16x16x32_bf16 a[60:63], a[252:255], v[144:147], a[60:63]
    v_mfma_f32_16x16x32_bf16 a[44:47], a[244:247], v[144:147], a[44:47]
    v_mfma_f32_16x16x32_bf16 a[44:47], a[240:243], v[108:111], a[44:47]
    v_mfma_f32_16x16x32_bf16 a[12:15], a[240:243], v[100:103], a[12:15]
    ds_read_b64_tr_b16 a[240:241], v195 offset:16384
    ds_read_b64_tr_b16 a[242:243], v199 offset:16384
    v_mfma_f32_16x16x32_bf16 a[12:15], a[244:247], v[136:139], a[12:15]
    ds_read_b64_tr_b16 a[244:245], v203 offset:16384
    ds_read_b64_tr_b16 a[246:247], v207 offset:16384
    v_mfma_f32_16x16x32_bf16 a[28:31], a[252:255], v[136:139], a[28:31]
    ds_read_b64_tr_b16 a[252:253], v203 offset:16896
    ds_read_b64_tr_b16 a[254:255], v207 offset:16896
    v_mfma_f32_16x16x32_bf16 a[28:31], a[248:251], v[100:103], a[28:31]
    ds_read_b64_tr_b16 a[248:249], v195 offset:16896
    ds_read_b64_tr_b16 a[250:251], v199 offset:16896
    v_mfma_f32_16x16x32_bf16 v[160:163], a[204:207], v[60:63], 0
    s_mov_b32 s21, 49152
    s_add_u32 m0, s24, 49152
    s_nop 0
    buffer_load_dwordx4 v210, s[8:11], s21 offen offset:0 nt lds
    v_mfma_f32_16x16x32_bf16 v[160:163], a[200:203], v[56:59], v[160:163]
    v_mfma_f32_16x16x32_bf16 v[160:163], a[196:199], v[52:55], v[160:163]
    v_mfma_f32_16x16x32_bf16 v[160:163], a[192:195], v[48:51], v[160:163]
    s_waitcnt vmcnt(5)
    s_barrier
    v_mfma_f32_16x16x32_bf16 v[164:167], a[220:223], v[60:63], 0
    buffer_load_dwordx4 v211, s[8:11], s21 offen offset:1024 nt lds
    ds_read_b128 a[192:195], v186 offset:32768
    ds_read_b128 a[196:199], v187 offset:32768
    ds_read_b128 a[200:203], v186 offset:40960
    ds_read_b128 a[204:207], v187 offset:40960
    v_mfma_f32_16x16x32_bf16 v[164:167], a[216:219], v[56:59], v[164:167]
    buffer_load_dwordx4 v212, s[8:11], s21 offen offset:2048 nt lds
    ds_read_b128 a[216:219], v188 offset:40960
    v_mfma_f32_16x16x32_bf16 v[164:167], a[212:215], v[52:55], v[164:167]
    buffer_load_dwordx4 v213, s[8:11], s21 offen offset:3072 nt lds
    ds_read_b128 a[212:215], v189 offset:32768
    v_mfma_f32_16x16x32_bf16 v[164:167], a[208:211], v[48:51], v[164:167]
    s_waitcnt lgkmcnt(2)
    ds_read_b128 a[208:211], v188 offset:32768
    v_mfma_f32_16x16x32_bf16 v[96:99], a[192:195], v[0:3], 0
    ds_read_b128 a[220:223], v189 offset:40960
    v_mfma_f32_16x16x32_bf16 v[96:99], a[196:199], v[4:7], v[96:99]
    s_mov_b32 s21, 49152
    s_add_u32 m0, s25, 49152
    s_nop 0
    buffer_load_dwordx4 v214, s[12:15], s21 offen offset:0 nt lds
    v_mfma_f32_16x16x32_bf16 v[96:99], a[200:203], v[8:11], v[96:99]
    v_mfma_f32_16x16x32_bf16 v[96:99], a[204:207], v[12:15], v[96:99]
    v_exp_f32 v160, v160
    v_mfma_f32_16x16x32_bf16 v[104:107], a[204:207], v[28:31], 0
    v_exp_f32 v161, v161
    v_mfma_f32_16x16x32_bf16 v[104:107], a[200:203], v[24:27], v[104:107]
    v_exp_f32 v162, v162
    v_cvt_pk_bf16_f32 v160, v160, v161
    v_mfma_f32_16x16x32_bf16 v[104:107], a[196:199], v[20:23], v[104:107]
    v_exp_f32 v163, v163
    v_mfma_f32_16x16x32_bf16 v[104:107], a[192:195], v[16:19], v[104:107]
    v_exp_f32 v164, v164
    v_cvt_pk_bf16_f32 v161, v162, v163
    v_mfma_f32_16x16x32_bf16 v[112:115], a[192:195], v[32:35], 0
    v_exp_f32 v165, v165
    v_mfma_f32_16x16x32_bf16 v[112:115], a[196:199], v[36:39], v[112:115]
    v_exp_f32 v166, v166
    v_cvt_pk_bf16_f32 v162, v164, v165
    buffer_load_dwordx4 v215, s[12:15], s21 offen offset:1024 nt lds
    v_mfma_f32_16x16x32_bf16 v[112:115], a[200:203], v[40:43], v[112:115]
    v_exp_f32 v167, v167
    v_mfma_f32_16x16x32_bf16 v[112:115], a[204:207], v[44:47], v[112:115]
    v_exp_f32 v96, v96
    v_cvt_pk_bf16_f32 v163, v166, v167
    v_mfma_f32_16x16x32_bf16 v[120:123], a[204:207], v[60:63], 0
    v_exp_f32 v97, v97
    v_add_f32 v180, v180, v96
    v_mfma_f32_16x16x32_bf16 v[120:123], a[200:203], v[56:59], v[120:123]
    v_exp_f32 v98, v98
    v_add_f32 v180, v180, v97
    v_mfma_f32_16x16x32_bf16 v[120:123], a[196:199], v[52:55], v[120:123]
    v_exp_f32 v99, v99
    v_add_f32 v180, v180, v98
    v_mfma_f32_16x16x32_bf16 v[120:123], a[192:195], v[48:51], v[120:123]
    v_exp_f32 v104, v104
    v_add_f32 v180, v180, v99
    v_lshlrev_b32 v128, 16, v64
    v_and_b32 v129, 0xffff0000, v64
    v_pk_mul_f32 v[128:129], v[128:129], s[28:29]
    v_cvt_pk_bf16_f32 v64, v128, v129
    buffer_load_dwordx4 v214, s[12:15], s21 offen offset:2048 nt lds
    v_lshlrev_b32 v130, 16, v65
    v_and_b32 v131, 0xffff0000, v65
    v_pk_mul_f32 v[130:131], v[130:131], s[28:29]
    v_cvt_pk_bf16_f32 v65, v130, v131
    v_lshlrev_b32 v132, 16, v66
    v_and_b32 v133, 0xffff0000, v66
    v_pk_mul_f32 v[132:133], v[132:133], s[28:29]
    v_cvt_pk_bf16_f32 v66, v132, v133
    v_lshlrev_b32 v134, 16, v67
    v_and_b32 v135, 0xffff0000, v67
    v_pk_mul_f32 v[134:135], v[134:135], s[28:29]
    v_cvt_pk_bf16_f32 v67, v134, v135
    v_lshlrev_b32 v128, 16, v68
    v_and_b32 v129, 0xffff0000, v68
    v_pk_mul_f32 v[128:129], v[128:129], s[28:29]
    v_cvt_pk_bf16_f32 v68, v128, v129
    v_lshlrev_b32 v130, 16, v69
    v_and_b32 v131, 0xffff0000, v69
    v_pk_mul_f32 v[130:131], v[130:131], s[28:29]
    v_cvt_pk_bf16_f32 v69, v130, v131
    v_lshlrev_b32 v132, 16, v70
    v_and_b32 v133, 0xffff0000, v70
    v_pk_mul_f32 v[132:133], v[132:133], s[28:29]
    v_cvt_pk_bf16_f32 v70, v132, v133
    v_lshlrev_b32 v134, 16, v71
    v_and_b32 v135, 0xffff0000, v71
    v_pk_mul_f32 v[134:135], v[134:135], s[28:29]
    v_cvt_pk_bf16_f32 v71, v134, v135
    v_lshlrev_b32 v128, 16, v72
    v_and_b32 v129, 0xffff0000, v72
    v_pk_mul_f32 v[128:129], v[128:129], s[28:29]
    v_cvt_pk_bf16_f32 v72, v128, v129
    v_lshlrev_b32 v130, 16, v73
    v_and_b32 v131, 0xffff0000, v73
    buffer_load_dwordx4 v215, s[12:15], s21 offen offset:3072 nt lds
    v_pk_mul_f32 v[130:131], v[130:131], s[28:29]
    v_cvt_pk_bf16_f32 v73, v130, v131
    v_lshlrev_b32 v132, 16, v74
    v_and_b32 v133, 0xffff0000, v74
    v_pk_mul_f32 v[132:133], v[132:133], s[28:29]
    v_cvt_pk_bf16_f32 v74, v132, v133
    v_lshlrev_b32 v134, 16, v75
    v_and_b32 v135, 0xffff0000, v75
    v_pk_mul_f32 v[134:135], v[134:135], s[28:29]
    v_cvt_pk_bf16_f32 v75, v134, v135
    v_lshlrev_b32 v128, 16, v76
    v_and_b32 v129, 0xffff0000, v76
    v_pk_mul_f32 v[128:129], v[128:129], s[28:29]
    v_cvt_pk_bf16_f32 v76, v128, v129
    v_lshlrev_b32 v130, 16, v77
    v_and_b32 v131, 0xffff0000, v77
    v_pk_mul_f32 v[130:131], v[130:131], s[28:29]
    v_cvt_pk_bf16_f32 v77, v130, v131
    v_lshlrev_b32 v132, 16, v78
    v_and_b32 v133, 0xffff0000, v78
    v_pk_mul_f32 v[132:133], v[132:133], s[28:29]
    v_cvt_pk_bf16_f32 v78, v132, v133
    v_lshlrev_b32 v134, 16, v79
    v_and_b32 v135, 0xffff0000, v79
    v_pk_mul_f32 v[134:135], v[134:135], s[28:29]
    v_cvt_pk_bf16_f32 v79, v134, v135
    v_mfma_f32_16x16x32_bf16 v[128:131], a[192:195], v[64:67], 0
    v_exp_f32 v105, v105
    v_cvt_pk_bf16_f32 v96, v96, v97
    v_mfma_f32_16x16x32_bf16 v[128:131], a[196:199], v[68:71], v[128:131]
    v_exp_f32 v106, v106
    v_cvt_pk_bf16_f32 v97, v98, v99
    s_mov_b32 s21, 65536
    s_add_u32 m0, s24, 0
    s_nop 0
    buffer_load_dwordx4 v210, s[8:11], s21 offen offset:0 nt lds
    v_mfma_f32_16x16x32_bf16 v[128:131], a[200:203], v[72:75], v[128:131]
    v_exp_f32 v107, v107
    v_add_f32 v181, v181, v104
    v_mfma_f32_16x16x32_bf16 v[128:131], a[204:207], v[76:79], v[128:131]
    v_add_f32 v181, v181, v105
    v_add_f32 v181, v181, v106
    v_add_f32 v181, v181, v107
    v_mfma_f32_16x16x32_bf16 v[176:179], a[204:207], v[92:95], 0
    ds_read_b128 a[204:207], v191 offset:40960
    v_exp_f32 v112, v112
    v_mfma_f32_16x16x32_bf16 v[176:179], a[200:203], v[88:91], v[176:179]
    ds_read_b128 a[200:203], v190 offset:40960
    v_exp_f32 v113, v113
    v_mfma_f32_16x16x32_bf16 v[176:179], a[196:199], v[84:87], v[176:179]
    ds_read_b128 a[196:199], v191 offset:32768
    v_cvt_pk_bf16_f32 v104, v104, v105
    v_cvt_pk_bf16_f32 v112, v112, v113
    v_mfma_f32_16x16x32_bf16 v[176:179], a[192:195], v[80:83], v[176:179]
    ds_read_b128 a[192:195], v190 offset:32768
    v_exp_f32 v114, v114
    v_mfma_f32_16x16x32_bf16 a[96:99], a[224:227], v[124:127], 0
    ds_read_b64_tr_b16 a[224:225], v196 offset:16384
    ds_read_b64_tr_b16 a[226:227], v200 offset:16384
    v_cvt_pk_bf16_f32 v105, v106, v107
    v_mfma_f32_16x16x32_bf16 a[96:99], a[228:231], v[160:163], a[96:99]
    buffer_load_dwordx4 v211, s[8:11], s21 offen offset:1024 nt lds
    ds_read_b64_tr_b16 a[228:229], v204 offset:16384
    ds_read_b64_tr_b16 a[230:231], v208 offset:16384
    v_mfma_f32_16x16x32_bf16 a[112:115], a[236:239], v[160:163], 0
    ds_read_b64_tr_b16 a[236:237], v204 offset:16896
    ds_read_b64_tr_b16 a[238:239], v208 offset:16896
    v_mfma_f32_16x16x32_bf16 a[112:115], a[232:235], v[124:127], a[112:115]
    ds_read_b64_tr_b16 a[232:233], v196 offset:16896
    ds_read_b64_tr_b16 a[234:235], v200 offset:16896
    v_mfma_f32_16x16x32_bf16 a[180:183], v[244:247], v[124:127], 0
    v_exp_f32 v115, v115
    v_mfma_f32_16x16x32_bf16 a[180:183], v[244:247], v[160:163], a[180:183]
    v_exp_f32 v120, v120
    v_cvt_pk_bf16_f32 v113, v114, v115
    v_mfma_f32_16x16x32_bf16 a[100:103], a[240:243], v[124:127], 0
    ds_read_b64_tr_b16 a[240:241], v197 offset:16384
    v_exp_f32 v121, v121
    v_mfma_f32_16x16x32_bf16 a[100:103], a[244:247], v[160:163], a[100:103]
    ds_read_b64_tr_b16 a[242:243], v201 offset:16384
    ds_read_b64_tr_b16 a[244:245], v205 offset:16384
    v_cvt_pk_bf16_f32 v120, v120, v121
    v_mfma_f32_16x16x32_bf16 a[116:119], a[252:255], v[160:163], 0
    ds_read_b64_tr_b16 a[246:247], v209 offset:16384
    v_exp_f32 v176, v176
    v_mfma_f32_16x16x32_bf16 a[116:119], a[248:251], v[124:127], a[116:119]
    buffer_load_dwordx4 v212, s[8:11], s21 offen offset:2048 nt lds
    ds_read_b64_tr_b16 a[252:253], v205 offset:16896
    ds_read_b64_tr_b16 a[254:255], v209 offset:16896
    v_add_f32 v185, v185, v176
    s_waitcnt lgkmcnt(6)
    v_mfma_f32_16x16x32_bf16 v[140:143], a[208:211], v[0:3], 0
    v_exp_f32 v177, v177
    v_mfma_f32_16x16x32_bf16 v[140:143], a[212:215], v[4:7], v[140:143]
    ds_read_b64_tr_b16 a[248:249], v197 offset:16896
    ds_read_b64_tr_b16 a[250:251], v201 offset:16896
    v_add_f32 v185, v185, v177
    v_mfma_f32_16x16x32_bf16 v[140:143], a[216:219], v[8:11], v[140:143]
    v_exp_f32 v178, v178
    v_cvt_pk_bf16_f32 v176, v176, v177
    v_mfma_f32_16x16x32_bf16 v[140:143], a[220:223], v[12:15], v[140:143]
    v_exp_f32 v179, v179
    v_add_f32 v185, v185, v178
    v_mfma_f32_16x16x32_bf16 v[148:151], a[220:223], v[28:31], 0
    v_exp_f32 v122, v122
    v_add_f32 v185, v185, v179
    v_mfma_f32_16x16x32_bf16 v[148:151], a[216:219], v[24:27], v[148:151]
    v_exp_f32 v123, v123
    v_cvt_pk_bf16_f32 v177, v178, v179
    v_mfma_f32_16x16x32_bf16 v[148:151], a[212:215], v[20:23], v[148:151]
    buffer_load_dwordx4 v213, s[8:11], s21 offen offset:3072 nt lds
    ds_write2st64_b64 v220, v[176:177], v[176:177] offset0:0 offset1:2
    v_exp_f32 v128, v128
    v_mfma_f32_16x16x32_bf16 v[148:151], a[208:211], v[16:19], v[148:151]
    v_exp_f32 v129, v129
    v_cvt_pk_bf16_f32 v121, v122, v123
    v_mfma_f32_16x16x32_bf16 v[156:159], a[208:211], v[32:35], 0
    v_exp_f32 v130, v130
    v_cvt_pk_bf16_f32 v128, v128, v129
    v_mfma_f32_16x16x32_bf16 v[156:159], a[212:215], v[36:39], v[156:159]
    v_exp_f32 v131, v131
    v_mfma_f32_16x16x32_bf16 v[156:159], a[216:219], v[40:43], v[156:159]
    v_cvt_pk_bf16_f32 v129, v130, v131
    v_mfma_f32_16x16x32_bf16 v[156:159], a[220:223], v[44:47], v[156:159]
    v_exp_f32 v140, v140
    v_mfma_f32_16x16x32_bf16 v[164:167], a[220:223], v[60:63], 0
    v_exp_f32 v141, v141
    v_add_f32 v180, v180, v140
    v_mfma_f32_16x16x32_bf16 v[164:167], a[216:219], v[56:59], v[164:167]
    v_exp_f32 v142, v142
    v_add_f32 v180, v180, v141
    s_mov_b32 s21, 65536
    s_add_u32 m0, s25, 0
    s_nop 0
    buffer_load_dwordx4 v214, s[12:15], s21 offen offset:0 nt lds
    v_mfma_f32_16x16x32_bf16 v[164:167], a[212:215], v[52:55], v[164:167]
    v_exp_f32 v143, v143
    v_add_f32 v180, v180, v142
    v_mfma_f32_16x16x32_bf16 v[164:167], a[208:211], v[48:51], v[164:167]
    v_exp_f32 v148, v148
    v_add_f32 v180, v180, v143
    v_mfma_f32_16x16x32_bf16 v[172:175], a[208:211], v[64:67], 0
    ds_read_b128 a[208:211], v192 offset:32768
    v_cvt_pk_bf16_f32 v98, v140, v141
    v_add_f32 v181, v181, v148
    v_mfma_f32_16x16x32_bf16 v[172:175], a[212:215], v[68:71], v[172:175]
    ds_read_b128 a[212:215], v193 offset:32768
    v_exp_f32 v149, v149
    v_mfma_f32_16x16x32_bf16 v[172:175], a[216:219], v[72:75], v[172:175]
    ds_read_b128 a[216:219], v192 offset:40960
    v_cvt_pk_bf16_f32 v99, v142, v143
    v_add_f32 v181, v181, v149
    v_mfma_f32_16x16x32_bf16 v[172:175], a[220:223], v[76:79], v[172:175]
    ds_read_b128 a[220:223], v193 offset:40960
    v_exp_f32 v150, v150
    v_mfma_f32_16x16x32_bf16 a[104:107], a[224:227], v[124:127], 0
    buffer_load_dwordx4 v215, s[12:15], s21 offen offset:1024 nt lds
    v_exp_f32 v151, v151
    v_add_f32 v181, v181, v150
    v_mfma_f32_16x16x32_bf16 a[104:107], a[228:231], v[160:163], a[104:107]
    v_exp_f32 v156, v156
    v_add_f32 v181, v181, v151
    v_mfma_f32_16x16x32_bf16 a[120:123], a[236:239], v[160:163], 0
    v_exp_f32 v157, v157
    v_cvt_pk_bf16_f32 v106, v148, v149
    v_mfma_f32_16x16x32_bf16 a[120:123], a[232:235], v[124:127], a[120:123]
    s_waitcnt lgkmcnt(0)
    v_exp_f32 v158, v158
    v_cvt_pk_bf16_f32 v107, v150, v151
    v_mfma_f32_16x16x32_bf16 a[108:111], a[240:243], v[124:127], 0
    v_exp_f32 v159, v159
    v_cvt_pk_bf16_f32 v114, v156, v157
    v_mfma_f32_16x16x32_bf16 a[108:111], a[244:247], v[160:163], a[108:111]
    v_exp_f32 v164, v164
    v_cvt_pk_bf16_f32 v115, v158, v159
    v_mfma_f32_16x16x32_bf16 a[124:127], a[252:255], v[160:163], 0
    v_exp_f32 v165, v165
    v_mfma_f32_16x16x32_bf16 a[124:127], a[248:251], v[124:127], a[124:127]
    buffer_load_dwordx4 v214, s[12:15], s21 offen offset:2048 nt lds
    v_cvt_pk_bf16_f32 v122, v164, v165
    s_waitcnt vmcnt(11)
    s_barrier
    v_mfma_f32_16x16x32_bf16 v[136:139], a[192:195], v[0:3], 0
    ds_read_b64_tr_b16 a[224:225], v194 offset:32768
    ds_read_b64_tr_b16 a[226:227], v198 offset:32768
    ds_read_b64_tr_b16 a[228:229], v202 offset:32768
    ds_read_b64_tr_b16 a[230:231], v206 offset:32768
    ds_read_b64_tr_b16 a[236:237], v202 offset:33280
    ds_read_b64_tr_b16 a[238:239], v206 offset:33280
    v_mfma_f32_16x16x32_bf16 v[136:139], a[196:199], v[4:7], v[136:139]
    ds_read_b64_tr_b16 a[232:233], v194 offset:33280
    ds_read_b64_tr_b16 a[234:235], v198 offset:33280
    v_mfma_f32_16x16x32_bf16 v[136:139], a[200:203], v[8:11], v[136:139]
    ds_read_b64_tr_b16 a[240:241], v195 offset:32768
    ds_read_b64_tr_b16 a[242:243], v199 offset:32768
    v_mfma_f32_16x16x32_bf16 v[136:139], a[204:207], v[12:15], v[136:139]
    ds_read_b64_tr_b16 a[244:245], v203 offset:32768
    v_exp_f32 v166, v166
    v_mfma_f32_16x16x32_bf16 v[144:147], a[204:207], v[28:31], 0
    ds_read_b64_tr_b16 a[246:247], v207 offset:32768
    v_exp_f32 v167, v167
    v_mfma_f32_16x16x32_bf16 v[144:147], a[200:203], v[24:27], v[144:147]
    buffer_load_dwordx4 v215, s[12:15], s21 offen offset:3072 nt lds
    ds_read_b64_tr_b16 a[252:253], v203 offset:33280
    ds_read_b64_tr_b16 a[254:255], v207 offset:33280
    v_cvt_pk_bf16_f32 v123, v166, v167
    v_mfma_f32_16x16x32_bf16 v[144:147], a[196:199], v[20:23], v[144:147]
    v_exp_f32 v172, v172
    v_mfma_f32_16x16x32_bf16 v[144:147], a[192:195], v[16:19], v[144:147]
    ds_read_b64_tr_b16 a[248:249], v195 offset:33280
    v_exp_f32 v173, v173
    v_mfma_f32_16x16x32_bf16 v[152:155], a[192:195], v[32:35], 0
    ds_read_b64_tr_b16 a[250:251], v199 offset:33280
    ds_read2st64_b64 a[168:171], v220 offset0:0 offset1:1
    v_cvt_pk_bf16_f32 v130, v172, v173
    v_mfma_f32_16x16x32_bf16 v[152:155], a[196:199], v[36:39], v[152:155]
    ds_read2st64_b64 a[172:175], v221 offset0:0 offset1:1
    v_exp_f32 v174, v174
    v_mfma_f32_16x16x32_bf16 v[152:155], a[200:203], v[40:43], v[152:155]
    v_exp_f32 v175, v175
    v_mfma_f32_16x16x32_bf16 v[152:155], a[204:207], v[44:47], v[152:155]
    v_exp_f32 v136, v136
    v_cvt_pk_bf16_f32 v131, v174, v175
    v_mfma_f32_16x16x32_bf16 v[160:163], a[204:207], v[60:63], 0
    s_mov_b32 s21, 81920
    s_add_u32 m0, s24, 16384
    s_nop 0
    buffer_load_dwordx4 v210, s[8:11], s21 offen offset:0 nt lds
    v_exp_f32 v137, v137
    v_add_f32 v180, v180, v136
    v_mfma_f32_16x16x32_bf16 v[160:163], a[200:203], v[56:59], v[160:163]
    v_exp_f32 v138, v138
    v_add_f32 v180, v180, v137
    v_mfma_f32_16x16x32_bf16 v[160:163], a[196:199], v[52:55], v[160:163]
    v_exp_f32 v139, v139
    v_add_f32 v180, v180, v138
    v_mfma_f32_16x16x32_bf16 v[160:163], a[192:195], v[48:51], v[160:163]
    v_exp_f32 v144, v144
    v_add_f32 v180, v180, v139
    v_mfma_f32_16x16x32_bf16 v[168:171], a[192:195], v[64:67], 0
    ds_read_b128 a[192:195], v186 offset:49152
    v_cvt_pk_bf16_f32 v136, v136, v137
    v_add_f32 v181, v181, v144
    v_mfma_f32_16x16x32_bf16 v[168:171], a[196:199], v[68:71], v[168:171]
    ds_read_b128 a[196:199], v187 offset:49152
    v_exp_f32 v145, v145
    v_mfma_f32_16x16x32_bf16 v[168:171], a[200:203], v[72:75], v[168:171]
    ds_read_b128 a[200:203], v186 offset:57344
    v_cvt_pk_bf16_f32 v137, v138, v139
    v_add_f32 v181, v181, v145
    buffer_load_dwordx4 v211, s[8:11], s21 offen offset:1024 nt lds
    v_mfma_f32_16x16x32_bf16 v[168:171], a[204:207], v[76:79], v[168:171]
    ds_read_b128 a[204:207], v187 offset:57344
    v_exp_f32 v146, v146
    v_mfma_f32_16x16x32_bf16 v[140:143], a[208:211], v[0:3], 0
    v_exp_f32 v147, v147
    v_add_f32 v181, v181, v146
    v_mfma_f32_16x16x32_bf16 v[140:143], a[212:215], v[4:7], v[140:143]
    v_exp_f32 v152, v152
    v_add_f32 v181, v181, v147
    v_mfma_f32_16x16x32_bf16 v[140:143], a[216:219], v[8:11], v[140:143]
    v_exp_f32 v153, v153
    v_cvt_pk_bf16_f32 v144, v144, v145
    v_mfma_f32_16x16x32_bf16 v[140:143], a[220:223], v[12:15], v[140:143]
    v_cvt_pk_bf16_f32 v145, v146, v147
    v_mfma_f32_16x16x32_bf16 v[148:151], a[220:223], v[28:31], 0
    v_mfma_f32_16x16x32_bf16 v[148:151], a[216:219], v[24:27], v[148:151]
    v_mfma_f32_16x16x32_bf16 v[148:151], a[212:215], v[20:23], v[148:151]
    buffer_load_dwordx4 v212, s[8:11], s21 offen offset:2048 nt lds
    v_mfma_f32_16x16x32_bf16 v[148:151], a[208:211], v[16:19], v[148:151]
    v_mfma_f32_16x16x32_bf16 v[156:159], a[208:211], v[32:35], 0
    v_mfma_f32_16x16x32_bf16 v[156:159], a[212:215], v[36:39], v[156:159]
    v_mfma_f32_16x16x32_bf16 v[156:159], a[216:219], v[40:43], v[156:159]
    v_mfma_f32_16x16x32_bf16 v[156:159], a[220:223], v[44:47], v[156:159]
    v_exp_f32 v140, v140
    v_mfma_f32_16x16x32_bf16 v[164:167], a[220:223], v[60:63], 0
    v_exp_f32 v141, v141
    v_add_f32 v180, v180, v140
    v_mfma_f32_16x16x32_bf16 v[164:167], a[216:219], v[56:59], v[164:167]
    v_exp_f32 v142, v142
    v_add_f32 v180, v180, v141
    v_mfma_f32_16x16x32_bf16 v[164:167], a[212:215], v[52:55], v[164:167]
    v_exp_f32 v143, v143
    v_add_f32 v180, v180, v142
    buffer_load_dwordx4 v213, s[8:11], s21 offen offset:3072 nt lds
    v_mfma_f32_16x16x32_bf16 v[164:167], a[208:211], v[48:51], v[164:167]
    v_exp_f32 v148, v148
    v_add_f32 v180, v180, v143
    v_mfma_f32_16x16x32_bf16 v[172:175], a[208:211], v[64:67], 0
    v_cvt_pk_bf16_f32 v138, v140, v141
    v_mfma_f32_16x16x32_bf16 v[172:175], a[212:215], v[68:71], v[172:175]
    v_cvt_pk_bf16_f32 v139, v142, v143
    v_mfma_f32_16x16x32_bf16 v[172:175], a[216:219], v[72:75], v[172:175]
    v_mfma_f32_16x16x32_bf16 v[172:175], a[220:223], v[76:79], v[172:175]
    s_mov_b32 s21, 81920
    s_add_u32 m0, s25, 16384
    s_nop 0
    buffer_load_dwordx4 v214, s[12:15], s21 offen offset:0 nt lds
    buffer_load_dwordx4 v215, s[12:15], s21 offen offset:1024 nt lds
    buffer_load_dwordx4 v214, s[12:15], s21 offen offset:2048 nt lds
    buffer_load_dwordx4 v215, s[12:15], s21 offen offset:3072 nt lds
    s_mov_b32 s21, 98304
    s_mov_b32 s23, 3
    s_waitcnt lgkmcnt(0)
.p2align 6
L_loop:
    s_waitcnt lgkmcnt(0)
    v_mfma_f32_16x16x32_bf16 v[100:103], a[192:195], v[0:3], 0
    v_exp_f32 v149, v149
    v_mfma_f32_16x16x32_bf16 v[100:103], a[196:199], v[4:7], v[100:103]
    v_exp_f32 v150, v150
    v_mfma_f32_16x16x32_bf16 v[100:103], a[200:203], v[8:11], v[100:103]
    v_exp_f32 v151, v151
    v_mfma_f32_16x16x32_bf16 v[100:103], a[204:207], v[12:15], v[100:103]
    v_exp_f32 v154, v154
    v_mfma_f32_16x16x32_bf16 v[108:111], a[204:207], v[28:31], 0
    v_exp_f32 v155, v155
    v_mfma_f32_16x16x32_bf16 v[108:111], a[200:203], v[24:27], v[108:111]
    v_add_f32 v181, v181, v148
    v_add_f32 v181, v181, v149
    v_mfma_f32_16x16x32_bf16 v[108:111], a[196:199], v[20:23], v[108:111]
    v_add_f32 v181, v181, v150
    v_add_f32 v181, v181, v151
    v_mfma_f32_16x16x32_bf16 v[108:111], a[192:195], v[16:19], v[108:111]
    v_cvt_pk_bf16_f32 v146, v148, v149
    v_cvt_pk_bf16_f32 v152, v152, v153
    v_mfma_f32_16x16x32_bf16 v[116:119], a[192:195], v[32:35], 0
    v_cvt_pk_bf16_f32 v147, v150, v151
    v_cvt_pk_bf16_f32 v153, v154, v155
    v_mfma_f32_16x16x32_bf16 v[116:119], a[196:199], v[36:39], v[116:119]
    v_exp_f32 v156, v156
    v_mfma_f32_16x16x32_bf16 v[116:119], a[200:203], v[40:43], v[116:119]
    v_exp_f32 v157, v157
    v_mfma_f32_16x16x32_bf16 v[116:119], a[204:207], v[44:47], v[116:119]
    v_exp_f32 v158, v158
    v_mfma_f32_16x16x32_bf16 v[124:127], a[204:207], v[60:63], 0
    v_exp_f32 v159, v159
    v_mfma_f32_16x16x32_bf16 v[124:127], a[200:203], v[56:59], v[124:127]
    v_exp_f32 v160, v160
    v_mfma_f32_16x16x32_bf16 v[124:127], a[196:199], v[52:55], v[124:127]
    v_exp_f32 v161, v161
    v_mfma_f32_16x16x32_bf16 v[124:127], a[192:195], v[48:51], v[124:127]
    v_cvt_pk_bf16_f32 v154, v156, v157
    v_cvt_pk_bf16_f32 v160, v160, v161
    v_mfma_f32_16x16x32_bf16 v[132:135], a[192:195], v[64:67], 0
    v_exp_f32 v162, v162
    v_mfma_f32_16x16x32_bf16 v[132:135], a[196:199], v[68:71], v[132:135]
    v_exp_f32 v163, v163
    v_mfma_f32_16x16x32_bf16 v[132:135], a[200:203], v[72:75], v[132:135]
    v_cvt_pk_bf16_f32 v155, v158, v159
    v_cvt_pk_bf16_f32 v161, v162, v163
    v_mfma_f32_16x16x32_bf16 v[132:135], a[204:207], v[76:79], v[132:135]
    v_exp_f32 v164, v164
    v_mfma_f32_16x16x32_bf16 v[176:179], a[204:207], v[92:95], 0
    v_exp_f32 v165, v165
    v_mfma_f32_16x16x32_bf16 v[176:179], a[200:203], v[88:91], v[176:179]
    v_exp_f32 v166, v166
    v_mfma_f32_16x16x32_bf16 v[176:179], a[196:199], v[84:87], v[176:179]
    v_exp_f32 v167, v167
    v_mfma_f32_16x16x32_bf16 v[176:179], a[192:195], v[80:83], v[176:179]
    ds_read_b128 a[208:211], v188 offset:49152
    v_cvt_pk_bf16_f32 v162, v164, v165
    v_mfma_f32_16x16x32_bf16 a[160:163], a[224:227], a[168:171], a[160:163]
    v_exp_f32 v168, v168
    v_mfma_f32_16x16x32_bf16 a[160:163], a[228:231], a[172:175], a[160:163]
    v_exp_f32 v169, v169
    v_mfma_f32_16x16x32_bf16 a[164:167], a[236:239], a[172:175], a[164:167]
    v_exp_f32 v170, v170
    v_mfma_f32_16x16x32_bf16 a[164:167], a[232:235], a[168:171], a[164:167]
    v_exp_f32 v171, v171
    v_mfma_f32_16x16x32_bf16 a[16:19], a[232:235], v[96:99], a[16:19]
    v_cvt_pk_bf16_f32 v163, v166, v167
    v_cvt_pk_bf16_f32 v168, v168, v169
    v_mfma_f32_16x16x32_bf16 a[16:19], a[236:239], v[136:139], a[16:19]
    v_exp_f32 v172, v172
    v_mfma_f32_16x16x32_bf16 a[0:3], a[228:231], v[136:139], a[0:3]
    v_exp_f32 v173, v173
    v_mfma_f32_16x16x32_bf16 a[0:3], a[224:227], v[96:99], a[0:3]
    v_exp_f32 v174, v174
    v_mfma_f32_16x16x32_bf16 a[32:35], a[224:227], v[104:107], a[32:35]
    v_exp_f32 v175, v175
    v_mfma_f32_16x16x32_bf16 a[32:35], a[228:231], v[144:147], a[32:35]
    ds_read_b128 a[212:215], v189 offset:49152
    v_cvt_pk_bf16_f32 v169, v170, v171
    v_mfma_f32_16x16x32_bf16 a[48:51], a[236:239], v[144:147], a[48:51]
    ds_read_b128 a[216:219], v188 offset:57344
    v_cvt_pk_bf16_f32 v170, v172, v173
    v_mfma_f32_16x16x32_bf16 a[48:51], a[232:235], v[104:107], a[48:51]
    ds_read_b128 a[220:223], v189 offset:57344
    v_cvt_pk_bf16_f32 v171, v174, v175
    v_mfma_f32_16x16x32_bf16 a[80:83], a[232:235], v[112:115], a[80:83]
    v_exp_f32 v176, v176
    v_mfma_f32_16x16x32_bf16 a[80:83], a[236:239], v[152:155], a[80:83]
    v_exp_f32 v177, v177
    v_mfma_f32_16x16x32_bf16 a[64:67], a[228:231], v[152:155], a[64:67]
    v_exp_f32 v178, v178
    v_mfma_f32_16x16x32_bf16 a[64:67], a[224:227], v[112:115], a[64:67]
    v_exp_f32 v179, v179
    v_mfma_f32_16x16x32_bf16 a[176:179], v[244:247], v[112:115], a[176:179]
    v_add_f32 v185, v185, v176
    v_add_f32 v185, v185, v177
    v_mfma_f32_16x16x32_bf16 a[176:179], v[244:247], v[152:155], a[176:179]
    v_add_f32 v185, v185, v178
    v_add_f32 v185, v185, v179
    v_mfma_f32_16x16x32_bf16 a[96:99], a[224:227], v[120:123], a[96:99]
    v_exp_f32 v100, v100
    v_mfma_f32_16x16x32_bf16 a[96:99], a[228:231], v[160:163], a[96:99]
    v_cvt_pk_bf16_f32 v176, v176, v177
    v_add_f32 v180, v180, v100
    v_mfma_f32_16x16x32_bf16 a[112:115], a[236:239], v[160:163], a[112:115]
    v_exp_f32 v101, v101
    v_mfma_f32_16x16x32_bf16 a[112:115], a[232:235], v[120:123], a[112:115]
    v_cvt_pk_bf16_f32 v177, v178, v179
    v_add_f32 v180, v180, v101
    v_mfma_f32_16x16x32_bf16 a[180:183], v[244:247], v[120:123], a[180:183]
    v_exp_f32 v102, v102
    v_mfma_f32_16x16x32_bf16 a[180:183], v[244:247], v[160:163], a[180:183]
    v_exp_f32 v103, v103
    v_mfma_f32_16x16x32_bf16 a[144:147], a[232:235], v[128:131], a[144:147]
    ds_read_b64_tr_b16 a[232:233], v196 offset:33280
    v_add_f32 v180, v180, v102
    v_mfma_f32_16x16x32_bf16 a[144:147], a[236:239], v[168:171], a[144:147]
    ds_read_b64_tr_b16 a[236:237], v204 offset:33280
    v_add_f32 v180, v180, v103
    v_mfma_f32_16x16x32_bf16 a[128:131], a[228:231], v[168:171], a[128:131]
    ds_read_b64_tr_b16 a[228:229], v204 offset:32768
    v_cvt_pk_bf16_f32 v100, v100, v101
    v_mfma_f32_16x16x32_bf16 a[128:131], a[224:227], v[128:131], a[128:131]
    ds_read_b64_tr_b16 a[224:225], v196 offset:32768
    v_cvt_pk_bf16_f32 v101, v102, v103
    v_mfma_f32_16x16x32_bf16 a[184:187], v[244:247], v[128:131], a[184:187]
    v_exp_f32 v108, v108
    v_mfma_f32_16x16x32_bf16 a[184:187], v[244:247], v[168:171], a[184:187]
    ds_read_b64_tr_b16 a[226:227], v200 offset:32768
    v_add_f32 v181, v181, v108
    v_mfma_f32_16x16x32_bf16 a[132:135], a[240:243], v[128:131], a[132:135]
    v_exp_f32 v109, v109
    v_mfma_f32_16x16x32_bf16 a[132:135], a[244:247], v[168:171], a[132:135]
    ds_read_b64_tr_b16 a[230:231], v208 offset:32768
    v_add_f32 v181, v181, v109
    v_mfma_f32_16x16x32_bf16 a[148:151], a[252:255], v[168:171], a[148:151]
    ds_read_b64_tr_b16 a[238:239], v208 offset:33280
    v_cvt_pk_bf16_f32 v108, v108, v109
    v_mfma_f32_16x16x32_bf16 a[148:151], a[248:251], v[128:131], a[148:151]
    v_exp_f32 v110, v110
    v_mfma_f32_16x16x32_bf16 a[116:119], a[248:251], v[120:123], a[116:119]
    ds_read_b64_tr_b16 a[234:235], v200 offset:33280
    v_add_f32 v181, v181, v110
    v_mfma_f32_16x16x32_bf16 a[116:119], a[252:255], v[160:163], a[116:119]
    v_exp_f32 v111, v111
    v_mfma_f32_16x16x32_bf16 a[100:103], a[244:247], v[160:163], a[100:103]
    ds_read_b128 a[192:195], v190 offset:49152
    v_add_f32 v181, v181, v111
    v_mfma_f32_16x16x32_bf16 a[100:103], a[240:243], v[120:123], a[100:103]
    ds_read_b128 a[196:199], v191 offset:49152
    v_cvt_pk_bf16_f32 v109, v110, v111
    v_mfma_f32_16x16x32_bf16 a[68:71], a[240:243], v[112:115], a[68:71]
    v_exp_f32 v116, v116
    v_mfma_f32_16x16x32_bf16 a[68:71], a[244:247], v[152:155], a[68:71]
    v_exp_f32 v117, v117
    v_mfma_f32_16x16x32_bf16 a[84:87], a[252:255], v[152:155], a[84:87]
    ds_read_b128 a[200:203], v190 offset:57344
    v_cvt_pk_bf16_f32 v116, v116, v117
    v_mfma_f32_16x16x32_bf16 a[84:87], a[248:251], v[112:115], a[84:87]
    v_exp_f32 v118, v118
    v_mfma_f32_16x16x32_bf16 a[52:55], a[248:251], v[104:107], a[52:55]
    v_exp_f32 v119, v119
    v_mfma_f32_16x16x32_bf16 a[52:55], a[252:255], v[144:147], a[52:55]
    ds_read_b128 a[204:207], v191 offset:57344
    v_cvt_pk_bf16_f32 v117, v118, v119
    v_mfma_f32_16x16x32_bf16 a[36:39], a[244:247], v[144:147], a[36:39]
    v_exp_f32 v124, v124
    v_mfma_f32_16x16x32_bf16 a[36:39], a[240:243], v[104:107], a[36:39]
    v_exp_f32 v125, v125
    v_mfma_f32_16x16x32_bf16 a[4:7], a[240:243], v[96:99], a[4:7]
    ds_read_b64_tr_b16 a[240:241], v197 offset:32768
    v_cvt_pk_bf16_f32 v124, v124, v125
    v_mfma_f32_16x16x32_bf16 a[4:7], a[244:247], v[136:139], a[4:7]
    v_exp_f32 v126, v126
    v_mfma_f32_16x16x32_bf16 a[20:23], a[252:255], v[136:139], a[20:23]
    v_exp_f32 v127, v127
    v_mfma_f32_16x16x32_bf16 a[20:23], a[248:251], v[96:99], a[20:23]
    s_waitcnt lgkmcnt(5)
    ds_read_b64_tr_b16 a[242:243], v201 offset:32768
    v_cvt_pk_bf16_f32 v125, v126, v127
    v_mfma_f32_16x16x32_bf16 v[140:143], a[208:211], v[0:3], 0
    v_exp_f32 v132, v132
    v_mfma_f32_16x16x32_bf16 v[140:143], a[212:215], v[4:7], v[140:143]
    v_exp_f32 v133, v133
    v_mfma_f32_16x16x32_bf16 v[140:143], a[216:219], v[8:11], v[140:143]
    ds_read_b64_tr_b16 a[244:245], v205 offset:32768
    v_cvt_pk_bf16_f32 v132, v132, v133
    v_mfma_f32_16x16x32_bf16 v[140:143], a[220:223], v[12:15], v[140:143]
    v_exp_f32 v134, v134
    v_mfma_f32_16x16x32_bf16 v[148:151], a[220:223], v[28:31], 0
    v_exp_f32 v135, v135
    v_mfma_f32_16x16x32_bf16 v[148:151], a[216:219], v[24:27], v[148:151]
    ds_read_b64_tr_b16 a[246:247], v209 offset:32768
    v_cvt_pk_bf16_f32 v133, v134, v135
    v_mfma_f32_16x16x32_bf16 v[148:151], a[212:215], v[20:23], v[148:151]
    ds_read_b64_tr_b16 a[252:253], v205 offset:33280
    v_mfma_f32_16x16x32_bf16 v[148:151], a[208:211], v[16:19], v[148:151]
    ds_read_b64_tr_b16 a[254:255], v209 offset:33280
    v_mfma_f32_16x16x32_bf16 v[156:159], a[208:211], v[32:35], 0
    ds_read_b64_tr_b16 a[248:249], v197 offset:33280
    v_mfma_f32_16x16x32_bf16 v[156:159], a[212:215], v[36:39], v[156:159]
    ds_read_b64_tr_b16 a[250:251], v201 offset:33280
    v_mfma_f32_16x16x32_bf16 v[156:159], a[216:219], v[40:43], v[156:159]
    ds_write2st64_b64 v220, v[176:177], v[176:177] offset0:8 offset1:10
    v_mfma_f32_16x16x32_bf16 v[156:159], a[220:223], v[44:47], v[156:159]
    v_exp_f32 v140, v140
    v_mfma_f32_16x16x32_bf16 v[164:167], a[220:223], v[60:63], 0
    v_exp_f32 v141, v141
    v_mfma_f32_16x16x32_bf16 v[164:167], a[216:219], v[56:59], v[164:167]
    v_exp_f32 v142, v142
    v_mfma_f32_16x16x32_bf16 v[164:167], a[212:215], v[52:55], v[164:167]
    v_exp_f32 v143, v143
    v_mfma_f32_16x16x32_bf16 v[164:167], a[208:211], v[48:51], v[164:167]
    v_add_f32 v180, v180, v140
    v_add_f32 v180, v180, v141
    v_mfma_f32_16x16x32_bf16 v[172:175], a[208:211], v[64:67], 0
    ds_read_b128 a[208:211], v192 offset:49152
    v_add_f32 v180, v180, v142
    v_mfma_f32_16x16x32_bf16 v[172:175], a[212:215], v[68:71], v[172:175]
    ds_read_b128 a[212:215], v193 offset:49152
    v_add_f32 v180, v180, v143
    v_mfma_f32_16x16x32_bf16 v[172:175], a[216:219], v[72:75], v[172:175]
    ds_read_b128 a[216:219], v192 offset:57344
    v_cvt_pk_bf16_f32 v102, v140, v141
    v_mfma_f32_16x16x32_bf16 v[172:175], a[220:223], v[76:79], v[172:175]
    ds_read_b128 a[220:223], v193 offset:57344
    v_cvt_pk_bf16_f32 v103, v142, v143
    v_mfma_f32_16x16x32_bf16 a[8:11], a[224:227], v[96:99], a[8:11]
    v_exp_f32 v148, v148
    v_mfma_f32_16x16x32_bf16 a[8:11], a[228:231], v[136:139], a[8:11]
    v_exp_f32 v149, v149
    v_mfma_f32_16x16x32_bf16 a[24:27], a[236:239], v[136:139], a[24:27]
    v_exp_f32 v150, v150
    v_mfma_f32_16x16x32_bf16 a[24:27], a[232:235], v[96:99], a[24:27]
    v_exp_f32 v151, v151
    v_mfma_f32_16x16x32_bf16 a[56:59], a[232:235], v[104:107], a[56:59]
    v_add_f32 v181, v181, v148
    v_add_f32 v181, v181, v149
    v_mfma_f32_16x16x32_bf16 a[56:59], a[236:239], v[144:147], a[56:59]
    v_add_f32 v181, v181, v150
    v_add_f32 v181, v181, v151
    v_mfma_f32_16x16x32_bf16 a[40:43], a[228:231], v[144:147], a[40:43]
    v_exp_f32 v156, v156
    v_mfma_f32_16x16x32_bf16 a[40:43], a[224:227], v[104:107], a[40:43]
    v_exp_f32 v157, v157
    v_mfma_f32_16x16x32_bf16 a[72:75], a[224:227], v[112:115], a[72:75]
    v_cvt_pk_bf16_f32 v110, v148, v149
    v_cvt_pk_bf16_f32 v118, v156, v157
    v_mfma_f32_16x16x32_bf16 a[72:75], a[228:231], v[152:155], a[72:75]
    v_exp_f32 v158, v158
    v_mfma_f32_16x16x32_bf16 a[88:91], a[236:239], v[152:155], a[88:91]
    v_exp_f32 v159, v159
    v_mfma_f32_16x16x32_bf16 a[88:91], a[232:235], v[112:115], a[88:91]
    v_cvt_pk_bf16_f32 v111, v150, v151
    v_cvt_pk_bf16_f32 v119, v158, v159
    v_mfma_f32_16x16x32_bf16 a[120:123], a[232:235], v[120:123], a[120:123]
    v_exp_f32 v164, v164
    v_mfma_f32_16x16x32_bf16 a[120:123], a[236:239], v[160:163], a[120:123]
    v_exp_f32 v165, v165
    v_mfma_f32_16x16x32_bf16 a[104:107], a[228:231], v[160:163], a[104:107]
    v_exp_f32 v166, v166
    v_mfma_f32_16x16x32_bf16 a[104:107], a[224:227], v[120:123], a[104:107]
    v_exp_f32 v167, v167
    v_mfma_f32_16x16x32_bf16 a[136:139], a[224:227], v[128:131], a[136:139]
    v_exp_f32 v172, v172
    v_mfma_f32_16x16x32_bf16 a[136:139], a[228:231], v[168:171], a[136:139]
    v_exp_f32 v173, v173
    v_mfma_f32_16x16x32_bf16 a[152:155], a[236:239], v[168:171], a[152:155]
    v_cvt_pk_bf16_f32 v126, v164, v165
    v_cvt_pk_bf16_f32 v134, v172, v173
    v_mfma_f32_16x16x32_bf16 a[152:155], a[232:235], v[128:131], a[152:155]
    s_waitcnt vmcnt(8) lgkmcnt(0)
    s_barrier
    v_mfma_f32_16x16x32_bf16 a[140:143], a[240:243], v[128:131], a[140:143]
    s_add_u32 m0, s25, 32768
    ds_read_b64_tr_b16 a[224:225], v194 offset:49152
    v_cvt_pk_bf16_f32 v127, v166, v167
    v_mfma_f32_16x16x32_bf16 a[140:143], a[244:247], v[168:171], a[140:143]
    v_exp_f32 v174, v174
    v_mfma_f32_16x16x32_bf16 a[156:159], a[252:255], v[168:171], a[156:159]
    v_exp_f32 v175, v175
    v_mfma_f32_16x16x32_bf16 a[156:159], a[248:251], v[128:131], a[156:159]
    ds_read_b64_tr_b16 a[226:227], v198 offset:49152
    v_cvt_pk_bf16_f32 v135, v174, v175
    v_mfma_f32_16x16x32_bf16 a[124:127], a[248:251], v[120:123], a[124:127]
    ds_read_b64_tr_b16 a[228:229], v202 offset:49152
    v_mfma_f32_16x16x32_bf16 a[124:127], a[252:255], v[160:163], a[124:127]
    buffer_load_dwordx4 v214, s[12:15], s21 offen offset:0 nt lds
    v_mfma_f32_16x16x32_bf16 a[108:111], a[244:247], v[160:163], a[108:111]
    ds_read_b64_tr_b16 a[230:231], v206 offset:49152
    v_mfma_f32_16x16x32_bf16 a[108:111], a[240:243], v[120:123], a[108:111]
    ds_read_b64_tr_b16 a[236:237], v202 offset:49664
    v_mfma_f32_16x16x32_bf16 a[76:79], a[240:243], v[112:115], a[76:79]
    ds_read_b64_tr_b16 a[238:239], v206 offset:49664
    v_mfma_f32_16x16x32_bf16 a[76:79], a[244:247], v[152:155], a[76:79]
    ds_read_b64_tr_b16 a[232:233], v194 offset:49664
    v_mfma_f32_16x16x32_bf16 a[92:95], a[252:255], v[152:155], a[92:95]
    buffer_load_dwordx4 v215, s[12:15], s21 offen offset:1024 nt lds
    v_mfma_f32_16x16x32_bf16 a[92:95], a[248:251], v[112:115], a[92:95]
    ds_read_b64_tr_b16 a[234:235], v198 offset:49664
    v_mfma_f32_16x16x32_bf16 a[60:63], a[248:251], v[104:107], a[60:63]
    ds_read2st64_b64 a[168:171], v220 offset0:8 offset1:9
    v_mfma_f32_16x16x32_bf16 a[60:63], a[252:255], v[144:147], a[60:63]
    ds_read2st64_b64 a[172:175], v221 offset0:8 offset1:9
    v_mfma_f32_16x16x32_bf16 a[44:47], a[244:247], v[144:147], a[44:47]
    v_mfma_f32_16x16x32_bf16 a[44:47], a[240:243], v[104:107], a[44:47]
    buffer_load_dwordx4 v214, s[12:15], s21 offen offset:2048 nt lds
    v_mfma_f32_16x16x32_bf16 a[12:15], a[240:243], v[96:99], a[12:15]
    ds_read_b64_tr_b16 a[240:241], v195 offset:49152
    v_mfma_f32_16x16x32_bf16 a[12:15], a[244:247], v[136:139], a[12:15]
    ds_read_b64_tr_b16 a[242:243], v199 offset:49152
    v_mfma_f32_16x16x32_bf16 a[28:31], a[252:255], v[136:139], a[28:31]
    ds_read_b64_tr_b16 a[244:245], v203 offset:49152
    v_mfma_f32_16x16x32_bf16 a[28:31], a[248:251], v[96:99], a[28:31]
    ds_read_b64_tr_b16 a[246:247], v207 offset:49152
    v_mfma_f32_16x16x32_bf16 v[136:139], a[192:195], v[0:3], 0
    buffer_load_dwordx4 v215, s[12:15], s21 offen offset:3072 nt lds
    v_mfma_f32_16x16x32_bf16 v[136:139], a[196:199], v[4:7], v[136:139]
    ds_read_b64_tr_b16 a[252:253], v203 offset:49664
    v_mfma_f32_16x16x32_bf16 v[136:139], a[200:203], v[8:11], v[136:139]
    ds_read_b64_tr_b16 a[254:255], v207 offset:49664
    v_mfma_f32_16x16x32_bf16 v[136:139], a[204:207], v[12:15], v[136:139]
    ds_read_b64_tr_b16 a[248:249], v195 offset:49664
    v_mfma_f32_16x16x32_bf16 v[144:147], a[204:207], v[28:31], 0
    ds_read_b64_tr_b16 a[250:251], v199 offset:49664
    v_mfma_f32_16x16x32_bf16 v[144:147], a[200:203], v[24:27], v[144:147]
    s_add_u32 m0, s24, 32768
    v_mfma_f32_16x16x32_bf16 v[144:147], a[196:199], v[20:23], v[144:147]
    v_mfma_f32_16x16x32_bf16 v[144:147], a[192:195], v[16:19], v[144:147]
    v_mfma_f32_16x16x32_bf16 v[152:155], a[192:195], v[32:35], 0
    v_mfma_f32_16x16x32_bf16 v[152:155], a[196:199], v[36:39], v[152:155]
    v_mfma_f32_16x16x32_bf16 v[152:155], a[200:203], v[40:43], v[152:155]
    buffer_load_dwordx4 v210, s[8:11], s21 offen offset:0 nt lds
    v_mfma_f32_16x16x32_bf16 v[152:155], a[204:207], v[44:47], v[152:155]
    v_exp_f32 v136, v136
    v_mfma_f32_16x16x32_bf16 v[160:163], a[204:207], v[60:63], 0
    v_exp_f32 v137, v137
    v_mfma_f32_16x16x32_bf16 v[160:163], a[200:203], v[56:59], v[160:163]
    v_exp_f32 v138, v138
    v_mfma_f32_16x16x32_bf16 v[160:163], a[196:199], v[52:55], v[160:163]
    v_exp_f32 v139, v139
    v_mfma_f32_16x16x32_bf16 v[160:163], a[192:195], v[48:51], v[160:163]
    buffer_load_dwordx4 v211, s[8:11], s21 offen offset:1024 nt lds
    v_mfma_f32_16x16x32_bf16 v[168:171], a[192:195], v[64:67], 0
    ds_read_b128 a[192:195], v186 offset:0
    v_add_f32 v180, v180, v136
    v_mfma_f32_16x16x32_bf16 v[168:171], a[196:199], v[68:71], v[168:171]
    ds_read_b128 a[196:199], v187 offset:0
    v_add_f32 v180, v180, v137
    v_mfma_f32_16x16x32_bf16 v[168:171], a[200:203], v[72:75], v[168:171]
    ds_read_b128 a[200:203], v186 offset:8192
    v_add_f32 v180, v180, v138
    v_mfma_f32_16x16x32_bf16 v[168:171], a[204:207], v[76:79], v[168:171]
    ds_read_b128 a[204:207], v187 offset:8192
    v_add_f32 v180, v180, v139
    v_mfma_f32_16x16x32_bf16 v[140:143], a[208:211], v[0:3], 0
    buffer_load_dwordx4 v212, s[8:11], s21 offen offset:2048 nt lds
    v_mfma_f32_16x16x32_bf16 v[140:143], a[212:215], v[4:7], v[140:143]
    v_exp_f32 v144, v144
    v_mfma_f32_16x16x32_bf16 v[140:143], a[216:219], v[8:11], v[140:143]
    v_cvt_pk_bf16_f32 v136, v136, v137
    v_add_f32 v181, v181, v144
    v_mfma_f32_16x16x32_bf16 v[140:143], a[220:223], v[12:15], v[140:143]
    v_exp_f32 v145, v145
    v_mfma_f32_16x16x32_bf16 v[148:151], a[220:223], v[28:31], 0
    v_cvt_pk_bf16_f32 v137, v138, v139
    v_add_f32 v181, v181, v145
    v_mfma_f32_16x16x32_bf16 v[148:151], a[216:219], v[24:27], v[148:151]
    buffer_load_dwordx4 v213, s[8:11], s21 offen offset:3072 nt lds
    v_mfma_f32_16x16x32_bf16 v[148:151], a[212:215], v[20:23], v[148:151]
    v_exp_f32 v146, v146
    v_mfma_f32_16x16x32_bf16 v[148:151], a[208:211], v[16:19], v[148:151]
    v_exp_f32 v147, v147
    v_mfma_f32_16x16x32_bf16 v[156:159], a[208:211], v[32:35], 0
    v_add_f32 v181, v181, v146
    v_add_f32 v181, v181, v147
    v_mfma_f32_16x16x32_bf16 v[156:159], a[212:215], v[36:39], v[156:159]
    v_exp_f32 v152, v152
    v_mfma_f32_16x16x32_bf16 v[156:159], a[216:219], v[40:43], v[156:159]
    s_add_u32 s21, s21, 16384
    v_exp_f32 v153, v153
    v_mfma_f32_16x16x32_bf16 v[156:159], a[220:223], v[44:47], v[156:159]
    v_exp_f32 v140, v140
    v_mfma_f32_16x16x32_bf16 v[164:167], a[220:223], v[60:63], 0
    v_exp_f32 v141, v141
    v_mfma_f32_16x16x32_bf16 v[164:167], a[216:219], v[56:59], v[164:167]
    v_exp_f32 v142, v142
    v_mfma_f32_16x16x32_bf16 v[164:167], a[212:215], v[52:55], v[164:167]
    v_exp_f32 v143, v143
    v_mfma_f32_16x16x32_bf16 v[164:167], a[208:211], v[48:51], v[164:167]
    v_add_f32 v180, v180, v140
    v_add_f32 v180, v180, v141
    v_mfma_f32_16x16x32_bf16 v[172:175], a[208:211], v[64:67], 0
    v_add_f32 v180, v180, v142
    v_add_f32 v180, v180, v143
    v_mfma_f32_16x16x32_bf16 v[172:175], a[212:215], v[68:71], v[172:175]
    v_cvt_pk_bf16_f32 v138, v140, v141
    v_cvt_pk_bf16_f32 v144, v144, v145
    v_mfma_f32_16x16x32_bf16 v[172:175], a[216:219], v[72:75], v[172:175]
    v_cvt_pk_bf16_f32 v139, v142, v143
    v_cvt_pk_bf16_f32 v145, v146, v147
    v_mfma_f32_16x16x32_bf16 v[172:175], a[220:223], v[76:79], v[172:175]
    s_waitcnt lgkmcnt(0)
    v_exp_f32 v148, v148
L_blk0:
    v_mfma_f32_16x16x32_bf16 v[96:99], a[192:195], v[0:3], 0
    v_exp_f32 v149, v149
    v_mfma_f32_16x16x32_bf16 v[96:99], a[196:199], v[4:7], v[96:99]
    v_exp_f32 v150, v150
    v_mfma_f32_16x16x32_bf16 v[96:99], a[200:203], v[8:11], v[96:99]
    v_exp_f32 v151, v151
    v_mfma_f32_16x16x32_bf16 v[96:99], a[204:207], v[12:15], v[96:99]
    v_exp_f32 v154, v154
    v_mfma_f32_16x16x32_bf16 v[104:107], a[204:207], v[28:31], 0
    v_exp_f32 v155, v155
    v_mfma_f32_16x16x32_bf16 v[104:107], a[200:203], v[24:27], v[104:107]
    v_add_f32 v181, v181, v148
    v_add_f32 v181, v181, v149
    v_mfma_f32_16x16x32_bf16 v[104:107], a[196:199], v[20:23], v[104:107]
    v_add_f32 v181, v181, v150
    v_add_f32 v181, v181, v151
    v_mfma_f32_16x16x32_bf16 v[104:107], a[192:195], v[16:19], v[104:107]
    v_cvt_pk_bf16_f32 v146, v148, v149
    v_cvt_pk_bf16_f32 v152, v152, v153
    v_mfma_f32_16x16x32_bf16 v[112:115], a[192:195], v[32:35], 0
    v_cvt_pk_bf16_f32 v147, v150, v151
    v_cvt_pk_bf16_f32 v153, v154, v155
    v_mfma_f32_16x16x32_bf16 v[112:115], a[196:199], v[36:39], v[112:115]
    v_exp_f32 v156, v156
    v_mfma_f32_16x16x32_bf16 v[112:115], a[200:203], v[40:43], v[112:115]
    v_exp_f32 v157, v157
    v_mfma_f32_16x16x32_bf16 v[112:115], a[204:207], v[44:47], v[112:115]
    v_exp_f32 v158, v158
    v_mfma_f32_16x16x32_bf16 v[120:123], a[204:207], v[60:63], 0
    v_exp_f32 v159, v159
    v_mfma_f32_16x16x32_bf16 v[120:123], a[200:203], v[56:59], v[120:123]
    v_exp_f32 v160, v160
    v_mfma_f32_16x16x32_bf16 v[120:123], a[196:199], v[52:55], v[120:123]
    v_exp_f32 v161, v161
    v_mfma_f32_16x16x32_bf16 v[120:123], a[192:195], v[48:51], v[120:123]
    v_cvt_pk_bf16_f32 v154, v156, v157
    v_cvt_pk_bf16_f32 v160, v160, v161
    v_mfma_f32_16x16x32_bf16 v[128:131], a[192:195], v[64:67], 0
    v_exp_f32 v162, v162
    v_mfma_f32_16x16x32_bf16 v[128:131], a[196:199], v[68:71], v[128:131]
    v_exp_f32 v163, v163
    v_mfma_f32_16x16x32_bf16 v[128:131], a[200:203], v[72:75], v[128:131]
    v_cvt_pk_bf16_f32 v155, v158, v159
    v_cvt_pk_bf16_f32 v161, v162, v163
    v_mfma_f32_16x16x32_bf16 v[128:131], a[204:207], v[76:79], v[128:131]
    v_exp_f32 v164, v164
    v_mfma_f32_16x16x32_bf16 v[176:179], a[204:207], v[92:95], 0
    v_exp_f32 v165, v165
    v_mfma_f32_16x16x32_bf16 v[176:179], a[200:203], v[88:91], v[176:179]
    v_exp_f32 v166, v166
    v_mfma_f32_16x16x32_bf16 v[176:179], a[196:199], v[84:87], v[176:179]
    v_exp_f32 v167, v167
    v_mfma_f32_16x16x32_bf16 v[176:179], a[192:195], v[80:83], v[176:179]
    ds_read_b128 a[208:211], v188 offset:0
    v_cvt_pk_bf16_f32 v162, v164, v165
    v_mfma_f32_16x16x32_bf16 a[160:163], a[224:227], a[168:171], a[160:163]
    v_exp_f32 v168, v168
    v_mfma_f32_16x16x32_bf16 a[160:163], a[228:231], a[172:175], a[160:163]
    v_exp_f32 v169, v169
    v_mfma_f32_16x16x32_bf16 a[164:167], a[236:239], a[172:175], a[164:167]
    v_exp_f32 v170, v170
    v_mfma_f32_16x16x32_bf16 a[164:167], a[232:235], a[168:171], a[164:167]
    v_exp_f32 v171, v171
    v_mfma_f32_16x16x32_bf16 a[16:19], a[232:235], v[100:103], a[16:19]
    v_cvt_pk_bf16_f32 v163, v166, v167
    v_cvt_pk_bf16_f32 v168, v168, v169
    v_mfma_f32_16x16x32_bf16 a[16:19], a[236:239], v[136:139], a[16:19]
    v_exp_f32 v172, v172
    v_mfma_f32_16x16x32_bf16 a[0:3], a[228:231], v[136:139], a[0:3]
    v_exp_f32 v173, v173
    v_mfma_f32_16x16x32_bf16 a[0:3], a[224:227], v[100:103], a[0:3]
    v_exp_f32 v174, v174
    v_mfma_f32_16x16x32_bf16 a[32:35], a[224:227], v[108:111], a[32:35]
    v_exp_f32 v175, v175
    v_mfma_f32_16x16x32_bf16 a[32:35], a[228:231], v[144:147], a[32:35]
    ds_read_b128 a[212:215], v189 offset:0
    v_cvt_pk_bf16_f32 v169, v170, v171
    v_mfma_f32_16x16x32_bf16 a[48:51], a[236:239], v[144:147], a[48:51]
    ds_read_b128 a[216:219], v188 offset:8192
    v_cvt_pk_bf16_f32 v170, v172, v173
    v_mfma_f32_16x16x32_bf16 a[48:51], a[232:235], v[108:111], a[48:51]
    ds_read_b128 a[220:223], v189 offset:8192
    v_cvt_pk_bf16_f32 v171, v174, v175
    v_mfma_f32_16x16x32_bf16 a[80:83], a[232:235], v[116:119], a[80:83]
    v_exp_f32 v176, v176
    v_mfma_f32_16x16x32_bf16 a[80:83], a[236:239], v[152:155], a[80:83]
    v_exp_f32 v177, v177
    v_mfma_f32_16x16x32_bf16 a[64:67], a[228:231], v[152:155], a[64:67]
    v_exp_f32 v178, v178
    v_mfma_f32_16x16x32_bf16 a[64:67], a[224:227], v[116:119], a[64:67]
    v_exp_f32 v179, v179
    v_mfma_f32_16x16x32_bf16 a[176:179], v[244:247], v[116:119], a[176:179]
    v_add_f32 v185, v185, v176
    v_add_f32 v185, v185, v177
    v_mfma_f32_16x16x32_bf16 a[176:179], v[244:247], v[152:155], a[176:179]
    v_add_f32 v185, v185, v178
    v_add_f32 v185, v185, v179
    v_mfma_f32_16x16x32_bf16 a[96:99], a[224:227], v[124:127], a[96:99]
    v_exp_f32 v96, v96
    v_mfma_f32_16x16x32_bf16 a[96:99], a[228:231], v[160:163], a[96:99]
    v_cvt_pk_bf16_f32 v176, v176, v177
    v_add_f32 v180, v180, v96
    v_mfma_f32_16x16x32_bf16 a[112:115], a[236:239], v[160:163], a[112:115]
    v_exp_f32 v97, v97
    v_mfma_f32_16x16x32_bf16 a[112:115], a[232:235], v[124:127], a[112:115]
    v_cvt_pk_bf16_f32 v177, v178, v179
    v_add_f32 v180, v180, v97
    v_mfma_f32_16x16x32_bf16 a[180:183], v[244:247], v[124:127], a[180:183]
    v_exp_f32 v98, v98
    v_mfma_f32_16x16x32_bf16 a[180:183], v[244:247], v[160:163], a[180:183]
    v_exp_f32 v99, v99
    v_mfma_f32_16x16x32_bf16 a[144:147], a[232:235], v[132:135], a[144:147]
    ds_read_b64_tr_b16 a[232:233], v196 offset:49664
    v_add_f32 v180, v180, v98
    v_mfma_f32_16x16x32_bf16 a[144:147], a[236:239], v[168:171], a[144:147]
    ds_read_b64_tr_b16 a[236:237], v204 offset:49664
    v_add_f32 v180, v180, v99
    v_mfma_f32_16x16x32_bf16 a[128:131], a[228:231], v[168:171], a[128:131]
    ds_read_b64_tr_b16 a[228:229], v204 offset:49152
    v_cvt_pk_bf16_f32 v96, v96, v97
    v_mfma_f32_16x16x32_bf16 a[128:131], a[224:227], v[132:135], a[128:131]
    ds_read_b64_tr_b16 a[224:225], v196 offset:49152
    v_cvt_pk_bf16_f32 v97, v98, v99
    v_mfma_f32_16x16x32_bf16 a[184:187], v[244:247], v[132:135], a[184:187]
    v_exp_f32 v104, v104
    v_mfma_f32_16x16x32_bf16 a[184:187], v[244:247], v[168:171], a[184:187]
    ds_read_b64_tr_b16 a[226:227], v200 offset:49152
    v_add_f32 v181, v181, v104
    v_mfma_f32_16x16x32_bf16 a[132:135], a[240:243], v[132:135], a[132:135]
    v_exp_f32 v105, v105
    v_mfma_f32_16x16x32_bf16 a[132:135], a[244:247], v[168:171], a[132:135]
    ds_read_b64_tr_b16 a[230:231], v208 offset:49152
    v_add_f32 v181, v181, v105
    v_mfma_f32_16x16x32_bf16 a[148:151], a[252:255], v[168:171], a[148:151]
    ds_read_b64_tr_b16 a[238:239], v208 offset:49664
    v_cvt_pk_bf16_f32 v104, v104, v105
    v_mfma_f32_16x16x32_bf16 a[148:151], a[248:251], v[132:135], a[148:151]
    v_exp_f32 v106, v106
    v_mfma_f32_16x16x32_bf16 a[116:119], a[248:251], v[124:127], a[116:119]
    ds_read_b64_tr_b16 a[234:235], v200 offset:49664
    v_add_f32 v181, v181, v106
    v_mfma_f32_16x16x32_bf16 a[116:119], a[252:255], v[160:163], a[116:119]
    v_exp_f32 v107, v107
    v_mfma_f32_16x16x32_bf16 a[100:103], a[244:247], v[160:163], a[100:103]
    ds_read_b128 a[192:195], v190 offset:0
    v_add_f32 v181, v181, v107
    v_mfma_f32_16x16x32_bf16 a[100:103], a[240:243], v[124:127], a[100:103]
    ds_read_b128 a[196:199], v191 offset:0
    v_cvt_pk_bf16_f32 v105, v106, v107
    v_mfma_f32_16x16x32_bf16 a[68:71], a[240:243], v[116:119], a[68:71]
    v_exp_f32 v112, v112
    v_mfma_f32_16x16x32_bf16 a[68:71], a[244:247], v[152:155], a[68:71]
    v_exp_f32 v113, v113
    v_mfma_f32_16x16x32_bf16 a[84:87], a[252:255], v[152:155], a[84:87]
    ds_read_b128 a[200:203], v190 offset:8192
    v_cvt_pk_bf16_f32 v112, v112, v113
    v_mfma_f32_16x16x32_bf16 a[84:87], a[248:251], v[116:119], a[84:87]
    v_exp_f32 v114, v114
    v_mfma_f32_16x16x32_bf16 a[52:55], a[248:251], v[108:111], a[52:55]
    v_exp_f32 v115, v115
    v_mfma_f32_16x16x32_bf16 a[52:55], a[252:255], v[144:147], a[52:55]
    ds_read_b128 a[204:207], v191 offset:8192
    v_cvt_pk_bf16_f32 v113, v114, v115
    v_mfma_f32_16x16x32_bf16 a[36:39], a[244:247], v[144:147], a[36:39]
    v_exp_f32 v120, v120
    v_mfma_f32_16x16x32_bf16 a[36:39], a[240:243], v[108:111], a[36:39]
    v_exp_f32 v121, v121
    v_mfma_f32_16x16x32_bf16 a[4:7], a[240:243], v[100:103], a[4:7]
    ds_read_b64_tr_b16 a[240:241], v197 offset:49152
    v_cvt_pk_bf16_f32 v120, v120, v121
    v_mfma_f32_16x16x32_bf16 a[4:7], a[244:247], v[136:139], a[4:7]
    v_exp_f32 v122, v122
    v_mfma_f32_16x16x32_bf16 a[20:23], a[252:255], v[136:139], a[20:23]
    v_exp_f32 v123, v123
    v_mfma_f32_16x16x32_bf16 a[20:23], a[248:251], v[100:103], a[20:23]
    s_waitcnt lgkmcnt(5)
    ds_read_b64_tr_b16 a[242:243], v201 offset:49152
    v_cvt_pk_bf16_f32 v121, v122, v123
    v_mfma_f32_16x16x32_bf16 v[140:143], a[208:211], v[0:3], 0
    v_exp_f32 v128, v128
    v_mfma_f32_16x16x32_bf16 v[140:143], a[212:215], v[4:7], v[140:143]
    v_exp_f32 v129, v129
    v_mfma_f32_16x16x32_bf16 v[140:143], a[216:219], v[8:11], v[140:143]
    ds_read_b64_tr_b16 a[244:245], v205 offset:49152
    v_cvt_pk_bf16_f32 v128, v128, v129
    v_mfma_f32_16x16x32_bf16 v[140:143], a[220:223], v[12:15], v[140:143]
    v_exp_f32 v130, v130
    v_mfma_f32_16x16x32_bf16 v[148:151], a[220:223], v[28:31], 0
    v_exp_f32 v131, v131
    v_mfma_f32_16x16x32_bf16 v[148:151], a[216:219], v[24:27], v[148:151]
    ds_read_b64_tr_b16 a[246:247], v209 offset:49152
    v_cvt_pk_bf16_f32 v129, v130, v131
    v_mfma_f32_16x16x32_bf16 v[148:151], a[212:215], v[20:23], v[148:151]
    ds_read_b64_tr_b16 a[252:253], v205 offset:49664
    v_mfma_f32_16x16x32_bf16 v[148:151], a[208:211], v[16:19], v[148:151]
    ds_read_b64_tr_b16 a[254:255], v209 offset:49664
    v_mfma_f32_16x16x32_bf16 v[156:159], a[208:211], v[32:35], 0
    ds_read_b64_tr_b16 a[248:249], v197 offset:49664
    v_mfma_f32_16x16x32_bf16 v[156:159], a[212:215], v[36:39], v[156:159]
    ds_read_b64_tr_b16 a[250:251], v201 offset:49664
    v_mfma_f32_16x16x32_bf16 v[156:159], a[216:219], v[40:43], v[156:159]
    ds_write2st64_b64 v220, v[176:177], v[176:177] offset0:0 offset1:2
    v_mfma_f32_16x16x32_bf16 v[156:159], a[220:223], v[44:47], v[156:159]
    v_exp_f32 v140, v140
    v_mfma_f32_16x16x32_bf16 v[164:167], a[220:223], v[60:63], 0
    v_exp_f32 v141, v141
    v_mfma_f32_16x16x32_bf16 v[164:167], a[216:219], v[56:59], v[164:167]
    v_exp_f32 v142, v142
    v_mfma_f32_16x16x32_bf16 v[164:167], a[212:215], v[52:55], v[164:167]
    v_exp_f32 v143, v143
    v_mfma_f32_16x16x32_bf16 v[164:167], a[208:211], v[48:51], v[164:167]
    v_add_f32 v180, v180, v140
    v_add_f32 v180, v180, v141
    v_mfma_f32_16x16x32_bf16 v[172:175], a[208:211], v[64:67], 0
    ds_read_b128 a[208:211], v192 offset:0
    v_add_f32 v180, v180, v142
    v_mfma_f32_16x16x32_bf16 v[172:175], a[212:215], v[68:71], v[172:175]
    ds_read_b128 a[212:215], v193 offset:0
    v_add_f32 v180, v180, v143
    v_mfma_f32_16x16x32_bf16 v[172:175], a[216:219], v[72:75], v[172:175]
    ds_read_b128 a[216:219], v192 offset:8192
    v_cvt_pk_bf16_f32 v98, v140, v141
    v_mfma_f32_16x16x32_bf16 v[172:175], a[220:223], v[76:79], v[172:175]
    ds_read_b128 a[220:223], v193 offset:8192
    v_cvt_pk_bf16_f32 v99, v142, v143
    v_mfma_f32_16x16x32_bf16 a[8:11], a[224:227], v[100:103], a[8:11]
    v_exp_f32 v148, v148
    v_mfma_f32_16x16x32_bf16 a[8:11], a[228:231], v[136:139], a[8:11]
    v_exp_f32 v149, v149
    v_mfma_f32_16x16x32_bf16 a[24:27], a[236:239], v[136:139], a[24:27]
    v_exp_f32 v150, v150
    v_mfma_f32_16x16x32_bf16 a[24:27], a[232:235], v[100:103], a[24:27]
    v_exp_f32 v151, v151
    v_mfma_f32_16x16x32_bf16 a[56:59], a[232:235], v[108:111], a[56:59]
    v_add_f32 v181, v181, v148
    v_add_f32 v181, v181, v149
    v_mfma_f32_16x16x32_bf16 a[56:59], a[236:239], v[144:147], a[56:59]
    v_add_f32 v181, v181, v150
    v_add_f32 v181, v181, v151
    v_mfma_f32_16x16x32_bf16 a[40:43], a[228:231], v[144:147], a[40:43]
    v_exp_f32 v156, v156
    v_mfma_f32_16x16x32_bf16 a[40:43], a[224:227], v[108:111], a[40:43]
    v_exp_f32 v157, v157
    v_mfma_f32_16x16x32_bf16 a[72:75], a[224:227], v[116:119], a[72:75]
    v_cvt_pk_bf16_f32 v106, v148, v149
    v_cvt_pk_bf16_f32 v114, v156, v157
    v_mfma_f32_16x16x32_bf16 a[72:75], a[228:231], v[152:155], a[72:75]
    v_exp_f32 v158, v158
    v_mfma_f32_16x16x32_bf16 a[88:91], a[236:239], v[152:155], a[88:91]
    v_exp_f32 v159, v159
    v_mfma_f32_16x16x32_bf16 a[88:91], a[232:235], v[116:119], a[88:91]
    v_cvt_pk_bf16_f32 v107, v150, v151
    v_cvt_pk_bf16_f32 v115, v158, v159
    v_mfma_f32_16x16x32_bf16 a[120:123], a[232:235], v[124:127], a[120:123]
    v_exp_f32 v164, v164
    v_mfma_f32_16x16x32_bf16 a[120:123], a[236:239], v[160:163], a[120:123]
    v_exp_f32 v165, v165
    v_mfma_f32_16x16x32_bf16 a[104:107], a[228:231], v[160:163], a[104:107]
    v_exp_f32 v166, v166
    v_mfma_f32_16x16x32_bf16 a[104:107], a[224:227], v[124:127], a[104:107]
    v_exp_f32 v167, v167
    v_mfma_f32_16x16x32_bf16 a[136:139], a[224:227], v[132:135], a[136:139]
    v_exp_f32 v172, v172
    v_mfma_f32_16x16x32_bf16 a[136:139], a[228:231], v[168:171], a[136:139]
    v_exp_f32 v173, v173
    v_mfma_f32_16x16x32_bf16 a[152:155], a[236:239], v[168:171], a[152:155]
    v_cvt_pk_bf16_f32 v122, v164, v165
    v_cvt_pk_bf16_f32 v130, v172, v173
    v_mfma_f32_16x16x32_bf16 a[152:155], a[232:235], v[132:135], a[152:155]
    s_waitcnt vmcnt(8) lgkmcnt(0)
    s_barrier
    global_load_dword v252, v253, s[62:63]
    v_mfma_f32_16x16x32_bf16 a[140:143], a[240:243], v[132:135], a[140:143]
    s_add_u32 m0, s25, 49152
    ds_read_b64_tr_b16 a[224:225], v194 offset:0
    v_cvt_pk_bf16_f32 v123, v166, v167
    v_mfma_f32_16x16x32_bf16 a[140:143], a[244:247], v[168:171], a[140:143]
    v_exp_f32 v174, v174
    v_mfma_f32_16x16x32_bf16 a[156:159], a[252:255], v[168:171], a[156:159]
    v_exp_f32 v175, v175
    v_mfma_f32_16x16x32_bf16 a[156:159], a[248:251], v[132:135], a[156:159]
    ds_read_b64_tr_b16 a[226:227], v198 offset:0
    v_cvt_pk_bf16_f32 v131, v174, v175
    v_mfma_f32_16x16x32_bf16 a[124:127], a[248:251], v[124:127], a[124:127]
    ds_read_b64_tr_b16 a[228:229], v202 offset:0
    v_mfma_f32_16x16x32_bf16 a[124:127], a[252:255], v[160:163], a[124:127]
    buffer_load_dwordx4 v214, s[12:15], s21 offen offset:0 nt lds
    v_mfma_f32_16x16x32_bf16 a[108:111], a[244:247], v[160:163], a[108:111]
    ds_read_b64_tr_b16 a[230:231], v206 offset:0
    v_mfma_f32_16x16x32_bf16 a[108:111], a[240:243], v[124:127], a[108:111]
    ds_read_b64_tr_b16 a[236:237], v202 offset:512
    v_mfma_f32_16x16x32_bf16 a[76:79], a[240:243], v[116:119], a[76:79]
    ds_read_b64_tr_b16 a[238:239], v206 offset:512
    v_mfma_f32_16x16x32_bf16 a[76:79], a[244:247], v[152:155], a[76:79]
    ds_read_b64_tr_b16 a[232:233], v194 offset:512
    v_mfma_f32_16x16x32_bf16 a[92:95], a[252:255], v[152:155], a[92:95]
    buffer_load_dwordx4 v215, s[12:15], s21 offen offset:1024 nt lds
    v_mfma_f32_16x16x32_bf16 a[92:95], a[248:251], v[116:119], a[92:95]
    ds_read_b64_tr_b16 a[234:235], v198 offset:512
    v_mfma_f32_16x16x32_bf16 a[60:63], a[248:251], v[108:111], a[60:63]
    ds_read2st64_b64 a[168:171], v220 offset0:0 offset1:1
    v_mfma_f32_16x16x32_bf16 a[60:63], a[252:255], v[144:147], a[60:63]
    ds_read2st64_b64 a[172:175], v221 offset0:0 offset1:1
    v_mfma_f32_16x16x32_bf16 a[44:47], a[244:247], v[144:147], a[44:47]
    v_mfma_f32_16x16x32_bf16 a[44:47], a[240:243], v[108:111], a[44:47]
    buffer_load_dwordx4 v214, s[12:15], s21 offen offset:2048 nt lds
    v_mfma_f32_16x16x32_bf16 a[12:15], a[240:243], v[100:103], a[12:15]
    ds_read_b64_tr_b16 a[240:241], v195 offset:0
    v_mfma_f32_16x16x32_bf16 a[12:15], a[244:247], v[136:139], a[12:15]
    ds_read_b64_tr_b16 a[242:243], v199 offset:0
    v_mfma_f32_16x16x32_bf16 a[28:31], a[252:255], v[136:139], a[28:31]
    ds_read_b64_tr_b16 a[244:245], v203 offset:0
    v_mfma_f32_16x16x32_bf16 a[28:31], a[248:251], v[100:103], a[28:31]
    ds_read_b64_tr_b16 a[246:247], v207 offset:0
    v_mfma_f32_16x16x32_bf16 v[136:139], a[192:195], v[0:3], 0
    buffer_load_dwordx4 v215, s[12:15], s21 offen offset:3072 nt lds
    v_mfma_f32_16x16x32_bf16 v[136:139], a[196:199], v[4:7], v[136:139]
    ds_read_b64_tr_b16 a[252:253], v203 offset:512
    v_mfma_f32_16x16x32_bf16 v[136:139], a[200:203], v[8:11], v[136:139]
    ds_read_b64_tr_b16 a[254:255], v207 offset:512
    v_mfma_f32_16x16x32_bf16 v[136:139], a[204:207], v[12:15], v[136:139]
    ds_read_b64_tr_b16 a[248:249], v195 offset:512
    v_mfma_f32_16x16x32_bf16 v[144:147], a[204:207], v[28:31], 0
    ds_read_b64_tr_b16 a[250:251], v199 offset:512
    v_mfma_f32_16x16x32_bf16 v[144:147], a[200:203], v[24:27], v[144:147]
    s_add_u32 m0, s24, 49152
    v_mfma_f32_16x16x32_bf16 v[144:147], a[196:199], v[20:23], v[144:147]
    v_mfma_f32_16x16x32_bf16 v[144:147], a[192:195], v[16:19], v[144:147]
    v_mfma_f32_16x16x32_bf16 v[152:155], a[192:195], v[32:35], 0
    v_mfma_f32_16x16x32_bf16 v[152:155], a[196:199], v[36:39], v[152:155]
    v_mfma_f32_16x16x32_bf16 v[152:155], a[200:203], v[40:43], v[152:155]
    buffer_load_dwordx4 v210, s[8:11], s21 offen offset:0 nt lds
    v_mfma_f32_16x16x32_bf16 v[152:155], a[204:207], v[44:47], v[152:155]
    v_exp_f32 v136, v136
    v_mfma_f32_16x16x32_bf16 v[160:163], a[204:207], v[60:63], 0
    v_exp_f32 v137, v137
    v_mfma_f32_16x16x32_bf16 v[160:163], a[200:203], v[56:59], v[160:163]
    v_exp_f32 v138, v138
    v_mfma_f32_16x16x32_bf16 v[160:163], a[196:199], v[52:55], v[160:163]
    v_exp_f32 v139, v139
    v_mfma_f32_16x16x32_bf16 v[160:163], a[192:195], v[48:51], v[160:163]
    buffer_load_dwordx4 v211, s[8:11], s21 offen offset:1024 nt lds
    v_mfma_f32_16x16x32_bf16 v[168:171], a[192:195], v[64:67], 0
    ds_read_b128 a[192:195], v186 offset:16384
    v_add_f32 v180, v180, v136
    v_mfma_f32_16x16x32_bf16 v[168:171], a[196:199], v[68:71], v[168:171]
    ds_read_b128 a[196:199], v187 offset:16384
    v_add_f32 v180, v180, v137
    v_mfma_f32_16x16x32_bf16 v[168:171], a[200:203], v[72:75], v[168:171]
    ds_read_b128 a[200:203], v186 offset:24576
    v_add_f32 v180, v180, v138
    v_mfma_f32_16x16x32_bf16 v[168:171], a[204:207], v[76:79], v[168:171]
    ds_read_b128 a[204:207], v187 offset:24576
    v_add_f32 v180, v180, v139
    v_mfma_f32_16x16x32_bf16 v[140:143], a[208:211], v[0:3], 0
    buffer_load_dwordx4 v212, s[8:11], s21 offen offset:2048 nt lds
    v_mfma_f32_16x16x32_bf16 v[140:143], a[212:215], v[4:7], v[140:143]
    v_exp_f32 v144, v144
    v_mfma_f32_16x16x32_bf16 v[140:143], a[216:219], v[8:11], v[140:143]
    v_cvt_pk_bf16_f32 v136, v136, v137
    v_add_f32 v181, v181, v144
    v_mfma_f32_16x16x32_bf16 v[140:143], a[220:223], v[12:15], v[140:143]
    v_exp_f32 v145, v145
    v_mfma_f32_16x16x32_bf16 v[148:151], a[220:223], v[28:31], 0
    v_cvt_pk_bf16_f32 v137, v138, v139
    v_add_f32 v181, v181, v145
    v_mfma_f32_16x16x32_bf16 v[148:151], a[216:219], v[24:27], v[148:151]
    buffer_load_dwordx4 v213, s[8:11], s21 offen offset:3072 nt lds
    v_mfma_f32_16x16x32_bf16 v[148:151], a[212:215], v[20:23], v[148:151]
    v_exp_f32 v146, v146
    v_mfma_f32_16x16x32_bf16 v[148:151], a[208:211], v[16:19], v[148:151]
    v_exp_f32 v147, v147
    v_mfma_f32_16x16x32_bf16 v[156:159], a[208:211], v[32:35], 0
    v_add_f32 v181, v181, v146
    v_add_f32 v181, v181, v147
    v_mfma_f32_16x16x32_bf16 v[156:159], a[212:215], v[36:39], v[156:159]
    v_exp_f32 v152, v152
    v_mfma_f32_16x16x32_bf16 v[156:159], a[216:219], v[40:43], v[156:159]
    s_add_u32 s21, s21, 16384
    s_bitset0_b32 s21, 18
    v_exp_f32 v153, v153
    v_mfma_f32_16x16x32_bf16 v[156:159], a[220:223], v[44:47], v[156:159]
    v_exp_f32 v140, v140
    v_mfma_f32_16x16x32_bf16 v[164:167], a[220:223], v[60:63], 0
    v_exp_f32 v141, v141
    v_mfma_f32_16x16x32_bf16 v[164:167], a[216:219], v[56:59], v[164:167]
    v_exp_f32 v142, v142
    v_mfma_f32_16x16x32_bf16 v[164:167], a[212:215], v[52:55], v[164:167]
    v_exp_f32 v143, v143
    v_mfma_f32_16x16x32_bf16 v[164:167], a[208:211], v[48:51], v[164:167]
    v_add_f32 v180, v180, v140
    v_add_f32 v180, v180, v141
    v_mfma_f32_16x16x32_bf16 v[172:175], a[208:211], v[64:67], 0
    v_add_f32 v180, v180, v142
    v_add_f32 v180, v180, v143
    v_mfma_f32_16x16x32_bf16 v[172:175], a[212:215], v[68:71], v[172:175]
    v_cvt_pk_bf16_f32 v138, v140, v141
    v_cvt_pk_bf16_f32 v144, v144, v145
    v_mfma_f32_16x16x32_bf16 v[172:175], a[216:219], v[72:75], v[172:175]
    v_cvt_pk_bf16_f32 v139, v142, v143
    v_cvt_pk_bf16_f32 v145, v146, v147
    v_mfma_f32_16x16x32_bf16 v[172:175], a[220:223], v[76:79], v[172:175]
    s_waitcnt lgkmcnt(0)
    v_exp_f32 v148, v148
L_blk1:
    v_mfma_f32_16x16x32_bf16 v[100:103], a[192:195], v[0:3], 0
    v_exp_f32 v149, v149
    v_mfma_f32_16x16x32_bf16 v[100:103], a[196:199], v[4:7], v[100:103]
    v_exp_f32 v150, v150
    v_mfma_f32_16x16x32_bf16 v[100:103], a[200:203], v[8:11], v[100:103]
    v_exp_f32 v151, v151
    v_mfma_f32_16x16x32_bf16 v[100:103], a[204:207], v[12:15], v[100:103]
    v_exp_f32 v154, v154
    v_mfma_f32_16x16x32_bf16 v[108:111], a[204:207], v[28:31], 0
    v_exp_f32 v155, v155
    v_mfma_f32_16x16x32_bf16 v[108:111], a[200:203], v[24:27], v[108:111]
    v_add_f32 v181, v181, v148
    v_add_f32 v181, v181, v149
    v_mfma_f32_16x16x32_bf16 v[108:111], a[196:199], v[20:23], v[108:111]
    v_add_f32 v181, v181, v150
    v_add_f32 v181, v181, v151
    v_mfma_f32_16x16x32_bf16 v[108:111], a[192:195], v[16:19], v[108:111]
    v_cvt_pk_bf16_f32 v146, v148, v149
    v_cvt_pk_bf16_f32 v152, v152, v153
    v_mfma_f32_16x16x32_bf16 v[116:119], a[192:195], v[32:35], 0
    v_cvt_pk_bf16_f32 v147, v150, v151
    v_cvt_pk_bf16_f32 v153, v154, v155
    v_mfma_f32_16x16x32_bf16 v[116:119], a[196:199], v[36:39], v[116:119]
    v_exp_f32 v156, v156
    v_mfma_f32_16x16x32_bf16 v[116:119], a[200:203], v[40:43], v[116:119]
    v_exp_f32 v157, v157
    v_mfma_f32_16x16x32_bf16 v[116:119], a[204:207], v[44:47], v[116:119]
    v_exp_f32 v158, v158
    v_mfma_f32_16x16x32_bf16 v[124:127], a[204:207], v[60:63], 0
    v_exp_f32 v159, v159
    v_mfma_f32_16x16x32_bf16 v[124:127], a[200:203], v[56:59], v[124:127]
    v_exp_f32 v160, v160
    v_mfma_f32_16x16x32_bf16 v[124:127], a[196:199], v[52:55], v[124:127]
    v_exp_f32 v161, v161
    v_mfma_f32_16x16x32_bf16 v[124:127], a[192:195], v[48:51], v[124:127]
    v_cvt_pk_bf16_f32 v154, v156, v157
    v_cvt_pk_bf16_f32 v160, v160, v161
    v_mfma_f32_16x16x32_bf16 v[132:135], a[192:195], v[64:67], 0
    v_exp_f32 v162, v162
    v_mfma_f32_16x16x32_bf16 v[132:135], a[196:199], v[68:71], v[132:135]
    v_exp_f32 v163, v163
    v_mfma_f32_16x16x32_bf16 v[132:135], a[200:203], v[72:75], v[132:135]
    v_cvt_pk_bf16_f32 v155, v158, v159
    v_cvt_pk_bf16_f32 v161, v162, v163
    v_mfma_f32_16x16x32_bf16 v[132:135], a[204:207], v[76:79], v[132:135]
    v_exp_f32 v164, v164
    v_mfma_f32_16x16x32_bf16 v[176:179], a[204:207], v[92:95], 0
    v_exp_f32 v165, v165
    v_mfma_f32_16x16x32_bf16 v[176:179], a[200:203], v[88:91], v[176:179]
    v_exp_f32 v166, v166
    v_mfma_f32_16x16x32_bf16 v[176:179], a[196:199], v[84:87], v[176:179]
    v_exp_f32 v167, v167
    v_mfma_f32_16x16x32_bf16 v[176:179], a[192:195], v[80:83], v[176:179]
    ds_read_b128 a[208:211], v188 offset:16384
    v_cvt_pk_bf16_f32 v162, v164, v165
    v_mfma_f32_16x16x32_bf16 a[160:163], a[224:227], a[168:171], a[160:163]
    v_exp_f32 v168, v168
    v_mfma_f32_16x16x32_bf16 a[160:163], a[228:231], a[172:175], a[160:163]
    v_exp_f32 v169, v169
    v_mfma_f32_16x16x32_bf16 a[164:167], a[236:239], a[172:175], a[164:167]
    v_exp_f32 v170, v170
    v_mfma_f32_16x16x32_bf16 a[164:167], a[232:235], a[168:171], a[164:167]
    v_exp_f32 v171, v171
    v_mfma_f32_16x16x32_bf16 a[16:19], a[232:235], v[96:99], a[16:19]
    v_cvt_pk_bf16_f32 v163, v166, v167
    v_cvt_pk_bf16_f32 v168, v168, v169
    v_mfma_f32_16x16x32_bf16 a[16:19], a[236:239], v[136:139], a[16:19]
    v_exp_f32 v172, v172
    v_mfma_f32_16x16x32_bf16 a[0:3], a[228:231], v[136:139], a[0:3]
    v_exp_f32 v173, v173
    v_mfma_f32_16x16x32_bf16 a[0:3], a[224:227], v[96:99], a[0:3]
    v_exp_f32 v174, v174
    v_mfma_f32_16x16x32_bf16 a[32:35], a[224:227], v[104:107], a[32:35]
    v_exp_f32 v175, v175
    v_mfma_f32_16x16x32_bf16 a[32:35], a[228:231], v[144:147], a[32:35]
    ds_read_b128 a[212:215], v189 offset:16384
    v_cvt_pk_bf16_f32 v169, v170, v171
    v_mfma_f32_16x16x32_bf16 a[48:51], a[236:239], v[144:147], a[48:51]
    ds_read_b128 a[216:219], v188 offset:24576
    v_cvt_pk_bf16_f32 v170, v172, v173
    v_mfma_f32_16x16x32_bf16 a[48:51], a[232:235], v[104:107], a[48:51]
    ds_read_b128 a[220:223], v189 offset:24576
    v_cvt_pk_bf16_f32 v171, v174, v175
    v_mfma_f32_16x16x32_bf16 a[80:83], a[232:235], v[112:115], a[80:83]
    v_exp_f32 v176, v176
    v_mfma_f32_16x16x32_bf16 a[80:83], a[236:239], v[152:155], a[80:83]
    v_exp_f32 v177, v177
    v_mfma_f32_16x16x32_bf16 a[64:67], a[228:231], v[152:155], a[64:67]
    v_exp_f32 v178, v178
    v_mfma_f32_16x16x32_bf16 a[64:67], a[224:227], v[112:115], a[64:67]
    v_exp_f32 v179, v179
    v_mfma_f32_16x16x32_bf16 a[176:179], v[244:247], v[112:115], a[176:179]
    v_add_f32 v185, v185, v176
    v_add_f32 v185, v185, v177
    v_mfma_f32_16x16x32_bf16 a[176:179], v[244:247], v[152:155], a[176:179]
    v_add_f32 v185, v185, v178
    v_add_f32 v185, v185, v179
    v_mfma_f32_16x16x32_bf16 a[96:99], a[224:227], v[120:123], a[96:99]
    v_exp_f32 v100, v100
    v_mfma_f32_16x16x32_bf16 a[96:99], a[228:231], v[160:163], a[96:99]
    v_cvt_pk_bf16_f32 v176, v176, v177
    v_add_f32 v180, v180, v100
    v_mfma_f32_16x16x32_bf16 a[112:115], a[236:239], v[160:163], a[112:115]
    v_exp_f32 v101, v101
    v_mfma_f32_16x16x32_bf16 a[112:115], a[232:235], v[120:123], a[112:115]
    v_cvt_pk_bf16_f32 v177, v178, v179
    v_add_f32 v180, v180, v101
    v_mfma_f32_16x16x32_bf16 a[180:183], v[244:247], v[120:123], a[180:183]
    v_exp_f32 v102, v102
    v_mfma_f32_16x16x32_bf16 a[180:183], v[244:247], v[160:163], a[180:183]
    v_exp_f32 v103, v103
    v_mfma_f32_16x16x32_bf16 a[144:147], a[232:235], v[128:131], a[144:147]
    ds_read_b64_tr_b16 a[232:233], v196 offset:512
    v_add_f32 v180, v180, v102
    v_mfma_f32_16x16x32_bf16 a[144:147], a[236:239], v[168:171], a[144:147]
    ds_read_b64_tr_b16 a[236:237], v204 offset:512
    v_add_f32 v180, v180, v103
    v_mfma_f32_16x16x32_bf16 a[128:131], a[228:231], v[168:171], a[128:131]
    ds_read_b64_tr_b16 a[228:229], v204 offset:0
    v_cvt_pk_bf16_f32 v100, v100, v101
    v_mfma_f32_16x16x32_bf16 a[128:131], a[224:227], v[128:131], a[128:131]
    ds_read_b64_tr_b16 a[224:225], v196 offset:0
    v_cvt_pk_bf16_f32 v101, v102, v103
    v_mfma_f32_16x16x32_bf16 a[184:187], v[244:247], v[128:131], a[184:187]
    v_exp_f32 v108, v108
    v_mfma_f32_16x16x32_bf16 a[184:187], v[244:247], v[168:171], a[184:187]
    ds_read_b64_tr_b16 a[226:227], v200 offset:0
    v_add_f32 v181, v181, v108
    v_mfma_f32_16x16x32_bf16 a[132:135], a[240:243], v[128:131], a[132:135]
    v_exp_f32 v109, v109
    v_mfma_f32_16x16x32_bf16 a[132:135], a[244:247], v[168:171], a[132:135]
    ds_read_b64_tr_b16 a[230:231], v208 offset:0
    v_add_f32 v181, v181, v109
    v_mfma_f32_16x16x32_bf16 a[148:151], a[252:255], v[168:171], a[148:151]
    ds_read_b64_tr_b16 a[238:239], v208 offset:512
    v_cvt_pk_bf16_f32 v108, v108, v109
    v_mfma_f32_16x16x32_bf16 a[148:151], a[248:251], v[128:131], a[148:151]
    v_exp_f32 v110, v110
    v_mfma_f32_16x16x32_bf16 a[116:119], a[248:251], v[120:123], a[116:119]
    ds_read_b64_tr_b16 a[234:235], v200 offset:512
    v_add_f32 v181, v181, v110
    v_mfma_f32_16x16x32_bf16 a[116:119], a[252:255], v[160:163], a[116:119]
    v_exp_f32 v111, v111
    v_mfma_f32_16x16x32_bf16 a[100:103], a[244:247], v[160:163], a[100:103]
    ds_read_b128 a[192:195], v190 offset:16384
    v_add_f32 v181, v181, v111
    v_mfma_f32_16x16x32_bf16 a[100:103], a[240:243], v[120:123], a[100:103]
    ds_read_b128 a[196:199], v191 offset:16384
    v_cvt_pk_bf16_f32 v109, v110, v111
    v_mfma_f32_16x16x32_bf16 a[68:71], a[240:243], v[112:115], a[68:71]
    v_exp_f32 v116, v116
    v_mfma_f32_16x16x32_bf16 a[68:71], a[244:247], v[152:155], a[68:71]
    v_exp_f32 v117, v117
    v_mfma_f32_16x16x32_bf16 a[84:87], a[252:255], v[152:155], a[84:87]
    ds_read_b128 a[200:203], v190 offset:24576
    v_cvt_pk_bf16_f32 v116, v116, v117
    v_mfma_f32_16x16x32_bf16 a[84:87], a[248:251], v[112:115], a[84:87]
    v_exp_f32 v118, v118
    v_mfma_f32_16x16x32_bf16 a[52:55], a[248:251], v[104:107], a[52:55]
    v_exp_f32 v119, v119
    v_mfma_f32_16x16x32_bf16 a[52:55], a[252:255], v[144:147], a[52:55]
    ds_read_b128 a[204:207], v191 offset:24576
    v_cvt_pk_bf16_f32 v117, v118, v119
    v_mfma_f32_16x16x32_bf16 a[36:39], a[244:247], v[144:147], a[36:39]
    v_exp_f32 v124, v124
    v_mfma_f32_16x16x32_bf16 a[36:39], a[240:243], v[104:107], a[36:39]
    v_exp_f32 v125, v125
    v_mfma_f32_16x16x32_bf16 a[4:7], a[240:243], v[96:99], a[4:7]
    ds_read_b64_tr_b16 a[240:241], v197 offset:0
    v_cvt_pk_bf16_f32 v124, v124, v125
    v_mfma_f32_16x16x32_bf16 a[4:7], a[244:247], v[136:139], a[4:7]
    v_exp_f32 v126, v126
    v_mfma_f32_16x16x32_bf16 a[20:23], a[252:255], v[136:139], a[20:23]
    v_exp_f32 v127, v127
    v_mfma_f32_16x16x32_bf16 a[20:23], a[248:251], v[96:99], a[20:23]
    s_waitcnt lgkmcnt(5)
    ds_read_b64_tr_b16 a[242:243], v201 offset:0
    v_cvt_pk_bf16_f32 v125, v126, v127
    v_mfma_f32_16x16x32_bf16 v[140:143], a[208:211], v[0:3], 0
    v_exp_f32 v132, v132
    v_mfma_f32_16x16x32_bf16 v[140:143], a[212:215], v[4:7], v[140:143]
    v_exp_f32 v133, v133
    v_mfma_f32_16x16x32_bf16 v[140:143], a[216:219], v[8:11], v[140:143]
    ds_read_b64_tr_b16 a[244:245], v205 offset:0
    v_cvt_pk_bf16_f32 v132, v132, v133
    v_mfma_f32_16x16x32_bf16 v[140:143], a[220:223], v[12:15], v[140:143]
    v_exp_f32 v134, v134
    v_mfma_f32_16x16x32_bf16 v[148:151], a[220:223], v[28:31], 0
    v_exp_f32 v135, v135
    v_mfma_f32_16x16x32_bf16 v[148:151], a[216:219], v[24:27], v[148:151]
    ds_read_b64_tr_b16 a[246:247], v209 offset:0
    v_cvt_pk_bf16_f32 v133, v134, v135
    v_mfma_f32_16x16x32_bf16 v[148:151], a[212:215], v[20:23], v[148:151]
    ds_read_b64_tr_b16 a[252:253], v205 offset:512
    v_mfma_f32_16x16x32_bf16 v[148:151], a[208:211], v[16:19], v[148:151]
    ds_read_b64_tr_b16 a[254:255], v209 offset:512
    v_mfma_f32_16x16x32_bf16 v[156:159], a[208:211], v[32:35], 0
    ds_read_b64_tr_b16 a[248:249], v197 offset:512
    v_mfma_f32_16x16x32_bf16 v[156:159], a[212:215], v[36:39], v[156:159]
    ds_read_b64_tr_b16 a[250:251], v201 offset:512
    v_mfma_f32_16x16x32_bf16 v[156:159], a[216:219], v[40:43], v[156:159]
    ds_write2st64_b64 v220, v[176:177], v[176:177] offset0:8 offset1:10
    v_mfma_f32_16x16x32_bf16 v[156:159], a[220:223], v[44:47], v[156:159]
    v_exp_f32 v140, v140
    v_mfma_f32_16x16x32_bf16 v[164:167], a[220:223], v[60:63], 0
    v_exp_f32 v141, v141
    v_mfma_f32_16x16x32_bf16 v[164:167], a[216:219], v[56:59], v[164:167]
    v_exp_f32 v142, v142
    v_mfma_f32_16x16x32_bf16 v[164:167], a[212:215], v[52:55], v[164:167]
    v_exp_f32 v143, v143
    v_mfma_f32_16x16x32_bf16 v[164:167], a[208:211], v[48:51], v[164:167]
    v_add_f32 v180, v180, v140
    v_add_f32 v180, v180, v141
    v_mfma_f32_16x16x32_bf16 v[172:175], a[208:211], v[64:67], 0
    ds_read_b128 a[208:211], v192 offset:16384
    v_add_f32 v180, v180, v142
    v_mfma_f32_16x16x32_bf16 v[172:175], a[212:215], v[68:71], v[172:175]
    ds_read_b128 a[212:215], v193 offset:16384
    v_add_f32 v180, v180, v143
    v_mfma_f32_16x16x32_bf16 v[172:175], a[216:219], v[72:75], v[172:175]
    ds_read_b128 a[216:219], v192 offset:24576
    v_cvt_pk_bf16_f32 v102, v140, v141
    v_mfma_f32_16x16x32_bf16 v[172:175], a[220:223], v[76:79], v[172:175]
    ds_read_b128 a[220:223], v193 offset:24576
    v_cvt_pk_bf16_f32 v103, v142, v143
    v_mfma_f32_16x16x32_bf16 a[8:11], a[224:227], v[96:99], a[8:11]
    v_exp_f32 v148, v148
    v_mfma_f32_16x16x32_bf16 a[8:11], a[228:231], v[136:139], a[8:11]
    v_exp_f32 v149, v149
    v_mfma_f32_16x16x32_bf16 a[24:27], a[236:239], v[136:139], a[24:27]
    v_exp_f32 v150, v150
    v_mfma_f32_16x16x32_bf16 a[24:27], a[232:235], v[96:99], a[24:27]
    v_exp_f32 v151, v151
    v_mfma_f32_16x16x32_bf16 a[56:59], a[232:235], v[104:107], a[56:59]
    v_add_f32 v181, v181, v148
    v_add_f32 v181, v181, v149
    v_mfma_f32_16x16x32_bf16 a[56:59], a[236:239], v[144:147], a[56:59]
    v_add_f32 v181, v181, v150
    v_add_f32 v181, v181, v151
    v_mfma_f32_16x16x32_bf16 a[40:43], a[228:231], v[144:147], a[40:43]
    v_exp_f32 v156, v156
    v_mfma_f32_16x16x32_bf16 a[40:43], a[224:227], v[104:107], a[40:43]
    v_exp_f32 v157, v157
    v_mfma_f32_16x16x32_bf16 a[72:75], a[224:227], v[112:115], a[72:75]
    v_cvt_pk_bf16_f32 v110, v148, v149
    v_cvt_pk_bf16_f32 v118, v156, v157
    v_mfma_f32_16x16x32_bf16 a[72:75], a[228:231], v[152:155], a[72:75]
    v_exp_f32 v158, v158
    v_mfma_f32_16x16x32_bf16 a[88:91], a[236:239], v[152:155], a[88:91]
    v_exp_f32 v159, v159
    v_mfma_f32_16x16x32_bf16 a[88:91], a[232:235], v[112:115], a[88:91]
    v_cvt_pk_bf16_f32 v111, v150, v151
    v_cvt_pk_bf16_f32 v119, v158, v159
    v_mfma_f32_16x16x32_bf16 a[120:123], a[232:235], v[120:123], a[120:123]
    v_exp_f32 v164, v164
    v_mfma_f32_16x16x32_bf16 a[120:123], a[236:239], v[160:163], a[120:123]
    v_exp_f32 v165, v165
    v_mfma_f32_16x16x32_bf16 a[104:107], a[228:231], v[160:163], a[104:107]
    v_exp_f32 v166, v166
    v_mfma_f32_16x16x32_bf16 a[104:107], a[224:227], v[120:123], a[104:107]
    v_exp_f32 v167, v167
    v_mfma_f32_16x16x32_bf16 a[136:139], a[224:227], v[128:131], a[136:139]
    v_exp_f32 v172, v172
    v_mfma_f32_16x16x32_bf16 a[136:139], a[228:231], v[168:171], a[136:139]
    v_exp_f32 v173, v173
    v_mfma_f32_16x16x32_bf16 a[152:155], a[236:239], v[168:171], a[152:155]
    v_cvt_pk_bf16_f32 v126, v164, v165
    v_cvt_pk_bf16_f32 v134, v172, v173
    v_mfma_f32_16x16x32_bf16 a[152:155], a[232:235], v[128:131], a[152:155]
    s_waitcnt vmcnt(8) lgkmcnt(0)
    s_barrier
    v_mfma_f32_16x16x32_bf16 a[140:143], a[240:243], v[128:131], a[140:143]
    s_add_u32 m0, s25, 0
    ds_read_b64_tr_b16 a[224:225], v194 offset:16384
    v_cvt_pk_bf16_f32 v127, v166, v167
    v_mfma_f32_16x16x32_bf16 a[140:143], a[244:247], v[168:171], a[140:143]
    v_exp_f32 v174, v174
    v_mfma_f32_16x16x32_bf16 a[156:159], a[252:255], v[168:171], a[156:159]
    v_exp_f32 v175, v175
    v_mfma_f32_16x16x32_bf16 a[156:159], a[248:251], v[128:131], a[156:159]
    ds_read_b64_tr_b16 a[226:227], v198 offset:16384
    v_cvt_pk_bf16_f32 v135, v174, v175
    v_mfma_f32_16x16x32_bf16 a[124:127], a[248:251], v[120:123], a[124:127]
    ds_read_b64_tr_b16 a[228:229], v202 offset:16384
    v_mfma_f32_16x16x32_bf16 a[124:127], a[252:255], v[160:163], a[124:127]
    buffer_load_dwordx4 v214, s[12:15], s21 offen offset:0 nt lds
    v_mfma_f32_16x16x32_bf16 a[108:111], a[244:247], v[160:163], a[108:111]
    ds_read_b64_tr_b16 a[230:231], v206 offset:16384
    v_mfma_f32_16x16x32_bf16 a[108:111], a[240:243], v[120:123], a[108:111]
    ds_read_b64_tr_b16 a[236:237], v202 offset:16896
    v_mfma_f32_16x16x32_bf16 a[76:79], a[240:243], v[112:115], a[76:79]
    ds_read_b64_tr_b16 a[238:239], v206 offset:16896
    v_mfma_f32_16x16x32_bf16 a[76:79], a[244:247], v[152:155], a[76:79]
    ds_read_b64_tr_b16 a[232:233], v194 offset:16896
    v_mfma_f32_16x16x32_bf16 a[92:95], a[252:255], v[152:155], a[92:95]
    buffer_load_dwordx4 v215, s[12:15], s21 offen offset:1024 nt lds
    v_mfma_f32_16x16x32_bf16 a[92:95], a[248:251], v[112:115], a[92:95]
    ds_read_b64_tr_b16 a[234:235], v198 offset:16896
    v_mfma_f32_16x16x32_bf16 a[60:63], a[248:251], v[104:107], a[60:63]
    ds_read2st64_b64 a[168:171], v220 offset0:8 offset1:9
    v_mfma_f32_16x16x32_bf16 a[60:63], a[252:255], v[144:147], a[60:63]
    ds_read2st64_b64 a[172:175], v221 offset0:8 offset1:9
    v_mfma_f32_16x16x32_bf16 a[44:47], a[244:247], v[144:147], a[44:47]
    v_mfma_f32_16x16x32_bf16 a[44:47], a[240:243], v[104:107], a[44:47]
    buffer_load_dwordx4 v214, s[12:15], s21 offen offset:2048 nt lds
    v_mfma_f32_16x16x32_bf16 a[12:15], a[240:243], v[96:99], a[12:15]
    ds_read_b64_tr_b16 a[240:241], v195 offset:16384
    v_mfma_f32_16x16x32_bf16 a[12:15], a[244:247], v[136:139], a[12:15]
    ds_read_b64_tr_b16 a[242:243], v199 offset:16384
    v_mfma_f32_16x16x32_bf16 a[28:31], a[252:255], v[136:139], a[28:31]
    ds_read_b64_tr_b16 a[244:245], v203 offset:16384
    v_mfma_f32_16x16x32_bf16 a[28:31], a[248:251], v[96:99], a[28:31]
    ds_read_b64_tr_b16 a[246:247], v207 offset:16384
    v_mfma_f32_16x16x32_bf16 v[136:139], a[192:195], v[0:3], 0
    buffer_load_dwordx4 v215, s[12:15], s21 offen offset:3072 nt lds
    v_mfma_f32_16x16x32_bf16 v[136:139], a[196:199], v[4:7], v[136:139]
    ds_read_b64_tr_b16 a[252:253], v203 offset:16896
    v_mfma_f32_16x16x32_bf16 v[136:139], a[200:203], v[8:11], v[136:139]
    ds_read_b64_tr_b16 a[254:255], v207 offset:16896
    v_mfma_f32_16x16x32_bf16 v[136:139], a[204:207], v[12:15], v[136:139]
    ds_read_b64_tr_b16 a[248:249], v195 offset:16896
    v_mfma_f32_16x16x32_bf16 v[144:147], a[204:207], v[28:31], 0
    ds_read_b64_tr_b16 a[250:251], v199 offset:16896
    v_mfma_f32_16x16x32_bf16 v[144:147], a[200:203], v[24:27], v[144:147]
    s_add_u32 m0, s24, 0
    v_mfma_f32_16x16x32_bf16 v[144:147], a[196:199], v[20:23], v[144:147]
    v_mfma_f32_16x16x32_bf16 v[144:147], a[192:195], v[16:19], v[144:147]
    v_mfma_f32_16x16x32_bf16 v[152:155], a[192:195], v[32:35], 0
    v_mfma_f32_16x16x32_bf16 v[152:155], a[196:199], v[36:39], v[152:155]
    v_mfma_f32_16x16x32_bf16 v[152:155], a[200:203], v[40:43], v[152:155]
    buffer_load_dwordx4 v210, s[8:11], s21 offen offset:0 nt lds
    v_mfma_f32_16x16x32_bf16 v[152:155], a[204:207], v[44:47], v[152:155]
    v_exp_f32 v136, v136
    v_mfma_f32_16x16x32_bf16 v[160:163], a[204:207], v[60:63], 0
    v_exp_f32 v137, v137
    v_mfma_f32_16x16x32_bf16 v[160:163], a[200:203], v[56:59], v[160:163]
    v_exp_f32 v138, v138
    v_mfma_f32_16x16x32_bf16 v[160:163], a[196:199], v[52:55], v[160:163]
    v_exp_f32 v139, v139
    v_mfma_f32_16x16x32_bf16 v[160:163], a[192:195], v[48:51], v[160:163]
    buffer_load_dwordx4 v211, s[8:11], s21 offen offset:1024 nt lds
    v_mfma_f32_16x16x32_bf16 v[168:171], a[192:195], v[64:67], 0
    ds_read_b128 a[192:195], v186 offset:32768
    v_add_f32 v180, v180, v136
    v_mfma_f32_16x16x32_bf16 v[168:171], a[196:199], v[68:71], v[168:171]
    ds_read_b128 a[196:199], v187 offset:32768
    v_add_f32 v180, v180, v137
    v_mfma_f32_16x16x32_bf16 v[168:171], a[200:203], v[72:75], v[168:171]
    ds_read_b128 a[200:203], v186 offset:40960
    v_add_f32 v180, v180, v138
    v_mfma_f32_16x16x32_bf16 v[168:171], a[204:207], v[76:79], v[168:171]
    ds_read_b128 a[204:207], v187 offset:40960
    v_add_f32 v180, v180, v139
    v_mfma_f32_16x16x32_bf16 v[140:143], a[208:211], v[0:3], 0
    buffer_load_dwordx4 v212, s[8:11], s21 offen offset:2048 nt lds
    v_mfma_f32_16x16x32_bf16 v[140:143], a[212:215], v[4:7], v[140:143]
    v_exp_f32 v144, v144
    v_mfma_f32_16x16x32_bf16 v[140:143], a[216:219], v[8:11], v[140:143]
    v_cvt_pk_bf16_f32 v136, v136, v137
    v_add_f32 v181, v181, v144
    v_mfma_f32_16x16x32_bf16 v[140:143], a[220:223], v[12:15], v[140:143]
    v_exp_f32 v145, v145
    v_mfma_f32_16x16x32_bf16 v[148:151], a[220:223], v[28:31], 0
    v_cvt_pk_bf16_f32 v137, v138, v139
    v_add_f32 v181, v181, v145
    v_mfma_f32_16x16x32_bf16 v[148:151], a[216:219], v[24:27], v[148:151]
    buffer_load_dwordx4 v213, s[8:11], s21 offen offset:3072 nt lds
    v_mfma_f32_16x16x32_bf16 v[148:151], a[212:215], v[20:23], v[148:151]
    v_exp_f32 v146, v146
    v_mfma_f32_16x16x32_bf16 v[148:151], a[208:211], v[16:19], v[148:151]
    v_exp_f32 v147, v147
    v_mfma_f32_16x16x32_bf16 v[156:159], a[208:211], v[32:35], 0
    v_add_f32 v181, v181, v146
    v_add_f32 v181, v181, v147
    v_mfma_f32_16x16x32_bf16 v[156:159], a[212:215], v[36:39], v[156:159]
    v_exp_f32 v152, v152
    v_mfma_f32_16x16x32_bf16 v[156:159], a[216:219], v[40:43], v[156:159]
    s_add_u32 s21, s21, 16384
    v_exp_f32 v153, v153
    v_mfma_f32_16x16x32_bf16 v[156:159], a[220:223], v[44:47], v[156:159]
    v_exp_f32 v140, v140
    v_mfma_f32_16x16x32_bf16 v[164:167], a[220:223], v[60:63], 0
    v_exp_f32 v141, v141
    v_mfma_f32_16x16x32_bf16 v[164:167], a[216:219], v[56:59], v[164:167]
    v_exp_f32 v142, v142
    v_mfma_f32_16x16x32_bf16 v[164:167], a[212:215], v[52:55], v[164:167]
    v_exp_f32 v143, v143
    v_mfma_f32_16x16x32_bf16 v[164:167], a[208:211], v[48:51], v[164:167]
    v_add_f32 v180, v180, v140
    v_add_f32 v180, v180, v141
    v_mfma_f32_16x16x32_bf16 v[172:175], a[208:211], v[64:67], 0
    v_add_f32 v180, v180, v142
    v_add_f32 v180, v180, v143
    v_mfma_f32_16x16x32_bf16 v[172:175], a[212:215], v[68:71], v[172:175]
    v_cvt_pk_bf16_f32 v138, v140, v141
    v_cvt_pk_bf16_f32 v144, v144, v145
    v_mfma_f32_16x16x32_bf16 v[172:175], a[216:219], v[72:75], v[172:175]
    v_cvt_pk_bf16_f32 v139, v142, v143
    v_cvt_pk_bf16_f32 v145, v146, v147
    v_mfma_f32_16x16x32_bf16 v[172:175], a[220:223], v[76:79], v[172:175]
    s_waitcnt lgkmcnt(0)
    v_exp_f32 v148, v148
L_blk2:
    v_mfma_f32_16x16x32_bf16 v[96:99], a[192:195], v[0:3], 0
    v_exp_f32 v149, v149
    v_mfma_f32_16x16x32_bf16 v[96:99], a[196:199], v[4:7], v[96:99]
    v_exp_f32 v150, v150
    v_mfma_f32_16x16x32_bf16 v[96:99], a[200:203], v[8:11], v[96:99]
    v_exp_f32 v151, v151
    v_mfma_f32_16x16x32_bf16 v[96:99], a[204:207], v[12:15], v[96:99]
    v_exp_f32 v154, v154
    v_mfma_f32_16x16x32_bf16 v[104:107], a[204:207], v[28:31], 0
    v_exp_f32 v155, v155
    v_mfma_f32_16x16x32_bf16 v[104:107], a[200:203], v[24:27], v[104:107]
    v_add_f32 v181, v181, v148
    v_add_f32 v181, v181, v149
    v_mfma_f32_16x16x32_bf16 v[104:107], a[196:199], v[20:23], v[104:107]
    v_add_f32 v181, v181, v150
    v_add_f32 v181, v181, v151
    v_mfma_f32_16x16x32_bf16 v[104:107], a[192:195], v[16:19], v[104:107]
    v_cvt_pk_bf16_f32 v146, v148, v149
    v_cvt_pk_bf16_f32 v152, v152, v153
    v_mfma_f32_16x16x32_bf16 v[112:115], a[192:195], v[32:35], 0
    v_cvt_pk_bf16_f32 v147, v150, v151
    v_cvt_pk_bf16_f32 v153, v154, v155
    v_mfma_f32_16x16x32_bf16 v[112:115], a[196:199], v[36:39], v[112:115]
    v_exp_f32 v156, v156
    v_mfma_f32_16x16x32_bf16 v[112:115], a[200:203], v[40:43], v[112:115]
    v_exp_f32 v157, v157
    v_mfma_f32_16x16x32_bf16 v[112:115], a[204:207], v[44:47], v[112:115]
    v_exp_f32 v158, v158
    v_mfma_f32_16x16x32_bf16 v[120:123], a[204:207], v[60:63], 0
    v_exp_f32 v159, v159
    v_mfma_f32_16x16x32_bf16 v[120:123], a[200:203], v[56:59], v[120:123]
    v_exp_f32 v160, v160
    v_mfma_f32_16x16x32_bf16 v[120:123], a[196:199], v[52:55], v[120:123]
    v_exp_f32 v161, v161
    v_mfma_f32_16x16x32_bf16 v[120:123], a[192:195], v[48:51], v[120:123]
    v_cvt_pk_bf16_f32 v154, v156, v157
    v_cvt_pk_bf16_f32 v160, v160, v161
    v_mfma_f32_16x16x32_bf16 v[128:131], a[192:195], v[64:67], 0
    v_exp_f32 v162, v162
    v_mfma_f32_16x16x32_bf16 v[128:131], a[196:199], v[68:71], v[128:131]
    v_exp_f32 v163, v163
    v_mfma_f32_16x16x32_bf16 v[128:131], a[200:203], v[72:75], v[128:131]
    v_cvt_pk_bf16_f32 v155, v158, v159
    v_cvt_pk_bf16_f32 v161, v162, v163
    v_mfma_f32_16x16x32_bf16 v[128:131], a[204:207], v[76:79], v[128:131]
    v_exp_f32 v164, v164
    v_mfma_f32_16x16x32_bf16 v[176:179], a[204:207], v[92:95], 0
    v_exp_f32 v165, v165
    v_mfma_f32_16x16x32_bf16 v[176:179], a[200:203], v[88:91], v[176:179]
    v_exp_f32 v166, v166
    v_mfma_f32_16x16x32_bf16 v[176:179], a[196:199], v[84:87], v[176:179]
    v_exp_f32 v167, v167
    v_mfma_f32_16x16x32_bf16 v[176:179], a[192:195], v[80:83], v[176:179]
    ds_read_b128 a[208:211], v188 offset:32768
    v_cvt_pk_bf16_f32 v162, v164, v165
    v_mfma_f32_16x16x32_bf16 a[160:163], a[224:227], a[168:171], a[160:163]
    v_exp_f32 v168, v168
    v_mfma_f32_16x16x32_bf16 a[160:163], a[228:231], a[172:175], a[160:163]
    v_exp_f32 v169, v169
    v_mfma_f32_16x16x32_bf16 a[164:167], a[236:239], a[172:175], a[164:167]
    v_exp_f32 v170, v170
    v_mfma_f32_16x16x32_bf16 a[164:167], a[232:235], a[168:171], a[164:167]
    v_exp_f32 v171, v171
    v_mfma_f32_16x16x32_bf16 a[16:19], a[232:235], v[100:103], a[16:19]
    v_cvt_pk_bf16_f32 v163, v166, v167
    v_cvt_pk_bf16_f32 v168, v168, v169
    v_mfma_f32_16x16x32_bf16 a[16:19], a[236:239], v[136:139], a[16:19]
    v_exp_f32 v172, v172
    v_mfma_f32_16x16x32_bf16 a[0:3], a[228:231], v[136:139], a[0:3]
    v_exp_f32 v173, v173
    v_mfma_f32_16x16x32_bf16 a[0:3], a[224:227], v[100:103], a[0:3]
    v_exp_f32 v174, v174
    v_mfma_f32_16x16x32_bf16 a[32:35], a[224:227], v[108:111], a[32:35]
    v_exp_f32 v175, v175
    v_mfma_f32_16x16x32_bf16 a[32:35], a[228:231], v[144:147], a[32:35]
    ds_read_b128 a[212:215], v189 offset:32768
    v_cvt_pk_bf16_f32 v169, v170, v171
    v_mfma_f32_16x16x32_bf16 a[48:51], a[236:239], v[144:147], a[48:51]
    ds_read_b128 a[216:219], v188 offset:40960
    v_cvt_pk_bf16_f32 v170, v172, v173
    v_mfma_f32_16x16x32_bf16 a[48:51], a[232:235], v[108:111], a[48:51]
    ds_read_b128 a[220:223], v189 offset:40960
    v_cvt_pk_bf16_f32 v171, v174, v175
    v_mfma_f32_16x16x32_bf16 a[80:83], a[232:235], v[116:119], a[80:83]
    v_exp_f32 v176, v176
    v_mfma_f32_16x16x32_bf16 a[80:83], a[236:239], v[152:155], a[80:83]
    v_exp_f32 v177, v177
    v_mfma_f32_16x16x32_bf16 a[64:67], a[228:231], v[152:155], a[64:67]
    v_exp_f32 v178, v178
    v_mfma_f32_16x16x32_bf16 a[64:67], a[224:227], v[116:119], a[64:67]
    v_exp_f32 v179, v179
    v_mfma_f32_16x16x32_bf16 a[176:179], v[244:247], v[116:119], a[176:179]
    v_add_f32 v185, v185, v176
    v_add_f32 v185, v185, v177
    v_mfma_f32_16x16x32_bf16 a[176:179], v[244:247], v[152:155], a[176:179]
    v_add_f32 v185, v185, v178
    v_add_f32 v185, v185, v179
    v_mfma_f32_16x16x32_bf16 a[96:99], a[224:227], v[124:127], a[96:99]
    v_exp_f32 v96, v96
    v_mfma_f32_16x16x32_bf16 a[96:99], a[228:231], v[160:163], a[96:99]
    v_cvt_pk_bf16_f32 v176, v176, v177
    v_add_f32 v180, v180, v96
    v_mfma_f32_16x16x32_bf16 a[112:115], a[236:239], v[160:163], a[112:115]
    v_exp_f32 v97, v97
    v_mfma_f32_16x16x32_bf16 a[112:115], a[232:235], v[124:127], a[112:115]
    v_cvt_pk_bf16_f32 v177, v178, v179
    v_add_f32 v180, v180, v97
    v_mfma_f32_16x16x32_bf16 a[180:183], v[244:247], v[124:127], a[180:183]
    v_exp_f32 v98, v98
    v_mfma_f32_16x16x32_bf16 a[180:183], v[244:247], v[160:163], a[180:183]
    v_exp_f32 v99, v99
    v_mfma_f32_16x16x32_bf16 a[144:147], a[232:235], v[132:135], a[144:147]
    ds_read_b64_tr_b16 a[232:233], v196 offset:16896
    v_add_f32 v180, v180, v98
    v_mfma_f32_16x16x32_bf16 a[144:147], a[236:239], v[168:171], a[144:147]
    ds_read_b64_tr_b16 a[236:237], v204 offset:16896
    v_add_f32 v180, v180, v99
    v_mfma_f32_16x16x32_bf16 a[128:131], a[228:231], v[168:171], a[128:131]
    ds_read_b64_tr_b16 a[228:229], v204 offset:16384
    v_cvt_pk_bf16_f32 v96, v96, v97
    v_mfma_f32_16x16x32_bf16 a[128:131], a[224:227], v[132:135], a[128:131]
    ds_read_b64_tr_b16 a[224:225], v196 offset:16384
    v_cvt_pk_bf16_f32 v97, v98, v99
    v_mfma_f32_16x16x32_bf16 a[184:187], v[244:247], v[132:135], a[184:187]
    v_exp_f32 v104, v104
    v_mfma_f32_16x16x32_bf16 a[184:187], v[244:247], v[168:171], a[184:187]
    ds_read_b64_tr_b16 a[226:227], v200 offset:16384
    v_add_f32 v181, v181, v104
    v_mfma_f32_16x16x32_bf16 a[132:135], a[240:243], v[132:135], a[132:135]
    v_exp_f32 v105, v105
    v_mfma_f32_16x16x32_bf16 a[132:135], a[244:247], v[168:171], a[132:135]
    ds_read_b64_tr_b16 a[230:231], v208 offset:16384
    v_add_f32 v181, v181, v105
    v_mfma_f32_16x16x32_bf16 a[148:151], a[252:255], v[168:171], a[148:151]
    ds_read_b64_tr_b16 a[238:239], v208 offset:16896
    v_cvt_pk_bf16_f32 v104, v104, v105
    v_mfma_f32_16x16x32_bf16 a[148:151], a[248:251], v[132:135], a[148:151]
    v_exp_f32 v106, v106
    v_mfma_f32_16x16x32_bf16 a[116:119], a[248:251], v[124:127], a[116:119]
    ds_read_b64_tr_b16 a[234:235], v200 offset:16896
    v_add_f32 v181, v181, v106
    v_mfma_f32_16x16x32_bf16 a[116:119], a[252:255], v[160:163], a[116:119]
    v_exp_f32 v107, v107
    v_mfma_f32_16x16x32_bf16 a[100:103], a[244:247], v[160:163], a[100:103]
    ds_read_b128 a[192:195], v190 offset:32768
    v_add_f32 v181, v181, v107
    v_mfma_f32_16x16x32_bf16 a[100:103], a[240:243], v[124:127], a[100:103]
    ds_read_b128 a[196:199], v191 offset:32768
    v_cvt_pk_bf16_f32 v105, v106, v107
    v_mfma_f32_16x16x32_bf16 a[68:71], a[240:243], v[116:119], a[68:71]
    v_exp_f32 v112, v112
    v_mfma_f32_16x16x32_bf16 a[68:71], a[244:247], v[152:155], a[68:71]
    v_exp_f32 v113, v113
    v_mfma_f32_16x16x32_bf16 a[84:87], a[252:255], v[152:155], a[84:87]
    ds_read_b128 a[200:203], v190 offset:40960
    v_cvt_pk_bf16_f32 v112, v112, v113
    v_mfma_f32_16x16x32_bf16 a[84:87], a[248:251], v[116:119], a[84:87]
    v_exp_f32 v114, v114
    v_mfma_f32_16x16x32_bf16 a[52:55], a[248:251], v[108:111], a[52:55]
    v_exp_f32 v115, v115
    v_mfma_f32_16x16x32_bf16 a[52:55], a[252:255], v[144:147], a[52:55]
    ds_read_b128 a[204:207], v191 offset:40960
    v_cvt_pk_bf16_f32 v113, v114, v115
    v_mfma_f32_16x16x32_bf16 a[36:39], a[244:247], v[144:147], a[36:39]
    v_exp_f32 v120, v120
    v_mfma_f32_16x16x32_bf16 a[36:39], a[240:243], v[108:111], a[36:39]
    v_exp_f32 v121, v121
    v_mfma_f32_16x16x32_bf16 a[4:7], a[240:243], v[100:103], a[4:7]
    ds_read_b64_tr_b16 a[240:241], v197 offset:16384
    v_cvt_pk_bf16_f32 v120, v120, v121
    v_mfma_f32_16x16x32_bf16 a[4:7], a[244:247], v[136:139], a[4:7]
    v_exp_f32 v122, v122
    v_mfma_f32_16x16x32_bf16 a[20:23], a[252:255], v[136:139], a[20:23]
    v_exp_f32 v123, v123
    v_mfma_f32_16x16x32_bf16 a[20:23], a[248:251], v[100:103], a[20:23]
    s_waitcnt lgkmcnt(5)
    ds_read_b64_tr_b16 a[242:243], v201 offset:16384
    v_cvt_pk_bf16_f32 v121, v122, v123
    v_mfma_f32_16x16x32_bf16 v[140:143], a[208:211], v[0:3], 0
    v_exp_f32 v128, v128
    v_mfma_f32_16x16x32_bf16 v[140:143], a[212:215], v[4:7], v[140:143]
    v_exp_f32 v129, v129
    v_mfma_f32_16x16x32_bf16 v[140:143], a[216:219], v[8:11], v[140:143]
    ds_read_b64_tr_b16 a[244:245], v205 offset:16384
    v_cvt_pk_bf16_f32 v128, v128, v129
    v_mfma_f32_16x16x32_bf16 v[140:143], a[220:223], v[12:15], v[140:143]
    v_exp_f32 v130, v130
    v_mfma_f32_16x16x32_bf16 v[148:151], a[220:223], v[28:31], 0
    v_exp_f32 v131, v131
    v_mfma_f32_16x16x32_bf16 v[148:151], a[216:219], v[24:27], v[148:151]
    ds_read_b64_tr_b16 a[246:247], v209 offset:16384
    v_cvt_pk_bf16_f32 v129, v130, v131
    v_mfma_f32_16x16x32_bf16 v[148:151], a[212:215], v[20:23], v[148:151]
    ds_read_b64_tr_b16 a[252:253], v205 offset:16896
    v_mfma_f32_16x16x32_bf16 v[148:151], a[208:211], v[16:19], v[148:151]
    ds_read_b64_tr_b16 a[254:255], v209 offset:16896
    v_mfma_f32_16x16x32_bf16 v[156:159], a[208:211], v[32:35], 0
    ds_read_b64_tr_b16 a[248:249], v197 offset:16896
    v_mfma_f32_16x16x32_bf16 v[156:159], a[212:215], v[36:39], v[156:159]
    ds_read_b64_tr_b16 a[250:251], v201 offset:16896
    v_mfma_f32_16x16x32_bf16 v[156:159], a[216:219], v[40:43], v[156:159]
    ds_write2st64_b64 v220, v[176:177], v[176:177] offset0:0 offset1:2
    v_mfma_f32_16x16x32_bf16 v[156:159], a[220:223], v[44:47], v[156:159]
    v_exp_f32 v140, v140
    v_mfma_f32_16x16x32_bf16 v[164:167], a[220:223], v[60:63], 0
    v_exp_f32 v141, v141
    v_mfma_f32_16x16x32_bf16 v[164:167], a[216:219], v[56:59], v[164:167]
    v_exp_f32 v142, v142
    v_mfma_f32_16x16x32_bf16 v[164:167], a[212:215], v[52:55], v[164:167]
    v_exp_f32 v143, v143
    v_mfma_f32_16x16x32_bf16 v[164:167], a[208:211], v[48:51], v[164:167]
    v_add_f32 v180, v180, v140
    v_add_f32 v180, v180, v141
    v_mfma_f32_16x16x32_bf16 v[172:175], a[208:211], v[64:67], 0
    ds_read_b128 a[208:211], v192 offset:32768
    v_add_f32 v180, v180, v142
    v_mfma_f32_16x16x32_bf16 v[172:175], a[212:215], v[68:71], v[172:175]
    ds_read_b128 a[212:215], v193 offset:32768
    v_add_f32 v180, v180, v143
    v_mfma_f32_16x16x32_bf16 v[172:175], a[216:219], v[72:75], v[172:175]
    ds_read_b128 a[216:219], v192 offset:40960
    v_cvt_pk_bf16_f32 v98, v140, v141
    v_mfma_f32_16x16x32_bf16 v[172:175], a[220:223], v[76:79], v[172:175]
    ds_read_b128 a[220:223], v193 offset:40960
    v_cvt_pk_bf16_f32 v99, v142, v143
    v_mfma_f32_16x16x32_bf16 a[8:11], a[224:227], v[100:103], a[8:11]
    v_exp_f32 v148, v148
    v_mfma_f32_16x16x32_bf16 a[8:11], a[228:231], v[136:139], a[8:11]
    v_exp_f32 v149, v149
    v_mfma_f32_16x16x32_bf16 a[24:27], a[236:239], v[136:139], a[24:27]
    v_exp_f32 v150, v150
    v_mfma_f32_16x16x32_bf16 a[24:27], a[232:235], v[100:103], a[24:27]
    v_exp_f32 v151, v151
    v_mfma_f32_16x16x32_bf16 a[56:59], a[232:235], v[108:111], a[56:59]
    v_add_f32 v181, v181, v148
    v_add_f32 v181, v181, v149
    v_mfma_f32_16x16x32_bf16 a[56:59], a[236:239], v[144:147], a[56:59]
    v_add_f32 v181, v181, v150
    v_add_f32 v181, v181, v151
    v_mfma_f32_16x16x32_bf16 a[40:43], a[228:231], v[144:147], a[40:43]
    v_exp_f32 v156, v156
    v_mfma_f32_16x16x32_bf16 a[40:43], a[224:227], v[108:111], a[40:43]
    v_exp_f32 v157, v157
    v_mfma_f32_16x16x32_bf16 a[72:75], a[224:227], v[116:119], a[72:75]
    v_cvt_pk_bf16_f32 v106, v148, v149
    v_cvt_pk_bf16_f32 v114, v156, v157
    v_mfma_f32_16x16x32_bf16 a[72:75], a[228:231], v[152:155], a[72:75]
    v_exp_f32 v158, v158
    v_mfma_f32_16x16x32_bf16 a[88:91], a[236:239], v[152:155], a[88:91]
    v_exp_f32 v159, v159
    v_mfma_f32_16x16x32_bf16 a[88:91], a[232:235], v[116:119], a[88:91]
    v_cvt_pk_bf16_f32 v107, v150, v151
    v_cvt_pk_bf16_f32 v115, v158, v159
    v_mfma_f32_16x16x32_bf16 a[120:123], a[232:235], v[124:127], a[120:123]
    v_exp_f32 v164, v164
    v_mfma_f32_16x16x32_bf16 a[120:123], a[236:239], v[160:163], a[120:123]
    v_exp_f32 v165, v165
    v_mfma_f32_16x16x32_bf16 a[104:107], a[228:231], v[160:163], a[104:107]
    v_exp_f32 v166, v166
    v_mfma_f32_16x16x32_bf16 a[104:107], a[224:227], v[124:127], a[104:107]
    v_exp_f32 v167, v167
    v_mfma_f32_16x16x32_bf16 a[136:139], a[224:227], v[132:135], a[136:139]
    v_exp_f32 v172, v172
    v_mfma_f32_16x16x32_bf16 a[136:139], a[228:231], v[168:171], a[136:139]
    v_exp_f32 v173, v173
    v_mfma_f32_16x16x32_bf16 a[152:155], a[236:239], v[168:171], a[152:155]
    v_cvt_pk_bf16_f32 v122, v164, v165
    v_cvt_pk_bf16_f32 v130, v172, v173
    v_mfma_f32_16x16x32_bf16 a[152:155], a[232:235], v[132:135], a[152:155]
    s_waitcnt vmcnt(8) lgkmcnt(0)
    s_barrier
    v_mfma_f32_16x16x32_bf16 a[140:143], a[240:243], v[132:135], a[140:143]
    s_add_u32 m0, s25, 16384
    ds_read_b64_tr_b16 a[224:225], v194 offset:32768
    v_cvt_pk_bf16_f32 v123, v166, v167
    v_mfma_f32_16x16x32_bf16 a[140:143], a[244:247], v[168:171], a[140:143]
    v_exp_f32 v174, v174
    v_mfma_f32_16x16x32_bf16 a[156:159], a[252:255], v[168:171], a[156:159]
    v_exp_f32 v175, v175
    v_mfma_f32_16x16x32_bf16 a[156:159], a[248:251], v[132:135], a[156:159]
    ds_read_b64_tr_b16 a[226:227], v198 offset:32768
    v_cvt_pk_bf16_f32 v131, v174, v175
    v_mfma_f32_16x16x32_bf16 a[124:127], a[248:251], v[124:127], a[124:127]
    ds_read_b64_tr_b16 a[228:229], v202 offset:32768
    v_mfma_f32_16x16x32_bf16 a[124:127], a[252:255], v[160:163], a[124:127]
    buffer_load_dwordx4 v214, s[12:15], s21 offen offset:0 nt lds
    v_mfma_f32_16x16x32_bf16 a[108:111], a[244:247], v[160:163], a[108:111]
    ds_read_b64_tr_b16 a[230:231], v206 offset:32768
    v_mfma_f32_16x16x32_bf16 a[108:111], a[240:243], v[124:127], a[108:111]
    ds_read_b64_tr_b16 a[236:237], v202 offset:33280
    v_mfma_f32_16x16x32_bf16 a[76:79], a[240:243], v[116:119], a[76:79]
    ds_read_b64_tr_b16 a[238:239], v206 offset:33280
    v_mfma_f32_16x16x32_bf16 a[76:79], a[244:247], v[152:155], a[76:79]
    ds_read_b64_tr_b16 a[232:233], v194 offset:33280
    v_mfma_f32_16x16x32_bf16 a[92:95], a[252:255], v[152:155], a[92:95]
    buffer_load_dwordx4 v215, s[12:15], s21 offen offset:1024 nt lds
    v_mfma_f32_16x16x32_bf16 a[92:95], a[248:251], v[116:119], a[92:95]
    ds_read_b64_tr_b16 a[234:235], v198 offset:33280
    v_mfma_f32_16x16x32_bf16 a[60:63], a[248:251], v[108:111], a[60:63]
    ds_read2st64_b64 a[168:171], v220 offset0:0 offset1:1
    v_mfma_f32_16x16x32_bf16 a[60:63], a[252:255], v[144:147], a[60:63]
    ds_read2st64_b64 a[172:175], v221 offset0:0 offset1:1
    v_mfma_f32_16x16x32_bf16 a[44:47], a[244:247], v[144:147], a[44:47]
    v_mfma_f32_16x16x32_bf16 a[44:47], a[240:243], v[108:111], a[44:47]
    buffer_load_dwordx4 v214, s[12:15], s21 offen offset:2048 nt lds
    v_mfma_f32_16x16x32_bf16 a[12:15], a[240:243], v[100:103], a[12:15]
    ds_read_b64_tr_b16 a[240:241], v195 offset:32768
    v_mfma_f32_16x16x32_bf16 a[12:15], a[244:247], v[136:139], a[12:15]
    ds_read_b64_tr_b16 a[242:243], v199 offset:32768
    v_mfma_f32_16x16x32_bf16 a[28:31], a[252:255], v[136:139], a[28:31]
    ds_read_b64_tr_b16 a[244:245], v203 offset:32768
    v_mfma_f32_16x16x32_bf16 a[28:31], a[248:251], v[100:103], a[28:31]
    ds_read_b64_tr_b16 a[246:247], v207 offset:32768
    v_mfma_f32_16x16x32_bf16 v[136:139], a[192:195], v[0:3], 0
    buffer_load_dwordx4 v215, s[12:15], s21 offen offset:3072 nt lds
    v_mfma_f32_16x16x32_bf16 v[136:139], a[196:199], v[4:7], v[136:139]
    ds_read_b64_tr_b16 a[252:253], v203 offset:33280
    v_mfma_f32_16x16x32_bf16 v[136:139], a[200:203], v[8:11], v[136:139]
    ds_read_b64_tr_b16 a[254:255], v207 offset:33280
    v_mfma_f32_16x16x32_bf16 v[136:139], a[204:207], v[12:15], v[136:139]
    ds_read_b64_tr_b16 a[248:249], v195 offset:33280
    v_mfma_f32_16x16x32_bf16 v[144:147], a[204:207], v[28:31], 0
    ds_read_b64_tr_b16 a[250:251], v199 offset:33280
    v_mfma_f32_16x16x32_bf16 v[144:147], a[200:203], v[24:27], v[144:147]
    s_add_u32 m0, s24, 16384
    v_mfma_f32_16x16x32_bf16 v[144:147], a[196:199], v[20:23], v[144:147]
    v_mfma_f32_16x16x32_bf16 v[144:147], a[192:195], v[16:19], v[144:147]
    v_mfma_f32_16x16x32_bf16 v[152:155], a[192:195], v[32:35], 0
    v_mfma_f32_16x16x32_bf16 v[152:155], a[196:199], v[36:39], v[152:155]
    v_mfma_f32_16x16x32_bf16 v[152:155], a[200:203], v[40:43], v[152:155]
    buffer_load_dwordx4 v210, s[8:11], s21 offen offset:0 nt lds
    v_mfma_f32_16x16x32_bf16 v[152:155], a[204:207], v[44:47], v[152:155]
    v_exp_f32 v136, v136
    v_mfma_f32_16x16x32_bf16 v[160:163], a[204:207], v[60:63], 0
    v_exp_f32 v137, v137
    v_mfma_f32_16x16x32_bf16 v[160:163], a[200:203], v[56:59], v[160:163]
    v_exp_f32 v138, v138
    v_mfma_f32_16x16x32_bf16 v[160:163], a[196:199], v[52:55], v[160:163]
    v_exp_f32 v139, v139
    v_mfma_f32_16x16x32_bf16 v[160:163], a[192:195], v[48:51], v[160:163]
    buffer_load_dwordx4 v211, s[8:11], s21 offen offset:1024 nt lds
    v_mfma_f32_16x16x32_bf16 v[168:171], a[192:195], v[64:67], 0
    ds_read_b128 a[192:195], v186 offset:49152
    v_add_f32 v180, v180, v136
    v_mfma_f32_16x16x32_bf16 v[168:171], a[196:199], v[68:71], v[168:171]
    ds_read_b128 a[196:199], v187 offset:49152
    v_add_f32 v180, v180, v137
    v_mfma_f32_16x16x32_bf16 v[168:171], a[200:203], v[72:75], v[168:171]
    ds_read_b128 a[200:203], v186 offset:57344
    v_add_f32 v180, v180, v138
    v_mfma_f32_16x16x32_bf16 v[168:171], a[204:207], v[76:79], v[168:171]
    ds_read_b128 a[204:207], v187 offset:57344
    v_add_f32 v180, v180, v139
    v_mfma_f32_16x16x32_bf16 v[140:143], a[208:211], v[0:3], 0
    buffer_load_dwordx4 v212, s[8:11], s21 offen offset:2048 nt lds
    v_mfma_f32_16x16x32_bf16 v[140:143], a[212:215], v[4:7], v[140:143]
    v_exp_f32 v144, v144
    v_mfma_f32_16x16x32_bf16 v[140:143], a[216:219], v[8:11], v[140:143]
    v_cvt_pk_bf16_f32 v136, v136, v137
    v_add_f32 v181, v181, v144
    v_mfma_f32_16x16x32_bf16 v[140:143], a[220:223], v[12:15], v[140:143]
    v_exp_f32 v145, v145
    v_mfma_f32_16x16x32_bf16 v[148:151], a[220:223], v[28:31], 0
    v_cvt_pk_bf16_f32 v137, v138, v139
    v_add_f32 v181, v181, v145
    v_mfma_f32_16x16x32_bf16 v[148:151], a[216:219], v[24:27], v[148:151]
    buffer_load_dwordx4 v213, s[8:11], s21 offen offset:3072 nt lds
    v_mfma_f32_16x16x32_bf16 v[148:151], a[212:215], v[20:23], v[148:151]
    v_exp_f32 v146, v146
    v_mfma_f32_16x16x32_bf16 v[148:151], a[208:211], v[16:19], v[148:151]
    v_exp_f32 v147, v147
    v_mfma_f32_16x16x32_bf16 v[156:159], a[208:211], v[32:35], 0
    v_add_f32 v181, v181, v146
    v_add_f32 v181, v181, v147
    v_mfma_f32_16x16x32_bf16 v[156:159], a[212:215], v[36:39], v[156:159]
    v_exp_f32 v152, v152
    v_mfma_f32_16x16x32_bf16 v[156:159], a[216:219], v[40:43], v[156:159]
    s_add_u32 s21, s21, 16384
    v_exp_f32 v153, v153
    v_mfma_f32_16x16x32_bf16 v[156:159], a[220:223], v[44:47], v[156:159]
    v_exp_f32 v140, v140
    v_mfma_f32_16x16x32_bf16 v[164:167], a[220:223], v[60:63], 0
    v_exp_f32 v141, v141
    v_mfma_f32_16x16x32_bf16 v[164:167], a[216:219], v[56:59], v[164:167]
    v_exp_f32 v142, v142
    v_mfma_f32_16x16x32_bf16 v[164:167], a[212:215], v[52:55], v[164:167]
    v_exp_f32 v143, v143
    v_mfma_f32_16x16x32_bf16 v[164:167], a[208:211], v[48:51], v[164:167]
    v_add_f32 v180, v180, v140
    v_add_f32 v180, v180, v141
    v_mfma_f32_16x16x32_bf16 v[172:175], a[208:211], v[64:67], 0
    v_add_f32 v180, v180, v142
    v_add_f32 v180, v180, v143
    v_mfma_f32_16x16x32_bf16 v[172:175], a[212:215], v[68:71], v[172:175]
    v_cvt_pk_bf16_f32 v138, v140, v141
    v_cvt_pk_bf16_f32 v144, v144, v145
    v_mfma_f32_16x16x32_bf16 v[172:175], a[216:219], v[72:75], v[172:175]
    v_cvt_pk_bf16_f32 v139, v142, v143
    v_cvt_pk_bf16_f32 v145, v146, v147
    v_mfma_f32_16x16x32_bf16 v[172:175], a[220:223], v[76:79], v[172:175]
    v_exp_f32 v148, v148
    s_sub_u32 s23, s23, 1
    s_cmp_lg_u32 s23, 0
    s_cbranch_scc1 L_loop
L_r2:
    s_waitcnt lgkmcnt(0)
    v_mfma_f32_16x16x32_bf16 v[100:103], a[192:195], v[0:3], 0
    v_exp_f32 v149, v149
    v_mfma_f32_16x16x32_bf16 v[100:103], a[196:199], v[4:7], v[100:103]
    v_exp_f32 v150, v150
    v_mfma_f32_16x16x32_bf16 v[100:103], a[200:203], v[8:11], v[100:103]
    v_exp_f32 v151, v151
    v_mfma_f32_16x16x32_bf16 v[100:103], a[204:207], v[12:15], v[100:103]
    v_exp_f32 v154, v154
    v_mfma_f32_16x16x32_bf16 v[108:111], a[204:207], v[28:31], 0
    v_exp_f32 v155, v155
    v_mfma_f32_16x16x32_bf16 v[108:111], a[200:203], v[24:27], v[108:111]
    v_add_f32 v181, v181, v148
    v_add_f32 v181, v181, v149
    v_mfma_f32_16x16x32_bf16 v[108:111], a[196:199], v[20:23], v[108:111]
    v_add_f32 v181, v181, v150
    v_add_f32 v181, v181, v151
    v_mfma_f32_16x16x32_bf16 v[108:111], a[192:195], v[16:19], v[108:111]
    v_cvt_pk_bf16_f32 v146, v148, v149
    v_cvt_pk_bf16_f32 v152, v152, v153
    v_mfma_f32_16x16x32_bf16 v[176:179], a[204:207], v[92:95], 0
    v_cvt_pk_bf16_f32 v147, v150, v151
    v_cvt_pk_bf16_f32 v153, v154, v155
    v_mfma_f32_16x16x32_bf16 v[176:179], a[200:203], v[88:91], v[176:179]
    v_exp_f32 v156, v156
    v_mfma_f32_16x16x32_bf16 v[176:179], a[196:199], v[84:87], v[176:179]
    v_exp_f32 v157, v157
    v_mfma_f32_16x16x32_bf16 v[176:179], a[192:195], v[80:83], v[176:179]
    v_exp_f32 v158, v158
    v_mfma_f32_16x16x32_bf16 a[160:163], a[224:227], a[168:171], a[160:163]
    v_exp_f32 v159, v159
    v_mfma_f32_16x16x32_bf16 a[160:163], a[228:231], a[172:175], a[160:163]
    ds_read_b128 a[208:211], v188 offset:49152
    v_cvt_pk_bf16_f32 v154, v156, v157
    v_mfma_f32_16x16x32_bf16 a[164:167], a[236:239], a[172:175], a[164:167]
    v_exp_f32 v160, v160
    v_mfma_f32_16x16x32_bf16 a[164:167], a[232:235], a[168:171], a[164:167]
    v_exp_f32 v161, v161
    v_mfma_f32_16x16x32_bf16 a[16:19], a[232:235], v[96:99], a[16:19]
    v_exp_f32 v162, v162
    v_mfma_f32_16x16x32_bf16 a[16:19], a[236:239], v[136:139], a[16:19]
    v_exp_f32 v163, v163
    v_mfma_f32_16x16x32_bf16 a[0:3], a[228:231], v[136:139], a[0:3]
    v_cvt_pk_bf16_f32 v155, v158, v159
    v_cvt_pk_bf16_f32 v160, v160, v161
    v_mfma_f32_16x16x32_bf16 a[0:3], a[224:227], v[96:99], a[0:3]
    v_exp_f32 v164, v164
    v_mfma_f32_16x16x32_bf16 a[32:35], a[224:227], v[104:107], a[32:35]
    v_exp_f32 v165, v165
    v_mfma_f32_16x16x32_bf16 a[32:35], a[228:231], v[144:147], a[32:35]
    v_exp_f32 v166, v166
    v_mfma_f32_16x16x32_bf16 a[48:51], a[236:239], v[144:147], a[48:51]
    v_exp_f32 v167, v167
    v_mfma_f32_16x16x32_bf16 a[48:51], a[232:235], v[104:107], a[48:51]
    ds_read_b128 a[212:215], v189 offset:49152
    v_cvt_pk_bf16_f32 v161, v162, v163
    v_mfma_f32_16x16x32_bf16 a[80:83], a[232:235], v[112:115], a[80:83]
    ds_read_b128 a[216:219], v188 offset:57344
    v_cvt_pk_bf16_f32 v162, v164, v165
    v_mfma_f32_16x16x32_bf16 a[80:83], a[236:239], v[152:155], a[80:83]
    v_exp_f32 v168, v168
    v_mfma_f32_16x16x32_bf16 a[64:67], a[228:231], v[152:155], a[64:67]
    v_exp_f32 v169, v169
    v_mfma_f32_16x16x32_bf16 a[64:67], a[224:227], v[112:115], a[64:67]
    v_exp_f32 v170, v170
    v_mfma_f32_16x16x32_bf16 a[176:179], v[244:247], v[112:115], a[176:179]
    v_exp_f32 v171, v171
    v_cvt_pk_bf16_f32 v163, v166, v167
    v_mfma_f32_16x16x32_bf16 a[176:179], v[244:247], v[152:155], a[176:179]
    v_exp_f32 v172, v172
    v_mfma_f32_16x16x32_bf16 a[96:99], a[224:227], v[120:123], a[96:99]
    v_exp_f32 v173, v173
    v_exp_f32 v174, v174
    v_exp_f32 v175, v175
    v_mfma_f32_16x16x32_bf16 a[96:99], a[228:231], v[160:163], a[96:99]
    ds_read_b128 a[220:223], v189 offset:57344
    v_cvt_pk_bf16_f32 v168, v168, v169
    v_mfma_f32_16x16x32_bf16 a[112:115], a[236:239], v[160:163], a[112:115]
    ds_read_b128 a[192:195], v190 offset:49152
    v_cvt_pk_bf16_f32 v169, v170, v171
    v_mfma_f32_16x16x32_bf16 a[112:115], a[232:235], v[120:123], a[112:115]
    ds_read_b128 a[196:199], v191 offset:49152
    v_cvt_pk_bf16_f32 v170, v172, v173
    v_mfma_f32_16x16x32_bf16 a[180:183], v[244:247], v[120:123], a[180:183]
    ds_read_b128 a[200:203], v190 offset:57344
    v_cvt_pk_bf16_f32 v171, v174, v175
    v_mfma_f32_16x16x32_bf16 a[180:183], v[244:247], v[160:163], a[180:183]
    v_exp_f32 v176, v176
    v_mfma_f32_16x16x32_bf16 a[144:147], a[232:235], v[128:131], a[144:147]
    ds_read_b64_tr_b16 a[232:233], v196 offset:33280
    v_add_f32 v185, v185, v176
    v_mfma_f32_16x16x32_bf16 a[144:147], a[236:239], v[168:171], a[144:147]
    v_exp_f32 v177, v177
    v_mfma_f32_16x16x32_bf16 a[128:131], a[228:231], v[168:171], a[128:131]
    ds_read_b64_tr_b16 a[228:229], v204 offset:32768
    v_add_f32 v185, v185, v177
    v_mfma_f32_16x16x32_bf16 a[128:131], a[224:227], v[128:131], a[128:131]
    ds_read_b64_tr_b16 a[224:225], v196 offset:32768
    v_cvt_pk_bf16_f32 v176, v176, v177
    v_mfma_f32_16x16x32_bf16 a[184:187], v[244:247], v[128:131], a[184:187]
    v_exp_f32 v178, v178
    v_mfma_f32_16x16x32_bf16 a[184:187], v[244:247], v[168:171], a[184:187]
    ds_read_b64_tr_b16 a[226:227], v200 offset:32768
    v_add_f32 v185, v185, v178
    v_mfma_f32_16x16x32_bf16 a[132:135], a[240:243], v[128:131], a[132:135]
    v_exp_f32 v179, v179
    v_mfma_f32_16x16x32_bf16 a[132:135], a[244:247], v[168:171], a[132:135]
    ds_read_b64_tr_b16 a[230:231], v208 offset:32768
    v_add_f32 v185, v185, v179
    v_mfma_f32_16x16x32_bf16 a[148:151], a[252:255], v[168:171], a[148:151]
    ds_read_b64_tr_b16 a[236:237], v204 offset:33280
    v_cvt_pk_bf16_f32 v177, v178, v179
    v_mfma_f32_16x16x32_bf16 a[148:151], a[248:251], v[128:131], a[148:151]
    v_exp_f32 v100, v100
    v_mfma_f32_16x16x32_bf16 a[116:119], a[248:251], v[120:123], a[116:119]
    ds_read_b64_tr_b16 a[238:239], v208 offset:33280
    v_add_f32 v180, v180, v100
    v_mfma_f32_16x16x32_bf16 a[116:119], a[252:255], v[160:163], a[116:119]
    v_exp_f32 v101, v101
    v_mfma_f32_16x16x32_bf16 a[100:103], a[244:247], v[160:163], a[100:103]
    ds_read_b64_tr_b16 a[234:235], v200 offset:33280
    v_add_f32 v180, v180, v101
    v_mfma_f32_16x16x32_bf16 a[100:103], a[240:243], v[120:123], a[100:103]
    ds_read_b128 a[204:207], v191 offset:57344
    v_cvt_pk_bf16_f32 v100, v100, v101
    v_mfma_f32_16x16x32_bf16 a[68:71], a[240:243], v[112:115], a[68:71]
    v_exp_f32 v102, v102
    v_mfma_f32_16x16x32_bf16 a[68:71], a[244:247], v[152:155], a[68:71]
    ds_write2st64_b64 v220, v[176:177], v[176:177] offset0:8 offset1:10
    v_add_f32 v180, v180, v102
    v_mfma_f32_16x16x32_bf16 a[84:87], a[252:255], v[152:155], a[84:87]
    v_exp_f32 v103, v103
    v_mfma_f32_16x16x32_bf16 a[84:87], a[248:251], v[112:115], a[84:87]
    v_exp_f32 v108, v108
    v_mfma_f32_16x16x32_bf16 a[52:55], a[248:251], v[104:107], a[52:55]
    v_add_f32 v180, v180, v103
    v_add_f32 v181, v181, v108
    v_mfma_f32_16x16x32_bf16 a[52:55], a[252:255], v[144:147], a[52:55]
    v_exp_f32 v109, v109
    v_mfma_f32_16x16x32_bf16 a[36:39], a[244:247], v[144:147], a[36:39]
    v_cvt_pk_bf16_f32 v101, v102, v103
    v_add_f32 v181, v181, v109
    v_mfma_f32_16x16x32_bf16 a[36:39], a[240:243], v[104:107], a[36:39]
    v_exp_f32 v110, v110
    v_mfma_f32_16x16x32_bf16 a[4:7], a[240:243], v[96:99], a[4:7]
    ds_read_b64_tr_b16 a[240:241], v197 offset:32768
    v_add_f32 v181, v181, v110
    v_mfma_f32_16x16x32_bf16 a[4:7], a[244:247], v[136:139], a[4:7]
    ds_read_b64_tr_b16 a[242:243], v201 offset:32768
    v_cvt_pk_bf16_f32 v108, v108, v109
    v_mfma_f32_16x16x32_bf16 a[20:23], a[252:255], v[136:139], a[20:23]
    v_exp_f32 v111, v111
    v_mfma_f32_16x16x32_bf16 a[20:23], a[248:251], v[96:99], a[20:23]
    s_waitcnt lgkmcnt(4)
    ds_read_b64_tr_b16 a[244:245], v205 offset:32768
    v_add_f32 v181, v181, v111
    v_mfma_f32_16x16x32_bf16 v[140:143], a[208:211], v[0:3], 0
    ds_read_b64_tr_b16 a[246:247], v209 offset:32768
    v_cvt_pk_bf16_f32 v109, v110, v111
    v_mfma_f32_16x16x32_bf16 v[140:143], a[212:215], v[4:7], v[140:143]
    ds_read_b64_tr_b16 a[252:253], v205 offset:33280
    v_mfma_f32_16x16x32_bf16 v[140:143], a[216:219], v[8:11], v[140:143]
    ds_read_b64_tr_b16 a[254:255], v209 offset:33280
    v_mfma_f32_16x16x32_bf16 v[140:143], a[220:223], v[12:15], v[140:143]
    ds_read_b64_tr_b16 a[248:249], v197 offset:33280
    v_mfma_f32_16x16x32_bf16 v[148:151], a[220:223], v[28:31], 0
    ds_read_b128 a[220:223], v193 offset:57344
    v_mfma_f32_16x16x32_bf16 v[148:151], a[216:219], v[24:27], v[148:151]
    ds_read_b128 a[216:219], v192 offset:57344
    v_mfma_f32_16x16x32_bf16 v[148:151], a[212:215], v[20:23], v[148:151]
    ds_read_b128 a[212:215], v193 offset:49152
    v_mfma_f32_16x16x32_bf16 v[148:151], a[208:211], v[16:19], v[148:151]
    ds_read_b128 a[208:211], v192 offset:49152
    v_mfma_f32_16x16x32_bf16 a[8:11], a[224:227], v[96:99], a[8:11]
    ds_read_b64_tr_b16 a[250:251], v201 offset:33280
    v_mfma_f32_16x16x32_bf16 a[8:11], a[228:231], v[136:139], a[8:11]
    v_mfma_f32_16x16x32_bf16 a[24:27], a[236:239], v[136:139], a[24:27]
    v_mfma_f32_16x16x32_bf16 a[24:27], a[232:235], v[96:99], a[24:27]
    v_exp_f32 v140, v140
    v_mfma_f32_16x16x32_bf16 a[56:59], a[232:235], v[104:107], a[56:59]
    v_exp_f32 v141, v141
    v_mfma_f32_16x16x32_bf16 a[56:59], a[236:239], v[144:147], a[56:59]
    v_exp_f32 v142, v142
    v_mfma_f32_16x16x32_bf16 a[40:43], a[228:231], v[144:147], a[40:43]
    v_exp_f32 v143, v143
    v_mfma_f32_16x16x32_bf16 a[40:43], a[224:227], v[104:107], a[40:43]
    v_add_f32 v180, v180, v140
    v_add_f32 v180, v180, v141
    v_mfma_f32_16x16x32_bf16 a[72:75], a[224:227], v[112:115], a[72:75]
    v_add_f32 v180, v180, v142
    v_add_f32 v180, v180, v143
    v_mfma_f32_16x16x32_bf16 a[72:75], a[228:231], v[152:155], a[72:75]
    v_mov_b32 v179, v185
    v_cvt_pk_bf16_f32 v102, v140, v141
    v_mfma_f32_16x16x32_bf16 a[88:91], a[236:239], v[152:155], a[88:91]
    v_permlane32_swap_b32 v185, v179
    v_cvt_pk_bf16_f32 v103, v142, v143
    v_mfma_f32_16x16x32_bf16 a[88:91], a[232:235], v[112:115], a[88:91]
    v_add_f32 v185, v185, v179
    v_mfma_f32_16x16x32_bf16 a[120:123], a[232:235], v[120:123], a[120:123]
    v_mov_b32 v179, v185
    v_mfma_f32_16x16x32_bf16 a[120:123], a[236:239], v[160:163], a[120:123]
    s_nop 0
    v_permlane16_swap_b32 v185, v179
    v_mfma_f32_16x16x32_bf16 a[104:107], a[228:231], v[160:163], a[104:107]
    v_add_f32 v185, v185, v179
    v_mfma_f32_16x16x32_bf16 a[104:107], a[224:227], v[120:123], a[104:107]
    ds_write2st64_b32 v220, v185, v185 offset0:32 offset1:36
    v_mfma_f32_16x16x32_bf16 a[136:139], a[224:227], v[128:131], a[136:139]
    v_exp_f32 v148, v148
    v_mfma_f32_16x16x32_bf16 a[136:139], a[228:231], v[168:171], a[136:139]
    ds_read_b64_tr_b16 a[224:225], v194 offset:49152
    v_add_f32 v181, v181, v148
    v_mfma_f32_16x16x32_bf16 a[152:155], a[236:239], v[168:171], a[152:155]
    v_exp_f32 v149, v149
    v_mfma_f32_16x16x32_bf16 a[152:155], a[232:235], v[128:131], a[152:155]
    s_waitcnt vmcnt(8) lgkmcnt(1)
    s_barrier
    v_mfma_f32_16x16x32_bf16 a[140:143], a[240:243], v[128:131], a[140:143]
    ds_read2st64_b32 v[176:177], v220 offset0:32 offset1:34
    ds_read2st64_b32 v[178:179], v221 offset0:32 offset1:34
    v_mfma_f32_16x16x32_bf16 a[140:143], a[244:247], v[168:171], a[140:143]
    ds_read_b64_tr_b16 a[226:227], v198 offset:49152
    v_add_f32 v181, v181, v149
    v_mfma_f32_16x16x32_bf16 a[156:159], a[252:255], v[168:171], a[156:159]
    ds_read_b64_tr_b16 a[228:229], v202 offset:49152
    v_cvt_pk_bf16_f32 v110, v148, v149
    v_mfma_f32_16x16x32_bf16 a[156:159], a[248:251], v[128:131], a[156:159]
    v_exp_f32 v150, v150
    v_mfma_f32_16x16x32_bf16 a[124:127], a[248:251], v[120:123], a[124:127]
    ds_read_b64_tr_b16 a[230:231], v206 offset:49152
    v_add_f32 v181, v181, v150
    v_mfma_f32_16x16x32_bf16 a[124:127], a[252:255], v[160:163], a[124:127]
    v_exp_f32 v151, v151
    v_mfma_f32_16x16x32_bf16 a[108:111], a[244:247], v[160:163], a[108:111]
    ds_read_b64_tr_b16 a[236:237], v202 offset:49664
    v_add_f32 v181, v181, v151
    v_mfma_f32_16x16x32_bf16 a[108:111], a[240:243], v[120:123], a[108:111]
    ds_read_b64_tr_b16 a[238:239], v206 offset:49664
    v_cvt_pk_bf16_f32 v111, v150, v151
    v_mfma_f32_16x16x32_bf16 a[76:79], a[240:243], v[112:115], a[76:79]
    ds_read_b64_tr_b16 a[232:233], v194 offset:49664
    s_waitcnt lgkmcnt(6)
    v_add_f32 v176, v176, v177
    v_mfma_f32_16x16x32_bf16 a[76:79], a[244:247], v[152:155], a[76:79]
    ds_read_b64_tr_b16 a[234:235], v198 offset:49664
    v_add_f32 v178, v178, v179
    v_mfma_f32_16x16x32_bf16 a[92:95], a[252:255], v[152:155], a[92:95]
    ds_read2st64_b64 a[168:171], v220 offset0:8 offset1:9
    v_add_f32 v185, v176, v178
    v_mfma_f32_16x16x32_bf16 a[92:95], a[248:251], v[112:115], a[92:95]
    v_rcp_f32 v176, v185
    v_mfma_f32_16x16x32_bf16 a[60:63], a[248:251], v[104:107], a[60:63]
    v_min_f32 v239, v239, v185
    v_max_f32 v240, v240, v185
    v_mfma_f32_16x16x32_bf16 a[60:63], a[252:255], v[144:147], a[60:63]
    ds_read2st64_b64 a[172:175], v221 offset0:8 offset1:9
    v_mfma_f32_16x16x32_bf16 a[44:47], a[244:247], v[144:147], a[44:47]
    v_mfma_f32_16x16x32_bf16 a[44:47], a[240:243], v[104:107], a[44:47]
    v_mfma_f32_16x16x32_bf16 a[12:15], a[240:243], v[96:99], a[12:15]
    ds_read_b64_tr_b16 a[240:241], v195 offset:49152
    v_mfma_f32_16x16x32_bf16 a[12:15], a[244:247], v[136:139], a[12:15]
    ds_read_b64_tr_b16 a[242:243], v199 offset:49152
    v_mfma_f32_16x16x32_bf16 a[28:31], a[252:255], v[136:139], a[28:31]
    ds_read_b64_tr_b16 a[244:245], v203 offset:49152
    v_mfma_f32_16x16x32_bf16 a[28:31], a[248:251], v[96:99], a[28:31]
    ds_read_b64_tr_b16 a[246:247], v207 offset:49152
    v_mfma_f32_16x16x32_bf16 v[136:139], a[192:195], v[0:3], 0
    ds_read_b64_tr_b16 a[252:253], v203 offset:49664
    v_mfma_f32_16x16x32_bf16 v[136:139], a[196:199], v[4:7], v[136:139]
    ds_read_b64_tr_b16 a[254:255], v207 offset:49664
    v_mfma_f32_16x16x32_bf16 v[136:139], a[200:203], v[8:11], v[136:139]
    ds_read_b64_tr_b16 a[248:249], v195 offset:49664
    v_mfma_f32_16x16x32_bf16 v[136:139], a[204:207], v[12:15], v[136:139]
    ds_read_b64_tr_b16 a[250:251], v199 offset:49664
    v_mfma_f32_16x16x32_bf16 v[144:147], a[204:207], v[28:31], 0
    ds_read_b128 a[204:207], v187 offset:57344
    v_mfma_f32_16x16x32_bf16 v[144:147], a[200:203], v[24:27], v[144:147]
    ds_read_b128 a[200:203], v186 offset:57344
    v_mfma_f32_16x16x32_bf16 v[144:147], a[196:199], v[20:23], v[144:147]
    ds_read_b128 a[196:199], v187 offset:49152
    v_mfma_f32_16x16x32_bf16 v[144:147], a[192:195], v[16:19], v[144:147]
    ds_read_b128 a[192:195], v186 offset:49152
    v_mfma_f32_16x16x32_bf16 v[140:143], a[208:211], v[0:3], 0
    v_mfma_f32_16x16x32_bf16 v[140:143], a[212:215], v[4:7], v[140:143]
    v_mfma_f32_16x16x32_bf16 v[140:143], a[216:219], v[8:11], v[140:143]
    v_mfma_f32_16x16x32_bf16 v[140:143], a[220:223], v[12:15], v[140:143]
    v_exp_f32 v136, v136
    v_mfma_f32_16x16x32_bf16 v[148:151], a[220:223], v[28:31], 0
    v_exp_f32 v137, v137
    v_mfma_f32_16x16x32_bf16 v[148:151], a[216:219], v[24:27], v[148:151]
    v_exp_f32 v138, v138
    v_mfma_f32_16x16x32_bf16 v[148:151], a[212:215], v[20:23], v[148:151]
    v_exp_f32 v139, v139
    v_mfma_f32_16x16x32_bf16 v[148:151], a[208:211], v[16:19], v[148:151]
    s_waitcnt lgkmcnt(0)
    v_add_f32 v180, v180, v136
    v_add_f32 v180, v180, v137
    v_mfma_f32_16x16x32_bf16 v[116:119], a[192:195], v[32:35], 0
    v_add_f32 v180, v180, v138
    v_add_f32 v180, v180, v139
    v_mfma_f32_16x16x32_bf16 v[116:119], a[196:199], v[36:39], v[116:119]
    ds_read_b128 a[208:211], v188 offset:49152
    v_cvt_pk_bf16_f32 v136, v136, v137
    v_mfma_f32_16x16x32_bf16 v[116:119], a[200:203], v[40:43], v[116:119]
    ds_read_b128 a[212:215], v189 offset:49152
    v_cvt_pk_bf16_f32 v137, v138, v139
    v_mfma_f32_16x16x32_bf16 v[116:119], a[204:207], v[44:47], v[116:119]
    v_exp_f32 v140, v140
    v_mfma_f32_16x16x32_bf16 v[124:127], a[204:207], v[60:63], 0
    v_exp_f32 v141, v141
    v_mfma_f32_16x16x32_bf16 v[124:127], a[200:203], v[56:59], v[124:127]
    v_exp_f32 v142, v142
    v_mfma_f32_16x16x32_bf16 v[124:127], a[196:199], v[52:55], v[124:127]
    v_exp_f32 v143, v143
    v_mfma_f32_16x16x32_bf16 v[124:127], a[192:195], v[48:51], v[124:127]
    v_exp_f32 v144, v144
    v_add_f32 v180, v180, v140
    v_mfma_f32_16x16x32_bf16 v[132:135], a[192:195], v[64:67], 0
    v_exp_f32 v145, v145
    v_mfma_f32_16x16x32_bf16 v[132:135], a[196:199], v[68:71], v[132:135]
    v_exp_f32 v146, v146
    v_mfma_f32_16x16x32_bf16 v[132:135], a[200:203], v[72:75], v[132:135]
    v_exp_f32 v147, v147
    v_mfma_f32_16x16x32_bf16 v[132:135], a[204:207], v[76:79], v[132:135]
    v_add_f32 v180, v180, v141
    v_add_f32 v180, v180, v142
    v_mfma_f32_16x16x32_bf16 a[160:163], a[224:227], a[168:171], a[160:163]
    v_add_f32 v180, v180, v143
    v_cvt_pk_bf16_f32 v138, v140, v141
    v_mfma_f32_16x16x32_bf16 a[160:163], a[228:231], a[172:175], a[160:163]
    v_exp_f32 v148, v148
    v_add_f32 v181, v181, v144
    v_add_f32 v181, v181, v145
    v_add_f32 v181, v181, v146
    v_add_f32 v181, v181, v147
    v_cvt_pk_bf16_f32 v139, v142, v143
    v_mfma_f32_16x16x32_bf16 a[164:167], a[236:239], a[172:175], a[164:167]
    v_exp_f32 v149, v149
    v_exp_f32 v150, v150
    v_exp_f32 v151, v151
    v_mfma_f32_16x16x32_bf16 a[164:167], a[232:235], a[168:171], a[164:167]
    ds_read_b128 a[216:219], v188 offset:57344
    ds_read_b128 a[220:223], v189 offset:57344
    v_cvt_pk_bf16_f32 v144, v144, v145
    v_add_f32 v181, v181, v148
    v_add_f32 v181, v181, v149
    v_add_f32 v181, v181, v150
    v_add_f32 v181, v181, v151
    v_mfma_f32_16x16x32_bf16 a[16:19], a[232:235], v[100:103], a[16:19]
    ds_read_b128 a[192:195], v190 offset:49152
    ds_read_b128 a[196:199], v191 offset:49152
    v_exp_f32 v116, v116
    v_exp_f32 v117, v117
    v_cvt_pk_bf16_f32 v145, v146, v147
    v_mfma_f32_16x16x32_bf16 a[16:19], a[236:239], v[136:139], a[16:19]
    ds_read_b128 a[200:203], v190 offset:57344
    ds_read_b128 a[204:207], v191 offset:57344
    v_exp_f32 v118, v118
    v_cvt_pk_bf16_f32 v146, v148, v149
    v_cvt_pk_bf16_f32 v116, v116, v117
    v_mfma_f32_16x16x32_bf16 a[0:3], a[228:231], v[136:139], a[0:3]
    v_exp_f32 v119, v119
    v_exp_f32 v124, v124
    v_exp_f32 v125, v125
    v_cvt_pk_bf16_f32 v147, v150, v151
    v_mfma_f32_16x16x32_bf16 a[0:3], a[224:227], v[100:103], a[0:3]
    v_exp_f32 v126, v126
    v_exp_f32 v127, v127
    v_cvt_pk_bf16_f32 v117, v118, v119
    v_cvt_pk_bf16_f32 v124, v124, v125
    v_mfma_f32_16x16x32_bf16 a[32:35], a[224:227], v[108:111], a[32:35]
    ds_read_b64_tr_b16 a[224:225], v196 offset:49152
    ds_read_b64_tr_b16 a[226:227], v200 offset:49152
    v_exp_f32 v132, v132
    v_exp_f32 v133, v133
    v_cvt_pk_bf16_f32 v125, v126, v127
    v_mfma_f32_16x16x32_bf16 a[32:35], a[228:231], v[144:147], a[32:35]
    ds_read_b64_tr_b16 a[228:229], v204 offset:49152
    ds_read_b64_tr_b16 a[230:231], v208 offset:49152
    v_exp_f32 v134, v134
    v_exp_f32 v135, v135
    v_cvt_pk_bf16_f32 v132, v132, v133
    v_mfma_f32_16x16x32_bf16 a[48:51], a[236:239], v[144:147], a[48:51]
    ds_read_b64_tr_b16 a[236:237], v204 offset:49664
    ds_read_b64_tr_b16 a[238:239], v208 offset:49664
    v_cvt_pk_bf16_f32 v133, v134, v135
    v_accvgpr_read_b32 v80, a160
    v_accvgpr_read_b32 v81, a161
    v_accvgpr_read_b32 v82, a162
    v_mfma_f32_16x16x32_bf16 a[48:51], a[232:235], v[108:111], a[48:51]
    ds_read_b64_tr_b16 a[232:233], v196 offset:49664
    ds_read_b64_tr_b16 a[234:235], v200 offset:49664
    v_accvgpr_read_b32 v83, a163
    v_mov_b32 v96, v180
    v_accvgpr_read_b32 v0, a0
    v_pk_mul_f32 v[80:81], v[80:81], v[176:177] op_sel_hi:[1,0]
    v_mfma_f32_16x16x32_bf16 a[36:39], a[240:243], v[108:111], a[36:39]
    v_cvt_pk_bf16_f32 v80, v80, v81
    v_permlane32_swap_b32 v180, v96
    v_accvgpr_read_b32 v1, a1
    v_accvgpr_read_b32 v2, a2
    v_accvgpr_read_b32 v3, a3
    v_pk_mul_f32 v[82:83], v[82:83], v[176:177] op_sel_hi:[1,0]
    v_mfma_f32_16x16x32_bf16 a[36:39], a[244:247], v[144:147], a[36:39]
    v_cvt_pk_bf16_f32 v81, v82, v83
    v_add_f32 v180, v180, v96
    v_mov_b32 v104, v181
    v_accvgpr_read_b32 v16, a32
    v_accvgpr_read_b32 v17, a33
    v_accvgpr_read_b32 v18, a34
    v_mfma_f32_16x16x32_bf16 a[52:55], a[252:255], v[144:147], a[52:55]
    v_accvgpr_read_b32 v84, a164
    v_accvgpr_read_b32 v85, a165
    v_accvgpr_read_b32 v86, a166
    v_accvgpr_read_b32 v87, a167
    v_mov_b32 v96, v180
    v_permlane32_swap_b32 v181, v104
    v_accvgpr_read_b32 v19, a35
    v_mfma_f32_16x16x32_bf16 a[52:55], a[248:251], v[108:111], a[52:55]
    v_permlane16_swap_b32 v180, v96
    v_add_f32 v181, v181, v104
    v_mul_f32 v84, v176, v84
    v_mul_f32 v85, v176, v85
    v_pk_mul_f32 v[86:87], v[86:87], v[176:177] op_sel_hi:[1,0]
    v_mfma_f32_16x16x32_bf16 a[20:23], a[248:251], v[100:103], a[20:23]
    ds_read_b64_tr_b16 a[248:249], v197 offset:49664
    ds_read_b64_tr_b16 a[250:251], v201 offset:49664
    v_cvt_pk_bf16_f32 v82, v84, v85
    v_add_f32 v180, v180, v96
    v_mov_b32 v104, v181
    v_mfma_f32_16x16x32_bf16 a[20:23], a[252:255], v[136:139], a[20:23]
    ds_read_b64_tr_b16 a[252:253], v205 offset:49664
    ds_read_b64_tr_b16 a[254:255], v209 offset:49664
    v_cvt_pk_bf16_f32 v83, v86, v87
    v_rcp_f32 v98, v180
    v_min_f32 v239, v239, v180
    v_max_f32 v240, v240, v180
    v_mfma_f32_16x16x32_bf16 a[4:7], a[244:247], v[136:139], a[4:7]
    ds_read_b64_tr_b16 a[244:245], v205 offset:49152
    ds_read_b64_tr_b16 a[246:247], v209 offset:49152
    v_permlane16_swap_b32 v80, v82
    v_permlane16_swap_b32 v81, v83
    v_pk_mul_f32 v[0:1], v[0:1], v[98:99] op_sel_hi:[1,0]
    v_mfma_f32_16x16x32_bf16 a[4:7], a[240:243], v[100:103], a[4:7]
    ds_read_b64_tr_b16 a[240:241], v197 offset:49152
    ds_read_b64_tr_b16 a[242:243], v201 offset:49152
    buffer_store_dwordx4 v[80:83], v238, s[16:19], s61 offen sc1
    v_mfma_f32_16x16x32_bf16 v[228:231], v[224:227], v[80:83], v[228:231]
    s_waitcnt lgkmcnt(8)
    v_mul_f32 v2, v98, v2
    v_mul_f32 v3, v98, v3
    v_mfma_f32_16x16x32_bf16 v[156:159], a[208:211], v[32:35], 0
    v_cvt_pk_bf16_f32 v0, v0, v1
    v_permlane16_swap_b32 v181, v104
    v_accvgpr_read_b32 v20, a36
    v_accvgpr_read_b32 v21, a37
    v_accvgpr_read_b32 v22, a38
    v_accvgpr_read_b32 v23, a39
    v_mfma_f32_16x16x32_bf16 v[156:159], a[212:215], v[36:39], v[156:159]
    v_cvt_pk_bf16_f32 v1, v2, v3
    v_add_f32 v181, v181, v104
    v_mfma_f32_16x16x32_bf16 v[156:159], a[216:219], v[40:43], v[156:159]
    v_accvgpr_read_b32 v140, a16
    v_accvgpr_read_b32 v141, a17
    v_accvgpr_read_b32 v142, a18
    v_accvgpr_read_b32 v143, a19
    v_rcp_f32 v106, v181
    v_mfma_f32_16x16x32_bf16 v[156:159], a[220:223], v[44:47], v[156:159]
    v_accvgpr_read_b32 v4, a4
    v_accvgpr_read_b32 v5, a5
    v_mul_f32 v140, v98, v140
    v_mul_f32 v141, v98, v141
    v_pk_mul_f32 v[142:143], v[142:143], v[98:99] op_sel_hi:[1,0]
    v_mfma_f32_16x16x32_bf16 v[164:167], a[220:223], v[60:63], 0
    v_cvt_pk_bf16_f32 v2, v140, v141
    v_accvgpr_read_b32 v6, a6
    v_accvgpr_read_b32 v7, a7
    v_min_f32 v239, v239, v181
    v_max_f32 v240, v240, v181
    v_pk_mul_f32 v[4:5], v[4:5], v[98:99] op_sel_hi:[1,0]
    v_mfma_f32_16x16x32_bf16 v[164:167], a[216:219], v[56:59], v[164:167]
    v_cvt_pk_bf16_f32 v3, v142, v143
    v_cvt_pk_bf16_f32 v4, v4, v5
    v_mul_f32 v6, v98, v6
    v_mul_f32 v7, v98, v7
    v_pk_mul_f32 v[16:17], v[16:17], v[106:107] op_sel_hi:[1,0]
    v_mfma_f32_16x16x32_bf16 v[164:167], a[212:215], v[52:55], v[164:167]
    v_permlane16_swap_b32 v0, v2
    v_permlane16_swap_b32 v1, v3
    v_cvt_pk_bf16_f32 v5, v6, v7
    v_cvt_pk_bf16_f32 v16, v16, v17
    v_pk_mul_f32 v[18:19], v[18:19], v[106:107] op_sel_hi:[1,0]
    v_mfma_f32_16x16x32_bf16 v[164:167], a[208:211], v[48:51], v[164:167]
    buffer_store_dwordx4 v[0:3], v238, s[16:19], s56 offen sc1
    v_mfma_f32_16x16x32_bf16 v[228:231], v[224:227], v[0:3], v[228:231]
    v_accvgpr_read_b32 v140, a20
    v_accvgpr_read_b32 v141, a21
    v_accvgpr_read_b32 v142, a22
    v_accvgpr_read_b32 v143, a23
    v_mfma_f32_16x16x32_bf16 v[172:175], a[208:211], v[64:67], 0
    ds_read_b128 a[208:211], v192 offset:49152
    v_cvt_pk_bf16_f32 v17, v18, v19
    v_mul_f32 v140, v98, v140
    v_mul_f32 v141, v98, v141
    v_pk_mul_f32 v[142:143], v[142:143], v[98:99] op_sel_hi:[1,0]
    v_mfma_f32_16x16x32_bf16 v[172:175], a[212:215], v[68:71], v[172:175]
    ds_read_b128 a[212:215], v193 offset:49152
    v_cvt_pk_bf16_f32 v6, v140, v141
    v_accvgpr_read_b32 v148, a48
    v_accvgpr_read_b32 v149, a49
    v_accvgpr_read_b32 v150, a50
    v_pk_mul_f32 v[20:21], v[20:21], v[106:107] op_sel_hi:[1,0]
    v_mfma_f32_16x16x32_bf16 v[172:175], a[216:219], v[72:75], v[172:175]
    ds_read_b128 a[216:219], v192 offset:57344
    v_cvt_pk_bf16_f32 v7, v142, v143
    v_accvgpr_read_b32 v151, a51
    v_mul_f32 v148, v106, v148
    v_mul_f32 v149, v106, v149
    v_pk_mul_f32 v[22:23], v[22:23], v[106:107] op_sel_hi:[1,0]
    v_mfma_f32_16x16x32_bf16 v[172:175], a[220:223], v[76:79], v[172:175]
    ds_read_b128 a[220:223], v193 offset:57344
    v_exp_f32 v156, v156
    v_exp_f32 v157, v157
    v_permlane16_swap_b32 v4, v6
    v_mfma_f32_16x16x32_bf16 a[8:11], a[224:227], v[100:103], a[8:11]
    v_exp_f32 v158, v158
    v_exp_f32 v159, v159
    v_cvt_pk_bf16_f32 v118, v156, v157
    v_permlane16_swap_b32 v5, v7
    v_cvt_pk_bf16_f32 v18, v148, v149
    v_mfma_f32_16x16x32_bf16 a[8:11], a[228:231], v[136:139], a[8:11]
    v_cvt_pk_bf16_f32 v119, v158, v159
    buffer_store_dwordx4 v[4:7], v241, s[16:19], s56 offen sc1
    v_mfma_f32_16x16x32_bf16 v[228:231], v[224:227], v[4:7], v[228:231]
    v_cvt_pk_bf16_f32 v20, v20, v21
    v_mul_f32 v150, v106, v150
    v_mul_f32 v151, v106, v151
    v_mfma_f32_16x16x32_bf16 a[24:27], a[236:239], v[136:139], a[24:27]
    v_cvt_pk_bf16_f32 v19, v150, v151
    v_cvt_pk_bf16_f32 v21, v22, v23
    v_mfma_f32_16x16x32_bf16 a[24:27], a[232:235], v[100:103], a[24:27]
    v_exp_f32 v164, v164
    v_exp_f32 v165, v165
    v_exp_f32 v166, v166
    v_permlane16_swap_b32 v16, v18
    v_mfma_f32_16x16x32_bf16 a[56:59], a[232:235], v[108:111], a[56:59]
    ds_read_b64_tr_b16 a[232:233], v194 offset:49664
    ds_read_b64_tr_b16 a[234:235], v198 offset:49664
    v_exp_f32 v167, v167
    v_cvt_pk_bf16_f32 v126, v164, v165
    v_permlane16_swap_b32 v17, v19
    v_mfma_f32_16x16x32_bf16 a[56:59], a[236:239], v[144:147], a[56:59]
    ds_read_b64_tr_b16 a[236:237], v202 offset:49664
    ds_read_b64_tr_b16 a[238:239], v206 offset:49664
    v_cvt_pk_bf16_f32 v127, v166, v167
    v_accvgpr_read_b32 v8, a8
    v_accvgpr_read_b32 v9, a9
    v_accvgpr_read_b32 v10, a10
    v_accvgpr_read_b32 v11, a11
    v_mfma_f32_16x16x32_bf16 a[40:43], a[228:231], v[144:147], a[40:43]
    ds_read_b64_tr_b16 a[228:229], v202 offset:49152
    ds_read_b64_tr_b16 a[230:231], v206 offset:49152
    buffer_store_dwordx4 v[16:19], v238, s[16:19], s57 offen sc1
    v_mul_f32 v8, v98, v8
    v_mul_f32 v9, v98, v9
    v_pk_mul_f32 v[10:11], v[10:11], v[98:99] op_sel_hi:[1,0]
    v_mfma_f32_16x16x32_bf16 a[40:43], a[224:227], v[108:111], a[40:43]
    s_waitcnt vmcnt(4)
    ds_read_b64_tr_b16 a[224:225], v194 offset:49152
    ds_read_b64_tr_b16 a[226:227], v198 offset:49152
    v_exp_f32 v172, v172
    s_barrier
    s_waitcnt lgkmcnt(8)
    v_mfma_f32_16x16x32_bf16 a[44:47], a[240:243], v[108:111], a[44:47]
    v_exp_f32 v173, v173
    v_exp_f32 v174, v174
    v_exp_f32 v175, v175
    v_cvt_pk_bf16_f32 v8, v8, v9
    v_mfma_f32_16x16x32_bf16 a[44:47], a[244:247], v[144:147], a[44:47]
    v_cvt_pk_bf16_f32 v134, v172, v173
    v_cvt_pk_bf16_f32 v9, v10, v11
    v_mfma_f32_16x16x32_bf16 v[228:231], v[224:227], v[16:19], v[228:231]
    v_accvgpr_read_b32 v148, a52
    v_accvgpr_read_b32 v149, a53
    v_mfma_f32_16x16x32_bf16 a[60:63], a[252:255], v[144:147], a[60:63]
    v_cvt_pk_bf16_f32 v135, v174, v175
    v_accvgpr_read_b32 v140, a24
    v_accvgpr_read_b32 v141, a25
    v_accvgpr_read_b32 v142, a26
    v_accvgpr_read_b32 v143, a27
    v_accvgpr_read_b32 v150, a54
    v_accvgpr_read_b32 v151, a55
    v_mfma_f32_16x16x32_bf16 a[60:63], a[248:251], v[108:111], a[60:63]
    v_accvgpr_read_b32 v24, a40
    v_mul_f32 v140, v98, v140
    v_mul_f32 v141, v98, v141
    v_mul_f32 v142, v98, v142
    v_mul_f32 v143, v98, v143
    v_pk_mul_f32 v[148:149], v[148:149], v[106:107] op_sel_hi:[1,0]
    v_mfma_f32_16x16x32_bf16 a[28:31], a[248:251], v[100:103], a[28:31]
    ds_read_b64_tr_b16 a[248:249], v195 offset:49664
    ds_read_b64_tr_b16 a[250:251], v199 offset:49664
    v_cvt_pk_bf16_f32 v10, v140, v141
    v_cvt_pk_bf16_f32 v22, v148, v149
    v_pk_mul_f32 v[150:151], v[150:151], v[106:107] op_sel_hi:[1,0]
    v_mfma_f32_16x16x32_bf16 a[28:31], a[252:255], v[136:139], a[28:31]
    ds_read_b64_tr_b16 a[252:253], v203 offset:49664
    ds_read_b64_tr_b16 a[254:255], v207 offset:49664
    v_cvt_pk_bf16_f32 v11, v142, v143
    v_cvt_pk_bf16_f32 v23, v150, v151
    v_accvgpr_read_b32 v25, a41
    v_accvgpr_read_b32 v26, a42
    v_accvgpr_read_b32 v27, a43
    v_mfma_f32_16x16x32_bf16 a[12:15], a[244:247], v[136:139], a[12:15]
    ds_read_b64_tr_b16 a[244:245], v203 offset:49152
    ds_read_b64_tr_b16 a[246:247], v207 offset:49152
    v_permlane16_swap_b32 v8, v10
    v_permlane16_swap_b32 v9, v11
    v_permlane16_swap_b32 v20, v22
    v_permlane16_swap_b32 v21, v23
    v_accvgpr_read_b32 v28, a44
    v_mfma_f32_16x16x32_bf16 a[12:15], a[240:243], v[100:103], a[12:15]
    ds_read_b64_tr_b16 a[240:241], v195 offset:49152
    ds_read_b64_tr_b16 a[242:243], v199 offset:49152
    buffer_store_dwordx4 v[8:11], v242, s[16:19], s56 offen sc1
    v_mfma_f32_16x16x32_bf16 v[228:231], v[224:227], v[8:11], v[228:231]
    buffer_store_dwordx4 v[20:23], v241, s[16:19], s57 offen sc1
    v_mfma_f32_16x16x32_bf16 v[152:155], a[192:195], v[32:35], 0
    v_mfma_f32_16x16x32_bf16 v[228:231], v[224:227], v[20:23], v[228:231]
    v_accvgpr_read_b32 v29, a45
    v_mul_f32 v24, v106, v24
    v_mul_f32 v25, v106, v25
    v_mul_f32 v26, v106, v26
    v_mul_f32 v27, v106, v27
    v_mfma_f32_16x16x32_bf16 v[152:155], a[196:199], v[36:39], v[152:155]
    v_cvt_pk_bf16_f32 v24, v24, v25
    v_accvgpr_read_b32 v30, a46
    v_accvgpr_read_b32 v31, a47
    v_mul_f32 v28, v106, v28
    v_mul_f32 v29, v106, v29
    v_mfma_f32_16x16x32_bf16 v[152:155], a[200:203], v[40:43], v[152:155]
    v_cvt_pk_bf16_f32 v25, v26, v27
    v_cvt_pk_bf16_f32 v28, v28, v29
    v_mul_f32 v30, v106, v30
    v_mul_f32 v31, v106, v31
    v_mfma_f32_16x16x32_bf16 v[152:155], a[204:207], v[44:47], v[152:155]
    v_accvgpr_read_b32 v12, a12
    v_accvgpr_read_b32 v13, a13
    v_accvgpr_read_b32 v14, a14
    v_accvgpr_read_b32 v15, a15
    v_accvgpr_read_b32 v148, a56
    v_accvgpr_read_b32 v149, a57
    v_accvgpr_read_b32 v150, a58
    v_mfma_f32_16x16x32_bf16 v[160:163], a[204:207], v[60:63], 0
    v_accvgpr_read_b32 v151, a59
    v_cvt_pk_bf16_f32 v29, v30, v31
    v_mul_f32 v12, v98, v12
    v_mul_f32 v13, v98, v13
    v_pk_mul_f32 v[14:15], v[14:15], v[98:99] op_sel_hi:[1,0]
    v_mfma_f32_16x16x32_bf16 v[160:163], a[200:203], v[56:59], v[160:163]
    v_cvt_pk_bf16_f32 v12, v12, v13
    v_mul_f32 v148, v106, v148
    v_mul_f32 v149, v106, v149
    v_mul_f32 v150, v106, v150
    v_mul_f32 v151, v106, v151
    v_mfma_f32_16x16x32_bf16 v[160:163], a[196:199], v[52:55], v[160:163]
    v_cvt_pk_bf16_f32 v13, v14, v15
    v_cvt_pk_bf16_f32 v26, v148, v149
    v_mfma_f32_16x16x32_bf16 v[160:163], a[192:195], v[48:51], v[160:163]
    v_accvgpr_read_b32 v140, a28
    v_accvgpr_read_b32 v141, a29
    v_accvgpr_read_b32 v142, a30
    v_accvgpr_read_b32 v143, a31
    v_cvt_pk_bf16_f32 v27, v150, v151
    v_mfma_f32_16x16x32_bf16 v[168:171], a[192:195], v[64:67], 0
    ds_read_b128 a[192:195], v186 offset:0
    v_permlane16_swap_b32 v24, v26
    v_permlane16_swap_b32 v25, v27
    v_mul_f32 v140, v98, v140
    v_mul_f32 v141, v98, v141
    v_pk_mul_f32 v[142:143], v[142:143], v[98:99] op_sel_hi:[1,0]
    v_mfma_f32_16x16x32_bf16 v[168:171], a[196:199], v[68:71], v[168:171]
    ds_read_b128 a[196:199], v187 offset:0
    v_cvt_pk_bf16_f32 v14, v140, v141
    buffer_store_dwordx4 v[24:27], v242, s[16:19], s57 offen sc1
    v_mfma_f32_16x16x32_bf16 v[228:231], v[224:227], v[24:27], v[228:231]
    v_accvgpr_read_b32 v148, a60
    v_mfma_f32_16x16x32_bf16 v[168:171], a[200:203], v[72:75], v[168:171]
    ds_read_b128 a[200:203], v186 offset:8192
    v_cvt_pk_bf16_f32 v15, v142, v143
    v_accvgpr_read_b32 v149, a61
    v_accvgpr_read_b32 v150, a62
    v_accvgpr_read_b32 v151, a63
    v_mfma_f32_16x16x32_bf16 v[168:171], a[204:207], v[76:79], v[168:171]
    ds_read_b128 a[204:207], v187 offset:8192
    v_exp_f32 v152, v152
    v_exp_f32 v153, v153
    v_exp_f32 v154, v154
    v_mfma_f32_16x16x32_bf16 v[156:159], a[208:211], v[32:35], 0
    v_exp_f32 v155, v155
    v_cvt_pk_bf16_f32 v152, v152, v153
    v_permlane16_swap_b32 v12, v14
    v_pk_mul_f32 v[148:149], v[148:149], v[106:107] op_sel_hi:[1,0]
    v_mfma_f32_16x16x32_bf16 v[156:159], a[212:215], v[36:39], v[156:159]
    v_cvt_pk_bf16_f32 v153, v154, v155
    v_permlane16_swap_b32 v13, v15
    v_cvt_pk_bf16_f32 v30, v148, v149
    v_mul_f32 v150, v106, v150
    v_mul_f32 v151, v106, v151
    v_mfma_f32_16x16x32_bf16 v[156:159], a[216:219], v[40:43], v[156:159]
    buffer_store_dwordx4 v[12:15], v243, s[16:19], s56 offen sc1
    v_cvt_pk_bf16_f32 v31, v150, v151
    v_mfma_f32_16x16x32_bf16 v[156:159], a[220:223], v[44:47], v[156:159]
    v_exp_f32 v160, v160
    v_mfma_f32_16x16x32_bf16 v[164:167], a[220:223], v[60:63], 0
    v_exp_f32 v161, v161
    v_mfma_f32_16x16x32_bf16 v[164:167], a[216:219], v[56:59], v[164:167]
    v_exp_f32 v162, v162
    v_mfma_f32_16x16x32_bf16 v[164:167], a[212:215], v[52:55], v[164:167]
    v_exp_f32 v163, v163
    v_mfma_f32_16x16x32_bf16 v[164:167], a[208:211], v[48:51], v[164:167]
    v_exp_f32 v168, v168
    v_cvt_pk_bf16_f32 v160, v160, v161
    v_mfma_f32_16x16x32_bf16 v[172:175], a[208:211], v[64:67], 0
    ds_read_b128 a[208:211], v188 offset:0
    v_cvt_pk_bf16_f32 v161, v162, v163
    v_mfma_f32_16x16x32_bf16 v[172:175], a[212:215], v[68:71], v[172:175]
    v_exp_f32 v169, v169
    v_mfma_f32_16x16x32_bf16 v[172:175], a[216:219], v[72:75], v[172:175]
    v_exp_f32 v170, v170
    v_mfma_f32_16x16x32_bf16 v[172:175], a[220:223], v[76:79], v[172:175]
    s_waitcnt lgkmcnt(1)
    v_exp_f32 v156, v156
    v_mfma_f32_16x16x32_bf16 v[120:123], a[204:207], v[60:63], 0
    v_exp_f32 v157, v157
    v_mfma_f32_16x16x32_bf16 v[120:123], a[200:203], v[56:59], v[120:123]
    v_exp_f32 v158, v158
    v_mfma_f32_16x16x32_bf16 v[120:123], a[196:199], v[52:55], v[120:123]
    v_exp_f32 v159, v159
    v_mfma_f32_16x16x32_bf16 v[120:123], a[192:195], v[48:51], v[120:123]
    v_cvt_pk_bf16_f32 v154, v156, v157
    v_cvt_pk_bf16_f32 v168, v168, v169
    v_mfma_f32_16x16x32_bf16 v[128:131], a[192:195], v[64:67], 0
    ds_read_b128 a[212:215], v189 offset:0
    v_cvt_pk_bf16_f32 v155, v158, v159
    v_mfma_f32_16x16x32_bf16 v[128:131], a[196:199], v[68:71], v[128:131]
    v_exp_f32 v164, v164
    v_mfma_f32_16x16x32_bf16 v[128:131], a[200:203], v[72:75], v[128:131]
    v_exp_f32 v165, v165
    v_mfma_f32_16x16x32_bf16 v[128:131], a[204:207], v[76:79], v[128:131]
    v_exp_f32 v166, v166
    v_mfma_f32_16x16x32_bf16 a[64:67], a[224:227], v[116:119], a[64:67]
    v_exp_f32 v167, v167
    v_mfma_f32_16x16x32_bf16 a[64:67], a[228:231], v[152:155], a[64:67]
    v_exp_f32 v171, v171
    v_cvt_pk_bf16_f32 v162, v164, v165
    v_mfma_f32_16x16x32_bf16 a[80:83], a[236:239], v[152:155], a[80:83]
    v_exp_f32 v172, v172
    v_cvt_pk_bf16_f32 v163, v166, v167
    v_mfma_f32_16x16x32_bf16 a[80:83], a[232:235], v[116:119], a[80:83]
    v_exp_f32 v173, v173
    v_cvt_pk_bf16_f32 v169, v170, v171
    v_mfma_f32_16x16x32_bf16 a[176:179], v[244:247], v[116:119], a[176:179]
    v_exp_f32 v174, v174
    v_cvt_pk_bf16_f32 v170, v172, v173
    v_mfma_f32_16x16x32_bf16 a[176:179], v[244:247], v[152:155], a[176:179]
    ds_read_b128 a[216:219], v188 offset:8192
    v_exp_f32 v175, v175
    v_mfma_f32_16x16x32_bf16 a[112:115], a[232:235], v[124:127], a[112:115]
    ds_read_b128 a[220:223], v189 offset:8192
    ds_read_b128 a[192:195], v190 offset:0
    v_cvt_pk_bf16_f32 v171, v174, v175
    v_mfma_f32_16x16x32_bf16 a[112:115], a[236:239], v[160:163], a[112:115]
    ds_read_b128 a[196:199], v191 offset:0
    ds_read_b128 a[200:203], v190 offset:8192
    v_permlane16_swap_b32 v28, v30
    v_mfma_f32_16x16x32_bf16 a[96:99], a[228:231], v[160:163], a[96:99]
    ds_read_b128 a[204:207], v191 offset:8192
    v_exp_f32 v120, v120
    v_mfma_f32_16x16x32_bf16 a[96:99], a[224:227], v[124:127], a[96:99]
    v_exp_f32 v121, v121
    v_permlane16_swap_b32 v29, v31
    v_mfma_f32_16x16x32_bf16 a[180:183], v[244:247], v[124:127], a[180:183]
    v_exp_f32 v122, v122
    v_cvt_pk_bf16_f32 v120, v120, v121
    v_mfma_f32_16x16x32_bf16 a[180:183], v[244:247], v[160:163], a[180:183]
    v_exp_f32 v123, v123
    buffer_store_dwordx4 v[28:31], v243, s[16:19], s57 offen sc1
    v_mfma_f32_16x16x32_bf16 a[128:131], a[224:227], v[132:135], a[128:131]
    ds_read_b64_tr_b16 a[224:225], v196 offset:49152
    ds_read_b64_tr_b16 a[226:227], v200 offset:49152
    v_cvt_pk_bf16_f32 v121, v122, v123
    v_mfma_f32_16x16x32_bf16 a[128:131], a[228:231], v[168:171], a[128:131]
    ds_read_b64_tr_b16 a[228:229], v204 offset:49152
    ds_read_b64_tr_b16 a[230:231], v208 offset:49152
    v_accvgpr_read_b32 v182, a176
    v_mfma_f32_16x16x32_bf16 a[144:147], a[236:239], v[168:171], a[144:147]
    ds_read_b64_tr_b16 a[236:237], v204 offset:49664
    ds_read_b64_tr_b16 a[238:239], v208 offset:49664
    v_exp_f32 v128, v128
    v_mfma_f32_16x16x32_bf16 a[144:147], a[232:235], v[132:135], a[144:147]
    ds_read_b64_tr_b16 a[232:233], v196 offset:49664
    ds_read_b64_tr_b16 a[234:235], v200 offset:49664
    v_accvgpr_read_b32 v32, a64
    v_mfma_f32_16x16x32_bf16 a[184:187], v[244:247], v[132:135], a[184:187]
    v_exp_f32 v129, v129
    v_accvgpr_read_b32 v33, a65
    v_mfma_f32_16x16x32_bf16 a[184:187], v[244:247], v[168:171], a[184:187]
    v_exp_f32 v130, v130
    v_cvt_pk_bf16_f32 v128, v128, v129
    v_mfma_f32_16x16x32_bf16 a[132:135], a[240:243], v[132:135], a[132:135]
    v_exp_f32 v131, v131
    v_accvgpr_read_b32 v34, a66
    v_mfma_f32_16x16x32_bf16 a[132:135], a[244:247], v[168:171], a[132:135]
    v_cvt_pk_bf16_f32 v129, v130, v131
    v_mfma_f32_16x16x32_bf16 v[228:231], v[224:227], v[12:15], v[228:231]
    v_mfma_f32_16x16x32_bf16 a[148:151], a[252:255], v[168:171], a[148:151]
    v_mfma_f32_16x16x32_bf16 v[228:231], v[224:227], v[28:31], v[228:231]
    v_accvgpr_read_b32 v35, a67
    v_mfma_f32_16x16x32_bf16 a[148:151], a[248:251], v[132:135], a[148:151]
    v_rcp_f32 v114, v182
    v_mfma_f32_16x16x32_bf16 a[116:119], a[248:251], v[124:127], a[116:119]
    v_min_f32 v239, v239, v182
    v_max_f32 v240, v240, v182
    v_mfma_f32_16x16x32_bf16 a[116:119], a[252:255], v[160:163], a[116:119]
    v_mul_f32 v32, v114, v32
    v_mul_f32 v33, v114, v33
    v_mfma_f32_16x16x32_bf16 a[100:103], a[244:247], v[160:163], a[100:103]
    v_cvt_pk_bf16_f32 v32, v32, v33
    v_mul_f32 v34, v114, v34
    v_mul_f32 v35, v114, v35
    v_mfma_f32_16x16x32_bf16 a[100:103], a[240:243], v[124:127], a[100:103]
    v_cvt_pk_bf16_f32 v33, v34, v35
    v_mfma_f32_16x16x32_bf16 a[68:71], a[240:243], v[116:119], a[68:71]
    ds_read_b64_tr_b16 a[240:241], v197 offset:49152
    ds_read_b64_tr_b16 a[242:243], v201 offset:49152
    v_accvgpr_read_b32 v156, a80
    v_mfma_f32_16x16x32_bf16 a[68:71], a[244:247], v[152:155], a[68:71]
    ds_read_b64_tr_b16 a[244:245], v205 offset:49152
    ds_read_b64_tr_b16 a[246:247], v209 offset:49152
    v_accvgpr_read_b32 v157, a81
    v_mfma_f32_16x16x32_bf16 a[84:87], a[252:255], v[152:155], a[84:87]
    ds_read_b64_tr_b16 a[252:253], v205 offset:49664
    ds_read_b64_tr_b16 a[254:255], v209 offset:49664
    v_accvgpr_read_b32 v158, a82
    v_mfma_f32_16x16x32_bf16 a[84:87], a[248:251], v[116:119], a[84:87]
    s_waitcnt lgkmcnt(6)
    ds_read_b64_tr_b16 a[248:249], v197 offset:49664
    ds_read_b64_tr_b16 a[250:251], v201 offset:49664
    v_accvgpr_read_b32 v159, a83
    v_mfma_f32_16x16x32_bf16 v[164:167], a[220:223], v[60:63], 0
    v_mul_f32 v156, v114, v156
    v_mul_f32 v157, v114, v157
    v_mfma_f32_16x16x32_bf16 v[164:167], a[216:219], v[56:59], v[164:167]
    v_cvt_pk_bf16_f32 v34, v156, v157
    v_mul_f32 v158, v114, v158
    v_mul_f32 v159, v114, v159
    v_mfma_f32_16x16x32_bf16 v[164:167], a[212:215], v[52:55], v[164:167]
    v_cvt_pk_bf16_f32 v35, v158, v159
    v_accvgpr_read_b32 v36, a68
    v_accvgpr_read_b32 v37, a69
    v_mfma_f32_16x16x32_bf16 v[164:167], a[208:211], v[48:51], v[164:167]
    v_permlane16_swap_b32 v32, v34
    v_permlane16_swap_b32 v33, v35
    v_accvgpr_read_b32 v38, a70
    v_mfma_f32_16x16x32_bf16 v[172:175], a[208:211], v[64:67], 0
    ds_read_b128 a[208:211], v192 offset:0
    buffer_store_dwordx4 v[32:35], v238, s[16:19], s58 offen sc1
    v_accvgpr_read_b32 v39, a71
    v_mfma_f32_16x16x32_bf16 v[172:175], a[212:215], v[68:71], v[172:175]
    ds_read_b128 a[212:215], v193 offset:0
    v_mfma_f32_16x16x32_bf16 v[228:231], v[224:227], v[32:35], v[228:231]
    v_mfma_f32_16x16x32_bf16 v[172:175], a[216:219], v[72:75], v[172:175]
    ds_read_b128 a[216:219], v192 offset:8192
    v_mul_f32 v36, v114, v36
    v_mul_f32 v37, v114, v37
    v_mfma_f32_16x16x32_bf16 v[172:175], a[220:223], v[76:79], v[172:175]
    ds_read_b128 a[220:223], v193 offset:8192
    v_mul_f32 v38, v114, v38
    v_mul_f32 v39, v114, v39
    v_mfma_f32_16x16x32_bf16 a[72:75], a[224:227], v[116:119], a[72:75]
    v_cvt_pk_bf16_f32 v36, v36, v37
    v_mfma_f32_16x16x32_bf16 a[72:75], a[228:231], v[152:155], a[72:75]
    v_cvt_pk_bf16_f32 v37, v38, v39
    v_mfma_f32_16x16x32_bf16 a[88:91], a[236:239], v[152:155], a[88:91]
    v_accvgpr_read_b32 v156, a84
    v_accvgpr_read_b32 v157, a85
    v_accvgpr_read_b32 v158, a86
    v_mfma_f32_16x16x32_bf16 a[88:91], a[232:235], v[116:119], a[88:91]
    v_exp_f32 v164, v164
    v_accvgpr_read_b32 v159, a87
    v_mfma_f32_16x16x32_bf16 a[120:123], a[232:235], v[124:127], a[120:123]
    v_exp_f32 v165, v165
    v_mfma_f32_16x16x32_bf16 a[120:123], a[236:239], v[160:163], a[120:123]
    v_exp_f32 v166, v166
    v_cvt_pk_bf16_f32 v122, v164, v165
    v_mfma_f32_16x16x32_bf16 a[104:107], a[228:231], v[160:163], a[104:107]
    v_exp_f32 v167, v167
    v_accvgpr_read_b32 v40, a72
    v_mfma_f32_16x16x32_bf16 a[104:107], a[224:227], v[124:127], a[104:107]
    v_exp_f32 v172, v172
    v_cvt_pk_bf16_f32 v123, v166, v167
    v_accvgpr_read_b32 v41, a73
    v_mfma_f32_16x16x32_bf16 a[136:139], a[224:227], v[132:135], a[136:139]
    ds_read_b64_tr_b16 a[224:225], v194 offset:0
    ds_read_b64_tr_b16 a[226:227], v198 offset:0
    v_accvgpr_read_b32 v42, a74
    v_mfma_f32_16x16x32_bf16 a[136:139], a[228:231], v[168:171], a[136:139]
    ds_read_b64_tr_b16 a[228:229], v202 offset:0
    ds_read_b64_tr_b16 a[230:231], v206 offset:0
    v_accvgpr_read_b32 v43, a75
    v_mfma_f32_16x16x32_bf16 a[152:155], a[236:239], v[168:171], a[152:155]
    ds_read_b64_tr_b16 a[236:237], v202 offset:512
    v_exp_f32 v173, v173
    v_mfma_f32_16x16x32_bf16 a[152:155], a[232:235], v[132:135], a[152:155]
    s_waitcnt lgkmcnt(5)
    ds_read_b64_tr_b16 a[238:239], v206 offset:512
    ds_read_b64_tr_b16 a[232:233], v194 offset:512
    v_cvt_pk_bf16_f32 v130, v172, v173
    v_mfma_f32_16x16x32_bf16 a[140:143], a[240:243], v[132:135], a[140:143]
    ds_read_b64_tr_b16 a[234:235], v198 offset:512
    v_exp_f32 v174, v174
    v_mfma_f32_16x16x32_bf16 a[140:143], a[244:247], v[168:171], a[140:143]
    v_exp_f32 v175, v175
    v_mfma_f32_16x16x32_bf16 a[156:159], a[252:255], v[168:171], a[156:159]
    v_cvt_pk_bf16_f32 v131, v174, v175
    v_mul_f32 v156, v114, v156
    v_mul_f32 v157, v114, v157
    v_mfma_f32_16x16x32_bf16 a[156:159], a[248:251], v[132:135], a[156:159]
    v_cvt_pk_bf16_f32 v38, v156, v157
    v_mul_f32 v158, v114, v158
    v_mul_f32 v159, v114, v159
    v_mfma_f32_16x16x32_bf16 a[124:127], a[248:251], v[124:127], a[124:127]
    v_cvt_pk_bf16_f32 v39, v158, v159
    v_mul_f32 v40, v114, v40
    v_mul_f32 v41, v114, v41
    v_mfma_f32_16x16x32_bf16 a[124:127], a[252:255], v[160:163], a[124:127]
    v_permlane16_swap_b32 v36, v38
    v_permlane16_swap_b32 v37, v39
    v_cvt_pk_bf16_f32 v40, v40, v41
    v_mfma_f32_16x16x32_bf16 a[108:111], a[244:247], v[160:163], a[108:111]
    buffer_store_dwordx4 v[36:39], v241, s[16:19], s58 offen sc1
    v_mfma_f32_16x16x32_bf16 v[228:231], v[224:227], v[36:39], v[228:231]
    v_mfma_f32_16x16x32_bf16 a[108:111], a[240:243], v[124:127], a[108:111]
    v_mul_f32 v42, v114, v42
    v_mul_f32 v43, v114, v43
    v_mfma_f32_16x16x32_bf16 a[76:79], a[240:243], v[116:119], a[76:79]
    ds_read_b64_tr_b16 a[240:241], v195 offset:0
    ds_read_b64_tr_b16 a[242:243], v199 offset:0
    v_cvt_pk_bf16_f32 v41, v42, v43
    v_mfma_f32_16x16x32_bf16 a[76:79], a[244:247], v[152:155], a[76:79]
    ds_read_b64_tr_b16 a[244:245], v203 offset:0
    ds_read_b64_tr_b16 a[246:247], v207 offset:0
    v_accvgpr_read_b32 v156, a88
    v_mfma_f32_16x16x32_bf16 a[92:95], a[252:255], v[152:155], a[92:95]
    ds_read_b64_tr_b16 a[252:253], v203 offset:512
    ds_read_b64_tr_b16 a[254:255], v207 offset:512
    v_accvgpr_read_b32 v157, a89
    v_mfma_f32_16x16x32_bf16 a[92:95], a[248:251], v[116:119], a[92:95]
    ds_read_b64_tr_b16 a[248:249], v195 offset:512
    ds_read_b64_tr_b16 a[250:251], v199 offset:512
    v_accvgpr_read_b32 v158, a90
    v_mfma_f32_16x16x32_bf16 v[160:163], a[204:207], v[60:63], 0
    v_accvgpr_read_b32 v159, a91
    v_mul_f32 v156, v114, v156
    v_mul_f32 v157, v114, v157
    v_mfma_f32_16x16x32_bf16 v[160:163], a[200:203], v[56:59], v[160:163]
    v_cvt_pk_bf16_f32 v42, v156, v157
    v_mul_f32 v158, v114, v158
    v_mul_f32 v159, v114, v159
    v_mfma_f32_16x16x32_bf16 v[160:163], a[196:199], v[52:55], v[160:163]
    v_cvt_pk_bf16_f32 v43, v158, v159
    v_accvgpr_read_b32 v44, a76
    v_accvgpr_read_b32 v45, a77
    v_mfma_f32_16x16x32_bf16 v[160:163], a[192:195], v[48:51], v[160:163]
    v_permlane16_swap_b32 v40, v42
    v_permlane16_swap_b32 v41, v43
    v_accvgpr_read_b32 v46, a78
    v_mfma_f32_16x16x32_bf16 v[168:171], a[192:195], v[64:67], 0
    ds_read_b128 a[192:195], v186 offset:16384
    buffer_store_dwordx4 v[40:43], v242, s[16:19], s58 offen sc1
    v_accvgpr_read_b32 v47, a79
    v_mfma_f32_16x16x32_bf16 v[168:171], a[196:199], v[68:71], v[168:171]
    ds_read_b128 a[196:199], v187 offset:16384
    v_mfma_f32_16x16x32_bf16 v[228:231], v[224:227], v[40:43], v[228:231]
    v_mfma_f32_16x16x32_bf16 v[168:171], a[200:203], v[72:75], v[168:171]
    ds_read_b128 a[200:203], v186 offset:24576
    v_mul_f32 v44, v114, v44
    v_mul_f32 v45, v114, v45
    v_mfma_f32_16x16x32_bf16 v[168:171], a[204:207], v[76:79], v[168:171]
    ds_read_b128 a[204:207], v187 offset:24576
    v_mul_f32 v46, v114, v46
    v_mul_f32 v47, v114, v47
    v_mfma_f32_16x16x32_bf16 v[164:167], a[220:223], v[60:63], 0
    v_cvt_pk_bf16_f32 v44, v44, v45
    v_mfma_f32_16x16x32_bf16 v[164:167], a[216:219], v[56:59], v[164:167]
    v_cvt_pk_bf16_f32 v45, v46, v47
    v_mfma_f32_16x16x32_bf16 v[164:167], a[212:215], v[52:55], v[164:167]
    v_accvgpr_read_b32 v156, a92
    v_accvgpr_read_b32 v157, a93
    v_accvgpr_read_b32 v158, a94
    v_mfma_f32_16x16x32_bf16 v[164:167], a[208:211], v[48:51], v[164:167]
    v_exp_f32 v160, v160
    v_accvgpr_read_b32 v159, a95
    v_mfma_f32_16x16x32_bf16 v[172:175], a[208:211], v[64:67], 0
    v_exp_f32 v161, v161
    v_exp_f32 v162, v162
    v_exp_f32 v163, v163
    v_mfma_f32_16x16x32_bf16 v[172:175], a[212:215], v[68:71], v[172:175]
    ds_read_b128 a[208:211], v188 offset:16384
    v_cvt_pk_bf16_f32 v160, v160, v161
    v_mul_f32 v156, v114, v156
    v_mul_f32 v157, v114, v157
    v_mfma_f32_16x16x32_bf16 v[172:175], a[216:219], v[72:75], v[172:175]
    ds_read_b128 a[212:215], v189 offset:16384
    v_cvt_pk_bf16_f32 v161, v162, v163
    v_mfma_f32_16x16x32_bf16 v[172:175], a[220:223], v[76:79], v[172:175]
    s_waitcnt lgkmcnt(2)
    v_exp_f32 v168, v168
    v_mfma_f32_16x16x32_bf16 v[132:135], a[192:195], v[64:67], 0
    v_exp_f32 v169, v169
    v_mfma_f32_16x16x32_bf16 v[132:135], a[196:199], v[68:71], v[132:135]
    v_exp_f32 v170, v170
    v_mfma_f32_16x16x32_bf16 v[132:135], a[200:203], v[72:75], v[132:135]
    v_exp_f32 v171, v171
    v_mfma_f32_16x16x32_bf16 v[132:135], a[204:207], v[76:79], v[132:135]
    v_exp_f32 v164, v164
    v_exp_f32 v165, v165
    v_exp_f32 v166, v166
    v_exp_f32 v167, v167
    v_mfma_f32_16x16x32_bf16 a[96:99], a[224:227], v[120:123], a[96:99]
    v_cvt_pk_bf16_f32 v162, v164, v165
    v_cvt_pk_bf16_f32 v168, v168, v169
    v_cvt_pk_bf16_f32 v163, v166, v167
    s_nop 1
    v_mfma_f32_16x16x32_bf16 a[96:99], a[228:231], v[160:163], a[96:99]
    ds_read_b128 a[216:219], v188 offset:24576
    ds_read_b128 a[220:223], v189 offset:24576
    v_cvt_pk_bf16_f32 v169, v170, v171
    v_mfma_f32_16x16x32_bf16 a[112:115], a[236:239], v[160:163], a[112:115]
    ds_read_b128 a[192:195], v190 offset:16384
    ds_read_b128 a[196:199], v191 offset:16384
    v_cvt_pk_bf16_f32 v46, v156, v157
    v_mfma_f32_16x16x32_bf16 a[112:115], a[232:235], v[120:123], a[112:115]
    v_exp_f32 v172, v172
    v_exp_f32 v173, v173
    v_exp_f32 v174, v174
    v_exp_f32 v175, v175
    v_mfma_f32_16x16x32_bf16 a[180:183], v[244:247], v[120:123], a[180:183]
    ds_read_b128 a[200:203], v190 offset:24576
    ds_read_b128 a[204:207], v191 offset:24576
    v_cvt_pk_bf16_f32 v170, v172, v173
    v_mfma_f32_16x16x32_bf16 a[180:183], v[244:247], v[160:163], a[180:183]
    v_cvt_pk_bf16_f32 v171, v174, v175
    v_mul_f32 v158, v114, v158
    v_mul_f32 v159, v114, v159
    v_mfma_f32_16x16x32_bf16 a[144:147], a[232:235], v[128:131], a[144:147]
    ds_read_b64_tr_b16 a[232:233], v196 offset:512
    ds_read_b64_tr_b16 a[234:235], v200 offset:512
    v_cvt_pk_bf16_f32 v47, v158, v159
    v_mfma_f32_16x16x32_bf16 a[144:147], a[236:239], v[168:171], a[144:147]
    ds_read_b64_tr_b16 a[236:237], v204 offset:512
    ds_read_b64_tr_b16 a[238:239], v208 offset:512
    v_exp_f32 v132, v132
    v_mfma_f32_16x16x32_bf16 a[128:131], a[228:231], v[168:171], a[128:131]
    ds_read_b64_tr_b16 a[228:229], v204 offset:0
    ds_read_b64_tr_b16 a[230:231], v208 offset:0
    v_permlane16_swap_b32 v44, v46
    v_mfma_f32_16x16x32_bf16 a[128:131], a[224:227], v[128:131], a[128:131]
    ds_read_b64_tr_b16 a[224:225], v196 offset:0
    ds_read_b64_tr_b16 a[226:227], v200 offset:0
    v_permlane16_swap_b32 v45, v47
    v_mfma_f32_16x16x32_bf16 a[184:187], v[244:247], v[128:131], a[184:187]
    v_exp_f32 v133, v133
    v_exp_f32 v134, v134
    v_mfma_f32_16x16x32_bf16 a[184:187], v[244:247], v[168:171], a[184:187]
    v_exp_f32 v135, v135
    v_cvt_pk_bf16_f32 v132, v132, v133
    v_mfma_f32_16x16x32_bf16 a[132:135], a[240:243], v[128:131], a[132:135]
    v_cvt_pk_bf16_f32 v133, v134, v135
    buffer_store_dwordx4 v[44:47], v243, s[16:19], s58 offen sc1
    v_mfma_f32_16x16x32_bf16 v[228:231], v[224:227], v[44:47], v[228:231]
    v_mfma_f32_16x16x32_bf16 a[132:135], a[244:247], v[168:171], a[132:135]
    v_accvgpr_read_b32 v183, a180
    v_accvgpr_read_b32 v48, a96
    v_accvgpr_read_b32 v49, a97
    v_mfma_f32_16x16x32_bf16 a[148:151], a[252:255], v[168:171], a[148:151]
    v_rcp_f32 v126, v183
    v_min_f32 v239, v239, v183
    v_max_f32 v240, v240, v183
    v_mfma_f32_16x16x32_bf16 a[148:151], a[248:251], v[128:131], a[148:151]
    v_accvgpr_read_b32 v50, a98
    v_mul_f32 v48, v126, v48
    v_mul_f32 v49, v126, v49
    v_mfma_f32_16x16x32_bf16 a[116:119], a[248:251], v[120:123], a[116:119]
    ds_read_b64_tr_b16 a[248:249], v197 offset:512
    ds_read_b64_tr_b16 a[250:251], v201 offset:512
    v_accvgpr_read_b32 v51, a99
    v_cvt_pk_bf16_f32 v48, v48, v49
    v_mfma_f32_16x16x32_bf16 a[116:119], a[252:255], v[160:163], a[116:119]
    ds_read_b64_tr_b16 a[252:253], v205 offset:512
    v_mul_f32 v50, v126, v50
    v_mul_f32 v51, v126, v51
    v_mfma_f32_16x16x32_bf16 a[100:103], a[244:247], v[160:163], a[100:103]
    ds_read_b64_tr_b16 a[244:245], v205 offset:0
    ds_read_b64_tr_b16 a[246:247], v209 offset:0
    v_cvt_pk_bf16_f32 v49, v50, v51
    v_mfma_f32_16x16x32_bf16 a[100:103], a[240:243], v[120:123], a[100:103]
    s_waitcnt lgkmcnt(5)
    ds_read_b64_tr_b16 a[240:241], v197 offset:0
    ds_read_b64_tr_b16 a[242:243], v201 offset:0
    v_accvgpr_read_b32 v164, a112
    v_accvgpr_read_b32 v165, a113
    v_mfma_f32_16x16x32_bf16 v[172:175], a[208:211], v[64:67], 0
    ds_read_b128 a[208:211], v192 offset:16384
    ds_read_b64_tr_b16 a[254:255], v209 offset:512
    v_accvgpr_read_b32 v166, a114
    v_mfma_f32_16x16x32_bf16 v[172:175], a[212:215], v[68:71], v[172:175]
    ds_read_b128 a[212:215], v193 offset:16384
    v_accvgpr_read_b32 v167, a115
    v_mul_f32 v164, v126, v164
    v_mul_f32 v165, v126, v165
    v_mfma_f32_16x16x32_bf16 v[172:175], a[216:219], v[72:75], v[172:175]
    ds_read_b128 a[216:219], v192 offset:24576
    v_mul_f32 v166, v126, v166
    v_mul_f32 v167, v126, v167
    v_mfma_f32_16x16x32_bf16 v[172:175], a[220:223], v[76:79], v[172:175]
    ds_read_b128 a[220:223], v193 offset:24576
    v_cvt_pk_bf16_f32 v50, v164, v165
    v_accvgpr_read_b32 v52, a100
    v_accvgpr_read_b32 v53, a101
    v_mfma_f32_16x16x32_bf16 a[104:107], a[224:227], v[120:123], a[104:107]
    v_cvt_pk_bf16_f32 v51, v166, v167
    v_accvgpr_read_b32 v54, a102
    v_accvgpr_read_b32 v55, a103
    v_mfma_f32_16x16x32_bf16 a[104:107], a[228:231], v[160:163], a[104:107]
    v_permlane16_swap_b32 v48, v50
    v_permlane16_swap_b32 v49, v51
    v_mul_f32 v52, v126, v52
    v_mul_f32 v53, v126, v53
    v_mfma_f32_16x16x32_bf16 a[120:123], a[236:239], v[160:163], a[120:123]
    buffer_store_dwordx4 v[48:51], v238, s[16:19], s59 offen sc1
    v_mfma_f32_16x16x32_bf16 v[228:231], v[224:227], v[48:51], v[228:231]
    v_mfma_f32_16x16x32_bf16 a[120:123], a[232:235], v[120:123], a[120:123]
    v_cvt_pk_bf16_f32 v52, v52, v53
    v_mul_f32 v54, v126, v54
    v_mul_f32 v55, v126, v55
    v_mfma_f32_16x16x32_bf16 a[152:155], a[232:235], v[128:131], a[152:155]
    ds_read_b64_tr_b16 a[232:233], v194 offset:16896
    ds_read_b64_tr_b16 a[234:235], v198 offset:16896
    v_cvt_pk_bf16_f32 v53, v54, v55
    v_mfma_f32_16x16x32_bf16 a[152:155], a[236:239], v[168:171], a[152:155]
    ds_read_b64_tr_b16 a[236:237], v202 offset:16896
    ds_read_b64_tr_b16 a[238:239], v206 offset:16896
    v_accvgpr_read_b32 v164, a116
    v_mfma_f32_16x16x32_bf16 a[136:139], a[228:231], v[168:171], a[136:139]
    ds_read_b64_tr_b16 a[228:229], v202 offset:16384
    ds_read_b64_tr_b16 a[230:231], v206 offset:16384
    v_accvgpr_read_b32 v165, a117
    v_accvgpr_read_b32 v166, a118
    v_mfma_f32_16x16x32_bf16 a[136:139], a[224:227], v[128:131], a[136:139]
    s_waitcnt lgkmcnt(6)
    ds_read_b64_tr_b16 a[224:225], v194 offset:16384
    ds_read_b64_tr_b16 a[226:227], v198 offset:16384
    v_accvgpr_read_b32 v167, a119
    v_mfma_f32_16x16x32_bf16 a[140:143], a[240:243], v[128:131], a[140:143]
    v_exp_f32 v172, v172
    v_exp_f32 v173, v173
    v_mfma_f32_16x16x32_bf16 a[140:143], a[244:247], v[168:171], a[140:143]
    v_exp_f32 v174, v174
    v_cvt_pk_bf16_f32 v134, v172, v173
    v_mfma_f32_16x16x32_bf16 a[156:159], a[252:255], v[168:171], a[156:159]
    v_exp_f32 v175, v175
    v_accvgpr_read_b32 v56, a104
    v_mfma_f32_16x16x32_bf16 a[156:159], a[248:251], v[128:131], a[156:159]
    v_cvt_pk_bf16_f32 v135, v174, v175
    v_accvgpr_read_b32 v57, a105
    v_mul_f32 v164, v126, v164
    v_mul_f32 v165, v126, v165
    v_mfma_f32_16x16x32_bf16 a[124:127], a[248:251], v[120:123], a[124:127]
    ds_read_b64_tr_b16 a[248:249], v195 offset:16896
    ds_read_b64_tr_b16 a[250:251], v199 offset:16896
    v_cvt_pk_bf16_f32 v54, v164, v165
    v_mfma_f32_16x16x32_bf16 a[124:127], a[252:255], v[160:163], a[124:127]
    ds_read_b64_tr_b16 a[252:253], v203 offset:16896
    ds_read_b64_tr_b16 a[254:255], v207 offset:16896
    v_mul_f32 v166, v126, v166
    v_mul_f32 v167, v126, v167
    v_mfma_f32_16x16x32_bf16 a[108:111], a[244:247], v[160:163], a[108:111]
    ds_read_b64_tr_b16 a[244:245], v203 offset:16384
    ds_read_b64_tr_b16 a[246:247], v207 offset:16384
    v_cvt_pk_bf16_f32 v55, v166, v167
    v_mfma_f32_16x16x32_bf16 a[108:111], a[240:243], v[120:123], a[108:111]
    ds_read_b64_tr_b16 a[240:241], v195 offset:16384
    ds_read_b64_tr_b16 a[242:243], v199 offset:16384
    v_permlane16_swap_b32 v52, v54
    v_permlane16_swap_b32 v53, v55
    v_mfma_f32_16x16x32_bf16 v[168:171], a[192:195], v[64:67], 0
    buffer_store_dwordx4 v[52:55], v241, s[16:19], s59 offen sc1
    v_mfma_f32_16x16x32_bf16 v[228:231], v[224:227], v[52:55], v[228:231]
    v_mfma_f32_16x16x32_bf16 v[168:171], a[196:199], v[68:71], v[168:171]
    v_accvgpr_read_b32 v58, a106
    v_accvgpr_read_b32 v59, a107
    v_mul_f32 v56, v126, v56
    v_mul_f32 v57, v126, v57
    v_mfma_f32_16x16x32_bf16 v[168:171], a[200:203], v[72:75], v[168:171]
    v_cvt_pk_bf16_f32 v56, v56, v57
    v_mul_f32 v58, v126, v58
    v_mul_f32 v59, v126, v59
    v_mfma_f32_16x16x32_bf16 v[168:171], a[204:207], v[76:79], v[168:171]
    s_waitcnt lgkmcnt(0)
    v_cvt_pk_bf16_f32 v57, v58, v59
    v_accvgpr_read_b32 v60, a108
    v_accvgpr_read_b32 v61, a109
    v_mfma_f32_16x16x32_bf16 a[128:131], a[224:227], v[132:135], a[128:131]
    ds_read_b64_tr_b16 a[224:225], v196 offset:16384
    ds_read_b64_tr_b16 a[226:227], v200 offset:16384
    v_accvgpr_read_b32 v164, a120
    v_accvgpr_read_b32 v165, a121
    v_mfma_f32_16x16x32_bf16 a[184:187], v[244:247], v[132:135], a[184:187]
    v_accvgpr_read_b32 v166, a122
    v_accvgpr_read_b32 v167, a123
    v_accvgpr_read_b32 v62, a110
    v_mfma_f32_16x16x32_bf16 a[144:147], a[232:235], v[132:135], a[144:147]
    ds_read_b64_tr_b16 a[232:233], v196 offset:16896
    ds_read_b64_tr_b16 a[234:235], v200 offset:16896
    v_mul_f32 v164, v126, v164
    v_mul_f32 v165, v126, v165
    v_mfma_f32_16x16x32_bf16 a[132:135], a[240:243], v[132:135], a[132:135]
    ds_read_b64_tr_b16 a[240:241], v197 offset:16384
    ds_read_b64_tr_b16 a[242:243], v201 offset:16384
    v_cvt_pk_bf16_f32 v58, v164, v165
    v_mfma_f32_16x16x32_bf16 a[148:151], a[248:251], v[132:135], a[148:151]
    ds_read_b64_tr_b16 a[248:249], v197 offset:16896
    ds_read_b64_tr_b16 a[250:251], v201 offset:16896
    v_mul_f32 v166, v126, v166
    v_mul_f32 v167, v126, v167
    v_mfma_f32_16x16x32_bf16 v[172:175], a[208:211], v[64:67], 0
    v_cvt_pk_bf16_f32 v59, v166, v167
    v_mul_f32 v60, v126, v60
    v_mul_f32 v61, v126, v61
    v_mfma_f32_16x16x32_bf16 v[172:175], a[212:215], v[68:71], v[172:175]
    v_permlane16_swap_b32 v56, v58
    v_permlane16_swap_b32 v57, v59
    v_accvgpr_read_b32 v63, a111
    v_cvt_pk_bf16_f32 v60, v60, v61
    v_mfma_f32_16x16x32_bf16 v[172:175], a[216:219], v[72:75], v[172:175]
    v_exp_f32 v168, v168
    v_exp_f32 v169, v169
    v_exp_f32 v170, v170
    v_exp_f32 v171, v171
    v_mfma_f32_16x16x32_bf16 v[172:175], a[220:223], v[76:79], v[172:175]
    v_cvt_pk_bf16_f32 v168, v168, v169
    v_mfma_f32_16x16x32_bf16 v[228:231], v[224:227], v[56:59], v[228:231]
    s_nop 5
    v_exp_f32 v172, v172
    v_exp_f32 v173, v173
    v_exp_f32 v174, v174
    v_exp_f32 v175, v175
    v_cvt_pk_bf16_f32 v169, v170, v171
    v_cvt_pk_bf16_f32 v170, v172, v173
    v_cvt_pk_bf16_f32 v171, v174, v175
    s_nop 1
    v_mfma_f32_16x16x32_bf16 a[128:131], a[228:231], v[168:171], a[128:131]
    ds_read_b64_tr_b16 a[228:229], v204 offset:16384
    ds_read_b64_tr_b16 a[230:231], v208 offset:16384
    v_mfma_f32_16x16x32_bf16 a[184:187], v[244:247], v[168:171], a[184:187]
    v_mul_f32 v62, v126, v62
    v_mul_f32 v63, v126, v63
    v_mfma_f32_16x16x32_bf16 a[144:147], a[236:239], v[168:171], a[144:147]
    ds_read_b64_tr_b16 a[236:237], v204 offset:16896
    ds_read_b64_tr_b16 a[238:239], v208 offset:16896
    v_mfma_f32_16x16x32_bf16 a[132:135], a[244:247], v[168:171], a[132:135]
    ds_read_b64_tr_b16 a[244:245], v205 offset:16384
    ds_read_b64_tr_b16 a[246:247], v209 offset:16384
    v_mfma_f32_16x16x32_bf16 a[148:151], a[252:255], v[168:171], a[148:151]
    s_waitcnt lgkmcnt(6)
    ds_read_b64_tr_b16 a[252:253], v205 offset:16896
    ds_read_b64_tr_b16 a[254:255], v209 offset:16896
    v_mfma_f32_16x16x32_bf16 a[136:139], a[224:227], v[132:135], a[136:139]
    buffer_store_dwordx4 v[56:59], v242, s[16:19], s59 offen sc1
    v_cvt_pk_bf16_f32 v61, v62, v63
    v_mfma_f32_16x16x32_bf16 a[152:155], a[232:235], v[132:135], a[152:155]
    v_accvgpr_read_b32 v164, a124
    v_accvgpr_read_b32 v165, a125
    v_mfma_f32_16x16x32_bf16 a[140:143], a[240:243], v[132:135], a[140:143]
    v_accvgpr_read_b32 v166, a126
    v_accvgpr_read_b32 v167, a127
    v_mfma_f32_16x16x32_bf16 a[156:159], a[248:251], v[132:135], a[156:159]
    s_waitcnt lgkmcnt(0)
    v_mul_f32 v164, v126, v164
    v_mul_f32 v165, v126, v165
    v_mfma_f32_16x16x32_bf16 a[136:139], a[228:231], v[168:171], a[136:139]
    v_mul_f32 v166, v126, v166
    v_mul_f32 v167, v126, v167
    v_mfma_f32_16x16x32_bf16 a[152:155], a[236:239], v[168:171], a[152:155]
    v_cvt_pk_bf16_f32 v62, v164, v165
    v_accvgpr_read_b32 v184, a184
    v_mfma_f32_16x16x32_bf16 a[140:143], a[244:247], v[168:171], a[140:143]
    v_cvt_pk_bf16_f32 v63, v166, v167
    v_accvgpr_read_b32 v64, a128
    v_mfma_f32_16x16x32_bf16 a[156:159], a[252:255], v[168:171], a[156:159]
    v_permlane16_swap_b32 v60, v62
    v_permlane16_swap_b32 v61, v63
    buffer_store_dwordx4 v[60:63], v243, s[16:19], s59 offen sc1
    v_accvgpr_read_b32 v65, a129
    v_mfma_f32_16x16x32_bf16 v[228:231], v[224:227], v[60:63], v[228:231]
    v_rcp_f32 v130, v184
    v_min_f32 v239, v239, v184
    v_max_f32 v240, v240, v184
    v_accvgpr_read_b32 v66, a130
    v_accvgpr_read_b32 v67, a131
    v_pk_mul_f32 v[64:65], v[64:65], v[130:131] op_sel_hi:[1,0]
    v_pk_mul_f32 v[66:67], v[66:67], v[130:131] op_sel_hi:[1,0]
    v_cvt_pk_bf16_f32 v64, v64, v65
    v_cvt_pk_bf16_f32 v65, v66, v67
    ds_write_b64 v216, v[64:65] offset:0
    v_accvgpr_read_b32 v68, a144
    v_accvgpr_read_b32 v69, a145
    v_accvgpr_read_b32 v70, a146
    v_accvgpr_read_b32 v71, a147
    v_pk_mul_f32 v[68:69], v[68:69], v[130:131] op_sel_hi:[1,0]
    v_pk_mul_f32 v[70:71], v[70:71], v[130:131] op_sel_hi:[1,0]
    v_cvt_pk_bf16_f32 v68, v68, v69
    v_cvt_pk_bf16_f32 v69, v70, v71
    ds_write_b64 v216, v[68:69] offset:32
    v_accvgpr_read_b32 v72, a132
    v_accvgpr_read_b32 v73, a133
    v_accvgpr_read_b32 v74, a134
    v_accvgpr_read_b32 v75, a135
    v_pk_mul_f32 v[72:73], v[72:73], v[130:131] op_sel_hi:[1,0]
    v_pk_mul_f32 v[74:75], v[74:75], v[130:131] op_sel_hi:[1,0]
    v_cvt_pk_bf16_f32 v72, v72, v73
    v_cvt_pk_bf16_f32 v73, v74, v75
    ds_write_b64 v217, v[72:73] offset:0
    v_accvgpr_read_b32 v76, a148
    v_accvgpr_read_b32 v77, a149
    v_accvgpr_read_b32 v78, a150
    v_accvgpr_read_b32 v79, a151
    v_pk_mul_f32 v[76:77], v[76:77], v[130:131] op_sel_hi:[1,0]
    v_pk_mul_f32 v[78:79], v[78:79], v[130:131] op_sel_hi:[1,0]
    v_cvt_pk_bf16_f32 v76, v76, v77
    v_cvt_pk_bf16_f32 v77, v78, v79
    ds_write_b64 v217, v[76:77] offset:32
    v_accvgpr_read_b32 v64, a136
    v_accvgpr_read_b32 v65, a137
    v_accvgpr_read_b32 v66, a138
    v_accvgpr_read_b32 v67, a139
    v_pk_mul_f32 v[64:65], v[64:65], v[130:131] op_sel_hi:[1,0]
    v_pk_mul_f32 v[66:67], v[66:67], v[130:131] op_sel_hi:[1,0]
    v_cvt_pk_bf16_f32 v64, v64, v65
    v_cvt_pk_bf16_f32 v65, v66, v67
    ds_write_b64 v222, v[64:65] offset:0
    v_accvgpr_read_b32 v68, a152
    v_accvgpr_read_b32 v69, a153
    v_accvgpr_read_b32 v70, a154
    v_accvgpr_read_b32 v71, a155
    v_pk_mul_f32 v[68:69], v[68:69], v[130:131] op_sel_hi:[1,0]
    v_pk_mul_f32 v[70:71], v[70:71], v[130:131] op_sel_hi:[1,0]
    v_cvt_pk_bf16_f32 v68, v68, v69
    v_cvt_pk_bf16_f32 v69, v70, v71
    ds_write_b64 v222, v[68:69] offset:32
    v_accvgpr_read_b32 v72, a140
    v_accvgpr_read_b32 v73, a141
    v_accvgpr_read_b32 v74, a142
    v_accvgpr_read_b32 v75, a143
    v_pk_mul_f32 v[72:73], v[72:73], v[130:131] op_sel_hi:[1,0]
    v_pk_mul_f32 v[74:75], v[74:75], v[130:131] op_sel_hi:[1,0]
    v_cvt_pk_bf16_f32 v72, v72, v73
    v_cvt_pk_bf16_f32 v73, v74, v75
    ds_write_b64 v223, v[72:73] offset:0
    v_accvgpr_read_b32 v76, a156
    v_accvgpr_read_b32 v77, a157
    v_accvgpr_read_b32 v78, a158
    v_accvgpr_read_b32 v79, a159
    v_pk_mul_f32 v[76:77], v[76:77], v[130:131] op_sel_hi:[1,0]
    v_pk_mul_f32 v[78:79], v[78:79], v[130:131] op_sel_hi:[1,0]
    v_cvt_pk_bf16_f32 v76, v76, v77
    v_cvt_pk_bf16_f32 v77, v78, v79
    ds_write_b64 v223, v[76:77] offset:32
    ds_read_b128 v[64:67], v236 offset:0
    ds_read_b128 v[68:71], v236 offset:1088
    ds_read_b128 v[72:75], v236 offset:2176
    ds_read_b128 v[76:79], v236 offset:3264
    s_waitcnt lgkmcnt(2)
    buffer_store_dwordx4 v[64:67], v237, s[16:19], s60 offen offset:0 sc1
    v_mfma_f32_16x16x32_bf16 v[228:231], v[224:227], v[64:67], v[228:231]
    buffer_store_dwordx4 v[68:71], v237, s[16:19], s60 offen offset:1024 sc1
    v_mfma_f32_16x16x32_bf16 v[228:231], v[224:227], v[68:71], v[228:231]
    s_waitcnt lgkmcnt(0)
    buffer_store_dwordx4 v[72:75], v237, s[16:19], s60 offen offset:2048 sc1
    v_mfma_f32_16x16x32_bf16 v[228:231], v[224:227], v[72:75], v[228:231]
    buffer_store_dwordx4 v[76:79], v237, s[16:19], s60 offen offset:3072 sc1
    v_mfma_f32_16x16x32_bf16 v[228:231], v[224:227], v[76:79], v[228:231]
    v_cmp_nle_f32_e64 s[30:31], s54, v239
    v_cmp_nge_f32_e64 s[32:33], s55, v240
    s_nop 5
    v_cmp_u_f32 vcc, v228, v229
    s_or_b64 s[30:31], s[30:31], s[32:33]
    s_or_b64 s[30:31], s[30:31], vcc
    s_cmp_lg_u64 s[30:31], 0
    s_cbranch_scc1 L_slow
L_end:
    s_endpgm
L_slow:
    s_waitcnt vmcnt(0) lgkmcnt(0)
    s_barrier
    s_mov_b32 s10, 262144
    s_mov_b32 s14, 262144
    buffer_load_dwordx4 v[0:3], v232, s[4:7], s56 offen offset:0 nt
    buffer_load_dwordx4 v[4:7], v232, s[4:7], s56 offen offset:64 nt
    buffer_load_dwordx4 v[8:11], v232, s[4:7], s56 offen offset:128 nt
    buffer_load_dwordx4 v[12:15], v232, s[4:7], s56 offen offset:192 nt
    buffer_load_dwordx4 v[16:19], v232, s[4:7], s57 offen offset:0 nt
    buffer_load_dwordx4 v[20:23], v232, s[4:7], s57 offen offset:64 nt
    buffer_load_dwordx4 v[24:27], v232, s[4:7], s57 offen offset:128 nt
    buffer_load_dwordx4 v[28:31], v232, s[4:7], s57 offen offset:192 nt
    buffer_load_dwordx4 v[32:35], v232, s[4:7], s58 offen offset:0 nt
    buffer_load_dwordx4 v[36:39], v232, s[4:7], s58 offen offset:64 nt
    buffer_load_dwordx4 v[40:43], v232, s[4:7], s58 offen offset:128 nt
    buffer_load_dwordx4 v[44:47], v232, s[4:7], s58 offen offset:192 nt
    buffer_load_dwordx4 v[48:51], v232, s[4:7], s59 offen offset:0 nt
    buffer_load_dwordx4 v[52:55], v232, s[4:7], s59 offen offset:64 nt
    buffer_load_dwordx4 v[56:59], v232, s[4:7], s59 offen offset:128 nt
    buffer_load_dwordx4 v[60:63], v232, s[4:7], s59 offen offset:192 nt
    buffer_load_dwordx4 v[64:67], v232, s[4:7], s60 offen offset:0 nt
    buffer_load_dwordx4 v[68:71], v232, s[4:7], s60 offen offset:64 nt
    buffer_load_dwordx4 v[72:75], v232, s[4:7], s60 offen offset:128 nt
    buffer_load_dwordx4 v[76:79], v232, s[4:7], s60 offen offset:192 nt
    buffer_load_dwordx4 v[80:83], v232, s[4:7], s61 offen offset:0 nt
    buffer_load_dwordx4 v[84:87], v232, s[4:7], s61 offen offset:64 nt
    buffer_load_dwordx4 v[88:91], v232, s[4:7], s61 offen offset:128 nt
    buffer_load_dwordx4 v[92:95], v232, s[4:7], s61 offen offset:192 nt
    v_accvgpr_write_b32 a0, 0
    v_accvgpr_write_b32 a1, 0
    v_accvgpr_write_b32 a2, 0
    v_accvgpr_write_b32 a3, 0
    v_accvgpr_write_b32 a4, 0
    v_accvgpr_write_b32 a5, 0
    v_accvgpr_write_b32 a6, 0
    v_accvgpr_write_b32 a7, 0
    v_accvgpr_write_b32 a8, 0
    v_accvgpr_write_b32 a9, 0
    v_accvgpr_write_b32 a10, 0
    v_accvgpr_write_b32 a11, 0
    v_accvgpr_write_b32 a12, 0
    v_accvgpr_write_b32 a13, 0
    v_accvgpr_write_b32 a14, 0
    v_accvgpr_write_b32 a15, 0
    v_accvgpr_write_b32 a16, 0
    v_accvgpr_write_b32 a17, 0
    v_accvgpr_write_b32 a18, 0
    v_accvgpr_write_b32 a19, 0
    v_accvgpr_write_b32 a20, 0
    v_accvgpr_write_b32 a21, 0
    v_accvgpr_write_b32 a22, 0
    v_accvgpr_write_b32 a23, 0
    v_accvgpr_write_b32 a24, 0
    v_accvgpr_write_b32 a25, 0
    v_accvgpr_write_b32 a26, 0
    v_accvgpr_write_b32 a27, 0
    v_accvgpr_write_b32 a28, 0
    v_accvgpr_write_b32 a29, 0
    v_accvgpr_write_b32 a30, 0
    v_accvgpr_write_b32 a31, 0
    v_accvgpr_write_b32 a32, 0
    v_accvgpr_write_b32 a33, 0
    v_accvgpr_write_b32 a34, 0
    v_accvgpr_write_b32 a35, 0
    v_accvgpr_write_b32 a36, 0
    v_accvgpr_write_b32 a37, 0
    v_accvgpr_write_b32 a38, 0
    v_accvgpr_write_b32 a39, 0
    v_accvgpr_write_b32 a40, 0
    v_accvgpr_write_b32 a41, 0
    v_accvgpr_write_b32 a42, 0
    v_accvgpr_write_b32 a43, 0
    v_accvgpr_write_b32 a44, 0
    v_accvgpr_write_b32 a45, 0
    v_accvgpr_write_b32 a46, 0
    v_accvgpr_write_b32 a47, 0
    v_accvgpr_write_b32 a48, 0
    v_accvgpr_write_b32 a49, 0
    v_accvgpr_write_b32 a50, 0
    v_accvgpr_write_b32 a51, 0
    v_accvgpr_write_b32 a52, 0
    v_accvgpr_write_b32 a53, 0
    v_accvgpr_write_b32 a54, 0
    v_accvgpr_write_b32 a55, 0
    v_accvgpr_write_b32 a56, 0
    v_accvgpr_write_b32 a57, 0
    v_accvgpr_write_b32 a58, 0
    v_accvgpr_write_b32 a59, 0
    v_accvgpr_write_b32 a60, 0
    v_accvgpr_write_b32 a61, 0
    v_accvgpr_write_b32 a62, 0
    v_accvgpr_write_b32 a63, 0
    v_accvgpr_write_b32 a64, 0
    v_accvgpr_write_b32 a65, 0
    v_accvgpr_write_b32 a66, 0
    v_accvgpr_write_b32 a67, 0
    v_accvgpr_write_b32 a68, 0
    v_accvgpr_write_b32 a69, 0
    v_accvgpr_write_b32 a70, 0
    v_accvgpr_write_b32 a71, 0
    v_accvgpr_write_b32 a72, 0
    v_accvgpr_write_b32 a73, 0
    v_accvgpr_write_b32 a74, 0
    v_accvgpr_write_b32 a75, 0
    v_accvgpr_write_b32 a76, 0
    v_accvgpr_write_b32 a77, 0
    v_accvgpr_write_b32 a78, 0
    v_accvgpr_write_b32 a79, 0
    v_accvgpr_write_b32 a80, 0
    v_accvgpr_write_b32 a81, 0
    v_accvgpr_write_b32 a82, 0
    v_accvgpr_write_b32 a83, 0
    v_accvgpr_write_b32 a84, 0
    v_accvgpr_write_b32 a85, 0
    v_accvgpr_write_b32 a86, 0
    v_accvgpr_write_b32 a87, 0
    v_accvgpr_write_b32 a88, 0
    v_accvgpr_write_b32 a89, 0
    v_accvgpr_write_b32 a90, 0
    v_accvgpr_write_b32 a91, 0
    v_accvgpr_write_b32 a92, 0
    v_accvgpr_write_b32 a93, 0
    v_accvgpr_write_b32 a94, 0
    v_accvgpr_write_b32 a95, 0
    v_accvgpr_write_b32 a96, 0
    v_accvgpr_write_b32 a97, 0
    v_accvgpr_write_b32 a98, 0
    v_accvgpr_write_b32 a99, 0
    v_accvgpr_write_b32 a100, 0
    v_accvgpr_write_b32 a101, 0
    v_accvgpr_write_b32 a102, 0
    v_accvgpr_write_b32 a103, 0
    v_accvgpr_write_b32 a104, 0
    v_accvgpr_write_b32 a105, 0
    v_accvgpr_write_b32 a106, 0
    v_accvgpr_write_b32 a107, 0
    v_accvgpr_write_b32 a108, 0
    v_accvgpr_write_b32 a109, 0
    v_accvgpr_write_b32 a110, 0
    v_accvgpr_write_b32 a111, 0
    v_accvgpr_write_b32 a112, 0
    v_accvgpr_write_b32 a113, 0
    v_accvgpr_write_b32 a114, 0
    v_accvgpr_write_b32 a115, 0
    v_accvgpr_write_b32 a116, 0
    v_accvgpr_write_b32 a117, 0
    v_accvgpr_write_b32 a118, 0
    v_accvgpr_write_b32 a119, 0
    v_accvgpr_write_b32 a120, 0
    v_accvgpr_write_b32 a121, 0
    v_accvgpr_write_b32 a122, 0
    v_accvgpr_write_b32 a123, 0
    v_accvgpr_write_b32 a124, 0
    v_accvgpr_write_b32 a125, 0
    v_accvgpr_write_b32 a126, 0
    v_accvgpr_write_b32 a127, 0
    v_accvgpr_write_b32 a128, 0
    v_accvgpr_write_b32 a129, 0
    v_accvgpr_write_b32 a130, 0
    v_accvgpr_write_b32 a131, 0
    v_accvgpr_write_b32 a132, 0
    v_accvgpr_write_b32 a133, 0
    v_accvgpr_write_b32 a134, 0
    v_accvgpr_write_b32 a135, 0
    v_accvgpr_write_b32 a136, 0
    v_accvgpr_write_b32 a137, 0
    v_accvgpr_write_b32 a138, 0
    v_accvgpr_write_b32 a139, 0
    v_accvgpr_write_b32 a140, 0
    v_accvgpr_write_b32 a141, 0
    v_accvgpr_write_b32 a142, 0
    v_accvgpr_write_b32 a143, 0
    v_accvgpr_write_b32 a144, 0
    v_accvgpr_write_b32 a145, 0
    v_accvgpr_write_b32 a146, 0
    v_accvgpr_write_b32 a147, 0
    v_accvgpr_write_b32 a148, 0
    v_accvgpr_write_b32 a149, 0
    v_accvgpr_write_b32 a150, 0
    v_accvgpr_write_b32 a151, 0
    v_accvgpr_write_b32 a152, 0
    v_accvgpr_write_b32 a153, 0
    v_accvgpr_write_b32 a154, 0
    v_accvgpr_write_b32 a155, 0
    v_accvgpr_write_b32 a156, 0
    v_accvgpr_write_b32 a157, 0
    v_accvgpr_write_b32 a158, 0
    v_accvgpr_write_b32 a159, 0
    v_accvgpr_write_b32 a160, 0
    v_accvgpr_write_b32 a161, 0
    v_accvgpr_write_b32 a162, 0
    v_accvgpr_write_b32 a163, 0
    v_accvgpr_write_b32 a164, 0
    v_accvgpr_write_b32 a165, 0
    v_accvgpr_write_b32 a166, 0
    v_accvgpr_write_b32 a167, 0
    v_accvgpr_write_b32 a168, 0
    v_accvgpr_write_b32 a169, 0
    v_accvgpr_write_b32 a170, 0
    v_accvgpr_write_b32 a171, 0
    v_accvgpr_write_b32 a172, 0
    v_accvgpr_write_b32 a173, 0
    v_accvgpr_write_b32 a174, 0
    v_accvgpr_write_b32 a175, 0
    v_accvgpr_write_b32 a176, 0
    v_accvgpr_write_b32 a177, 0
    v_accvgpr_write_b32 a178, 0
    v_accvgpr_write_b32 a179, 0
    v_accvgpr_write_b32 a180, 0
    v_accvgpr_write_b32 a181, 0
    v_accvgpr_write_b32 a182, 0
    v_accvgpr_write_b32 a183, 0
    v_accvgpr_write_b32 a184, 0
    v_accvgpr_write_b32 a185, 0
    v_accvgpr_write_b32 a186, 0
    v_accvgpr_write_b32 a187, 0
    v_accvgpr_write_b32 a188, 0
    v_accvgpr_write_b32 a189, 0
    v_accvgpr_write_b32 a190, 0
    v_accvgpr_write_b32 a191, 0
    v_mov_b32 v180, 0
    v_mov_b32 v164, 0xff800000
    v_mov_b32 v181, 0
    v_mov_b32 v165, 0xff800000
    v_mov_b32 v182, 0
    v_mov_b32 v166, 0xff800000
    v_mov_b32 v183, 0
    v_mov_b32 v167, 0xff800000
    v_mov_b32 v184, 0
    v_mov_b32 v168, 0xff800000
    v_mov_b32 v185, 0
    v_mov_b32 v169, 0xff800000
    s_lshl_b32 s33, s20, 12
    s_lshl_b32 s24, s20, 14
    s_sub_u32 s32, s24, 65536
    v_subrev_u32 v210, s26, v210
    v_subrev_u32 v214, s33, v214
    v_add_u32 v186, s24, v186
    v_add_u32 v187, s24, v187
    v_add_u32 v194, s32, v194
    v_add_u32 v195, s32, v195
    v_add_u32 v196, s32, v196
    v_add_u32 v197, s32, v197
    v_subrev_u32 v211, s26, v211
    v_subrev_u32 v215, s33, v215
    v_add_u32 v188, s24, v188
    v_add_u32 v189, s24, v189
    v_add_u32 v198, s32, v198
    v_add_u32 v199, s32, v199
    v_add_u32 v200, s32, v200
    v_add_u32 v201, s32, v201
    v_subrev_u32 v212, s26, v212
    v_add_u32 v190, s24, v190
    v_add_u32 v191, s24, v191
    v_add_u32 v202, s32, v202
    v_add_u32 v203, s32, v203
    v_add_u32 v204, s32, v204
    v_add_u32 v205, s32, v205
    v_subrev_u32 v213, s26, v213
    v_add_u32 v192, s24, v192
    v_add_u32 v193, s24, v193
    v_add_u32 v206, s32, v206
    v_add_u32 v207, s32, v207
    v_add_u32 v208, s32, v208
    v_add_u32 v209, s32, v209
    s_waitcnt vmcnt(0)
    v_lshlrev_b32 v244, 16, v0
    v_and_b32 v245, 0xffff0000, v0
    v_pk_mul_f32 v[244:245], v[244:245], s[28:29]
    v_cvt_pk_bf16_f32 v0, v244, v245
    v_lshlrev_b32 v246, 16, v1
    v_and_b32 v247, 0xffff0000, v1
    v_pk_mul_f32 v[246:247], v[246:247], s[28:29]
    v_cvt_pk_bf16_f32 v1, v246, v247
    v_lshlrev_b32 v248, 16, v2
    v_and_b32 v249, 0xffff0000, v2
    v_pk_mul_f32 v[248:249], v[248:249], s[28:29]
    v_cvt_pk_bf16_f32 v2, v248, v249
    v_lshlrev_b32 v250, 16, v3
    v_and_b32 v251, 0xffff0000, v3
    v_pk_mul_f32 v[250:251], v[250:251], s[28:29]
    v_cvt_pk_bf16_f32 v3, v250, v251
    v_lshlrev_b32 v244, 16, v4
    v_and_b32 v245, 0xffff0000, v4
    v_pk_mul_f32 v[244:245], v[244:245], s[28:29]
    v_cvt_pk_bf16_f32 v4, v244, v245
    v_lshlrev_b32 v246, 16, v5
    v_and_b32 v247, 0xffff0000, v5
    v_pk_mul_f32 v[246:247], v[246:247], s[28:29]
    v_cvt_pk_bf16_f32 v5, v246, v247
    v_lshlrev_b32 v248, 16, v6
    v_and_b32 v249, 0xffff0000, v6
    v_pk_mul_f32 v[248:249], v[248:249], s[28:29]
    v_cvt_pk_bf16_f32 v6, v248, v249
    v_lshlrev_b32 v250, 16, v7
    v_and_b32 v251, 0xffff0000, v7
    v_pk_mul_f32 v[250:251], v[250:251], s[28:29]
    v_cvt_pk_bf16_f32 v7, v250, v251
    v_lshlrev_b32 v244, 16, v8
    v_and_b32 v245, 0xffff0000, v8
    v_pk_mul_f32 v[244:245], v[244:245], s[28:29]
    v_cvt_pk_bf16_f32 v8, v244, v245
    v_lshlrev_b32 v246, 16, v9
    v_and_b32 v247, 0xffff0000, v9
    v_pk_mul_f32 v[246:247], v[246:247], s[28:29]
    v_cvt_pk_bf16_f32 v9, v246, v247
    v_lshlrev_b32 v248, 16, v10
    v_and_b32 v249, 0xffff0000, v10
    v_pk_mul_f32 v[248:249], v[248:249], s[28:29]
    v_cvt_pk_bf16_f32 v10, v248, v249
    v_lshlrev_b32 v250, 16, v11
    v_and_b32 v251, 0xffff0000, v11
    v_pk_mul_f32 v[250:251], v[250:251], s[28:29]
    v_cvt_pk_bf16_f32 v11, v250, v251
    v_lshlrev_b32 v244, 16, v12
    v_and_b32 v245, 0xffff0000, v12
    v_pk_mul_f32 v[244:245], v[244:245], s[28:29]
    v_cvt_pk_bf16_f32 v12, v244, v245
    v_lshlrev_b32 v246, 16, v13
    v_and_b32 v247, 0xffff0000, v13
    v_pk_mul_f32 v[246:247], v[246:247], s[28:29]
    v_cvt_pk_bf16_f32 v13, v246, v247
    v_lshlrev_b32 v248, 16, v14
    v_and_b32 v249, 0xffff0000, v14
    v_pk_mul_f32 v[248:249], v[248:249], s[28:29]
    v_cvt_pk_bf16_f32 v14, v248, v249
    v_lshlrev_b32 v250, 16, v15
    v_and_b32 v251, 0xffff0000, v15
    v_pk_mul_f32 v[250:251], v[250:251], s[28:29]
    v_cvt_pk_bf16_f32 v15, v250, v251
    v_lshlrev_b32 v244, 16, v16
    v_and_b32 v245, 0xffff0000, v16
    v_pk_mul_f32 v[244:245], v[244:245], s[28:29]
    v_cvt_pk_bf16_f32 v16, v244, v245
    v_lshlrev_b32 v246, 16, v17
    v_and_b32 v247, 0xffff0000, v17
    v_pk_mul_f32 v[246:247], v[246:247], s[28:29]
    v_cvt_pk_bf16_f32 v17, v246, v247
    v_lshlrev_b32 v248, 16, v18
    v_and_b32 v249, 0xffff0000, v18
    v_pk_mul_f32 v[248:249], v[248:249], s[28:29]
    v_cvt_pk_bf16_f32 v18, v248, v249
    v_lshlrev_b32 v250, 16, v19
    v_and_b32 v251, 0xffff0000, v19
    v_pk_mul_f32 v[250:251], v[250:251], s[28:29]
    v_cvt_pk_bf16_f32 v19, v250, v251
    v_lshlrev_b32 v244, 16, v20
    v_and_b32 v245, 0xffff0000, v20
    v_pk_mul_f32 v[244:245], v[244:245], s[28:29]
    v_cvt_pk_bf16_f32 v20, v244, v245
    v_lshlrev_b32 v246, 16, v21
    v_and_b32 v247, 0xffff0000, v21
    v_pk_mul_f32 v[246:247], v[246:247], s[28:29]
    v_cvt_pk_bf16_f32 v21, v246, v247
    v_lshlrev_b32 v248, 16, v22
    v_and_b32 v249, 0xffff0000, v22
    v_pk_mul_f32 v[248:249], v[248:249], s[28:29]
    v_cvt_pk_bf16_f32 v22, v248, v249
    v_lshlrev_b32 v250, 16, v23
    v_and_b32 v251, 0xffff0000, v23
    v_pk_mul_f32 v[250:251], v[250:251], s[28:29]
    v_cvt_pk_bf16_f32 v23, v250, v251
    v_lshlrev_b32 v244, 16, v24
    v_and_b32 v245, 0xffff0000, v24
    v_pk_mul_f32 v[244:245], v[244:245], s[28:29]
    v_cvt_pk_bf16_f32 v24, v244, v245
    v_lshlrev_b32 v246, 16, v25
    v_and_b32 v247, 0xffff0000, v25
    v_pk_mul_f32 v[246:247], v[246:247], s[28:29]
    v_cvt_pk_bf16_f32 v25, v246, v247
    v_lshlrev_b32 v248, 16, v26
    v_and_b32 v249, 0xffff0000, v26
    v_pk_mul_f32 v[248:249], v[248:249], s[28:29]
    v_cvt_pk_bf16_f32 v26, v248, v249
    v_lshlrev_b32 v250, 16, v27
    v_and_b32 v251, 0xffff0000, v27
    v_pk_mul_f32 v[250:251], v[250:251], s[28:29]
    v_cvt_pk_bf16_f32 v27, v250, v251
    v_lshlrev_b32 v244, 16, v28
    v_and_b32 v245, 0xffff0000, v28
    v_pk_mul_f32 v[244:245], v[244:245], s[28:29]
    v_cvt_pk_bf16_f32 v28, v244, v245
    v_lshlrev_b32 v246, 16, v29
    v_and_b32 v247, 0xffff0000, v29
    v_pk_mul_f32 v[246:247], v[246:247], s[28:29]
    v_cvt_pk_bf16_f32 v29, v246, v247
    v_lshlrev_b32 v248, 16, v30
    v_and_b32 v249, 0xffff0000, v30
    v_pk_mul_f32 v[248:249], v[248:249], s[28:29]
    v_cvt_pk_bf16_f32 v30, v248, v249
    v_lshlrev_b32 v250, 16, v31
    v_and_b32 v251, 0xffff0000, v31
    v_pk_mul_f32 v[250:251], v[250:251], s[28:29]
    v_cvt_pk_bf16_f32 v31, v250, v251
    v_lshlrev_b32 v244, 16, v32
    v_and_b32 v245, 0xffff0000, v32
    v_pk_mul_f32 v[244:245], v[244:245], s[28:29]
    v_cvt_pk_bf16_f32 v32, v244, v245
    v_lshlrev_b32 v246, 16, v33
    v_and_b32 v247, 0xffff0000, v33
    v_pk_mul_f32 v[246:247], v[246:247], s[28:29]
    v_cvt_pk_bf16_f32 v33, v246, v247
    v_lshlrev_b32 v248, 16, v34
    v_and_b32 v249, 0xffff0000, v34
    v_pk_mul_f32 v[248:249], v[248:249], s[28:29]
    v_cvt_pk_bf16_f32 v34, v248, v249
    v_lshlrev_b32 v250, 16, v35
    v_and_b32 v251, 0xffff0000, v35
    v_pk_mul_f32 v[250:251], v[250:251], s[28:29]
    v_cvt_pk_bf16_f32 v35, v250, v251
    v_lshlrev_b32 v244, 16, v36
    v_and_b32 v245, 0xffff0000, v36
    v_pk_mul_f32 v[244:245], v[244:245], s[28:29]
    v_cvt_pk_bf16_f32 v36, v244, v245
    v_lshlrev_b32 v246, 16, v37
    v_and_b32 v247, 0xffff0000, v37
    v_pk_mul_f32 v[246:247], v[246:247], s[28:29]
    v_cvt_pk_bf16_f32 v37, v246, v247
    v_lshlrev_b32 v248, 16, v38
    v_and_b32 v249, 0xffff0000, v38
    v_pk_mul_f32 v[248:249], v[248:249], s[28:29]
    v_cvt_pk_bf16_f32 v38, v248, v249
    v_lshlrev_b32 v250, 16, v39
    v_and_b32 v251, 0xffff0000, v39
    v_pk_mul_f32 v[250:251], v[250:251], s[28:29]
    v_cvt_pk_bf16_f32 v39, v250, v251
    v_lshlrev_b32 v244, 16, v40
    v_and_b32 v245, 0xffff0000, v40
    v_pk_mul_f32 v[244:245], v[244:245], s[28:29]
    v_cvt_pk_bf16_f32 v40, v244, v245
    v_lshlrev_b32 v246, 16, v41
    v_and_b32 v247, 0xffff0000, v41
    v_pk_mul_f32 v[246:247], v[246:247], s[28:29]
    v_cvt_pk_bf16_f32 v41, v246, v247
    v_lshlrev_b32 v248, 16, v42
    v_and_b32 v249, 0xffff0000, v42
    v_pk_mul_f32 v[248:249], v[248:249], s[28:29]
    v_cvt_pk_bf16_f32 v42, v248, v249
    v_lshlrev_b32 v250, 16, v43
    v_and_b32 v251, 0xffff0000, v43
    v_pk_mul_f32 v[250:251], v[250:251], s[28:29]
    v_cvt_pk_bf16_f32 v43, v250, v251
    v_lshlrev_b32 v244, 16, v44
    v_and_b32 v245, 0xffff0000, v44
    v_pk_mul_f32 v[244:245], v[244:245], s[28:29]
    v_cvt_pk_bf16_f32 v44, v244, v245
    v_lshlrev_b32 v246, 16, v45
    v_and_b32 v247, 0xffff0000, v45
    v_pk_mul_f32 v[246:247], v[246:247], s[28:29]
    v_cvt_pk_bf16_f32 v45, v246, v247
    v_lshlrev_b32 v248, 16, v46
    v_and_b32 v249, 0xffff0000, v46
    v_pk_mul_f32 v[248:249], v[248:249], s[28:29]
    v_cvt_pk_bf16_f32 v46, v248, v249
    v_lshlrev_b32 v250, 16, v47
    v_and_b32 v251, 0xffff0000, v47
    v_pk_mul_f32 v[250:251], v[250:251], s[28:29]
    v_cvt_pk_bf16_f32 v47, v250, v251
    v_lshlrev_b32 v244, 16, v48
    v_and_b32 v245, 0xffff0000, v48
    v_pk_mul_f32 v[244:245], v[244:245], s[28:29]
    v_cvt_pk_bf16_f32 v48, v244, v245
    v_lshlrev_b32 v246, 16, v49
    v_and_b32 v247, 0xffff0000, v49
    v_pk_mul_f32 v[246:247], v[246:247], s[28:29]
    v_cvt_pk_bf16_f32 v49, v246, v247
    v_lshlrev_b32 v248, 16, v50
    v_and_b32 v249, 0xffff0000, v50
    v_pk_mul_f32 v[248:249], v[248:249], s[28:29]
    v_cvt_pk_bf16_f32 v50, v248, v249
    v_lshlrev_b32 v250, 16, v51
    v_and_b32 v251, 0xffff0000, v51
    v_pk_mul_f32 v[250:251], v[250:251], s[28:29]
    v_cvt_pk_bf16_f32 v51, v250, v251
    v_lshlrev_b32 v244, 16, v52
    v_and_b32 v245, 0xffff0000, v52
    v_pk_mul_f32 v[244:245], v[244:245], s[28:29]
    v_cvt_pk_bf16_f32 v52, v244, v245
    v_lshlrev_b32 v246, 16, v53
    v_and_b32 v247, 0xffff0000, v53
    v_pk_mul_f32 v[246:247], v[246:247], s[28:29]
    v_cvt_pk_bf16_f32 v53, v246, v247
    v_lshlrev_b32 v248, 16, v54
    v_and_b32 v249, 0xffff0000, v54
    v_pk_mul_f32 v[248:249], v[248:249], s[28:29]
    v_cvt_pk_bf16_f32 v54, v248, v249
    v_lshlrev_b32 v250, 16, v55
    v_and_b32 v251, 0xffff0000, v55
    v_pk_mul_f32 v[250:251], v[250:251], s[28:29]
    v_cvt_pk_bf16_f32 v55, v250, v251
    v_lshlrev_b32 v244, 16, v56
    v_and_b32 v245, 0xffff0000, v56
    v_pk_mul_f32 v[244:245], v[244:245], s[28:29]
    v_cvt_pk_bf16_f32 v56, v244, v245
    v_lshlrev_b32 v246, 16, v57
    v_and_b32 v247, 0xffff0000, v57
    v_pk_mul_f32 v[246:247], v[246:247], s[28:29]
    v_cvt_pk_bf16_f32 v57, v246, v247
    v_lshlrev_b32 v248, 16, v58
    v_and_b32 v249, 0xffff0000, v58
    v_pk_mul_f32 v[248:249], v[248:249], s[28:29]
    v_cvt_pk_bf16_f32 v58, v248, v249
    v_lshlrev_b32 v250, 16, v59
    v_and_b32 v251, 0xffff0000, v59
    v_pk_mul_f32 v[250:251], v[250:251], s[28:29]
    v_cvt_pk_bf16_f32 v59, v250, v251
    v_lshlrev_b32 v244, 16, v60
    v_and_b32 v245, 0xffff0000, v60
    v_pk_mul_f32 v[244:245], v[244:245], s[28:29]
    v_cvt_pk_bf16_f32 v60, v244, v245
    v_lshlrev_b32 v246, 16, v61
    v_and_b32 v247, 0xffff0000, v61
    v_pk_mul_f32 v[246:247], v[246:247], s[28:29]
    v_cvt_pk_bf16_f32 v61, v246, v247
    v_lshlrev_b32 v248, 16, v62
    v_and_b32 v249, 0xffff0000, v62
    v_pk_mul_f32 v[248:249], v[248:249], s[28:29]
    v_cvt_pk_bf16_f32 v62, v248, v249
    v_lshlrev_b32 v250, 16, v63
    v_and_b32 v251, 0xffff0000, v63
    v_pk_mul_f32 v[250:251], v[250:251], s[28:29]
    v_cvt_pk_bf16_f32 v63, v250, v251
    v_lshlrev_b32 v244, 16, v64
    v_and_b32 v245, 0xffff0000, v64
    v_pk_mul_f32 v[244:245], v[244:245], s[28:29]
    v_cvt_pk_bf16_f32 v64, v244, v245
    v_lshlrev_b32 v246, 16, v65
    v_and_b32 v247, 0xffff0000, v65
    v_pk_mul_f32 v[246:247], v[246:247], s[28:29]
    v_cvt_pk_bf16_f32 v65, v246, v247
    v_lshlrev_b32 v248, 16, v66
    v_and_b32 v249, 0xffff0000, v66
    v_pk_mul_f32 v[248:249], v[248:249], s[28:29]
    v_cvt_pk_bf16_f32 v66, v248, v249
    v_lshlrev_b32 v250, 16, v67
    v_and_b32 v251, 0xffff0000, v67
    v_pk_mul_f32 v[250:251], v[250:251], s[28:29]
    v_cvt_pk_bf16_f32 v67, v250, v251
    v_lshlrev_b32 v244, 16, v68
    v_and_b32 v245, 0xffff0000, v68
    v_pk_mul_f32 v[244:245], v[244:245], s[28:29]
    v_cvt_pk_bf16_f32 v68, v244, v245
    v_lshlrev_b32 v246, 16, v69
    v_and_b32 v247, 0xffff0000, v69
    v_pk_mul_f32 v[246:247], v[246:247], s[28:29]
    v_cvt_pk_bf16_f32 v69, v246, v247
    v_lshlrev_b32 v248, 16, v70
    v_and_b32 v249, 0xffff0000, v70
    v_pk_mul_f32 v[248:249], v[248:249], s[28:29]
    v_cvt_pk_bf16_f32 v70, v248, v249
    v_lshlrev_b32 v250, 16, v71
    v_and_b32 v251, 0xffff0000, v71
    v_pk_mul_f32 v[250:251], v[250:251], s[28:29]
    v_cvt_pk_bf16_f32 v71, v250, v251
    v_lshlrev_b32 v244, 16, v72
    v_and_b32 v245, 0xffff0000, v72
    v_pk_mul_f32 v[244:245], v[244:245], s[28:29]
    v_cvt_pk_bf16_f32 v72, v244, v245
    v_lshlrev_b32 v246, 16, v73
    v_and_b32 v247, 0xffff0000, v73
    v_pk_mul_f32 v[246:247], v[246:247], s[28:29]
    v_cvt_pk_bf16_f32 v73, v246, v247
    v_lshlrev_b32 v248, 16, v74
    v_and_b32 v249, 0xffff0000, v74
    v_pk_mul_f32 v[248:249], v[248:249], s[28:29]
    v_cvt_pk_bf16_f32 v74, v248, v249
    v_lshlrev_b32 v250, 16, v75
    v_and_b32 v251, 0xffff0000, v75
    v_pk_mul_f32 v[250:251], v[250:251], s[28:29]
    v_cvt_pk_bf16_f32 v75, v250, v251
    v_lshlrev_b32 v244, 16, v76
    v_and_b32 v245, 0xffff0000, v76
    v_pk_mul_f32 v[244:245], v[244:245], s[28:29]
    v_cvt_pk_bf16_f32 v76, v244, v245
    v_lshlrev_b32 v246, 16, v77
    v_and_b32 v247, 0xffff0000, v77
    v_pk_mul_f32 v[246:247], v[246:247], s[28:29]
    v_cvt_pk_bf16_f32 v77, v246, v247
    v_lshlrev_b32 v248, 16, v78
    v_and_b32 v249, 0xffff0000, v78
    v_pk_mul_f32 v[248:249], v[248:249], s[28:29]
    v_cvt_pk_bf16_f32 v78, v248, v249
    v_lshlrev_b32 v250, 16, v79
    v_and_b32 v251, 0xffff0000, v79
    v_pk_mul_f32 v[250:251], v[250:251], s[28:29]
    v_cvt_pk_bf16_f32 v79, v250, v251
    v_lshlrev_b32 v244, 16, v80
    v_and_b32 v245, 0xffff0000, v80
    v_pk_mul_f32 v[244:245], v[244:245], s[28:29]
    v_cvt_pk_bf16_f32 v80, v244, v245
    v_lshlrev_b32 v246, 16, v81
    v_and_b32 v247, 0xffff0000, v81
    v_pk_mul_f32 v[246:247], v[246:247], s[28:29]
    v_cvt_pk_bf16_f32 v81, v246, v247
    v_lshlrev_b32 v248, 16, v82
    v_and_b32 v249, 0xffff0000, v82
    v_pk_mul_f32 v[248:249], v[248:249], s[28:29]
    v_cvt_pk_bf16_f32 v82, v248, v249
    v_lshlrev_b32 v250, 16, v83
    v_and_b32 v251, 0xffff0000, v83
    v_pk_mul_f32 v[250:251], v[250:251], s[28:29]
    v_cvt_pk_bf16_f32 v83, v250, v251
    v_lshlrev_b32 v244, 16, v84
    v_and_b32 v245, 0xffff0000, v84
    v_pk_mul_f32 v[244:245], v[244:245], s[28:29]
    v_cvt_pk_bf16_f32 v84, v244, v245
    v_lshlrev_b32 v246, 16, v85
    v_and_b32 v247, 0xffff0000, v85
    v_pk_mul_f32 v[246:247], v[246:247], s[28:29]
    v_cvt_pk_bf16_f32 v85, v246, v247
    v_lshlrev_b32 v248, 16, v86
    v_and_b32 v249, 0xffff0000, v86
    v_pk_mul_f32 v[248:249], v[248:249], s[28:29]
    v_cvt_pk_bf16_f32 v86, v248, v249
    v_lshlrev_b32 v250, 16, v87
    v_and_b32 v251, 0xffff0000, v87
    v_pk_mul_f32 v[250:251], v[250:251], s[28:29]
    v_cvt_pk_bf16_f32 v87, v250, v251
    v_lshlrev_b32 v244, 16, v88
    v_and_b32 v245, 0xffff0000, v88
    v_pk_mul_f32 v[244:245], v[244:245], s[28:29]
    v_cvt_pk_bf16_f32 v88, v244, v245
    v_lshlrev_b32 v246, 16, v89
    v_and_b32 v247, 0xffff0000, v89
    v_pk_mul_f32 v[246:247], v[246:247], s[28:29]
    v_cvt_pk_bf16_f32 v89, v246, v247
    v_lshlrev_b32 v248, 16, v90
    v_and_b32 v249, 0xffff0000, v90
    v_pk_mul_f32 v[248:249], v[248:249], s[28:29]
    v_cvt_pk_bf16_f32 v90, v248, v249
    v_lshlrev_b32 v250, 16, v91
    v_and_b32 v251, 0xffff0000, v91
    v_pk_mul_f32 v[250:251], v[250:251], s[28:29]
    v_cvt_pk_bf16_f32 v91, v250, v251
    v_lshlrev_b32 v244, 16, v92
    v_and_b32 v245, 0xffff0000, v92
    v_pk_mul_f32 v[244:245], v[244:245], s[28:29]
    v_cvt_pk_bf16_f32 v92, v244, v245
    v_lshlrev_b32 v246, 16, v93
    v_and_b32 v247, 0xffff0000, v93
    v_pk_mul_f32 v[246:247], v[246:247], s[28:29]
    v_cvt_pk_bf16_f32 v93, v246, v247
    v_lshlrev_b32 v248, 16, v94
    v_and_b32 v249, 0xffff0000, v94
    v_pk_mul_f32 v[248:249], v[248:249], s[28:29]
    v_cvt_pk_bf16_f32 v94, v248, v249
    v_lshlrev_b32 v250, 16, v95
    v_and_b32 v251, 0xffff0000, v95
    v_pk_mul_f32 v[250:251], v[250:251], s[28:29]
    v_cvt_pk_bf16_f32 v95, v250, v251
    s_mov_b32 s33, 0
    s_mov_b32 s23, 16
L_slow_loop:
    s_add_u32 s21, s33, 0
    s_add_u32 m0, s24, 0
    s_nop 0
    buffer_load_dwordx4 v210, s[8:11], s21 offen offset:0 nt lds
    buffer_load_dwordx4 v211, s[8:11], s21 offen offset:1024 nt lds
    buffer_load_dwordx4 v212, s[8:11], s21 offen offset:2048 nt lds
    buffer_load_dwordx4 v213, s[8:11], s21 offen offset:3072 nt lds
    s_add_u32 s21, s33, 8192
    s_add_u32 m0, s24, 4096
    s_nop 0
    buffer_load_dwordx4 v210, s[8:11], s21 offen offset:0 nt lds
    buffer_load_dwordx4 v211, s[8:11], s21 offen offset:1024 nt lds
    buffer_load_dwordx4 v212, s[8:11], s21 offen offset:2048 nt lds
    buffer_load_dwordx4 v213, s[8:11], s21 offen offset:3072 nt lds
    s_add_u32 s21, s33, 128
    s_add_u32 m0, s24, 8192
    s_nop 0
    buffer_load_dwordx4 v210, s[8:11], s21 offen offset:0 nt lds
    buffer_load_dwordx4 v211, s[8:11], s21 offen offset:1024 nt lds
    buffer_load_dwordx4 v212, s[8:11], s21 offen offset:2048 nt lds
    buffer_load_dwordx4 v213, s[8:11], s21 offen offset:3072 nt lds
    s_add_u32 s21, s33, 8320
    s_add_u32 m0, s24, 12288
    s_nop 0
    buffer_load_dwordx4 v210, s[8:11], s21 offen offset:0 nt lds
    buffer_load_dwordx4 v211, s[8:11], s21 offen offset:1024 nt lds
    buffer_load_dwordx4 v212, s[8:11], s21 offen offset:2048 nt lds
    buffer_load_dwordx4 v213, s[8:11], s21 offen offset:3072 nt lds
    s_waitcnt vmcnt(0)
    ds_read_b128 a[192:195], v186 offset:0
    ds_read_b128 a[196:199], v187 offset:0
    ds_read_b128 a[200:203], v186 offset:8192
    ds_read_b128 a[204:207], v187 offset:8192
    s_waitcnt lgkmcnt(0)
    ds_read_b128 a[208:211], v188 offset:0
    ds_read_b128 a[212:215], v189 offset:0
    ds_read_b128 a[216:219], v188 offset:8192
    ds_read_b128 a[220:223], v189 offset:8192
    s_waitcnt lgkmcnt(0)
    ds_read_b128 a[224:227], v190 offset:0
    ds_read_b128 a[228:231], v191 offset:0
    ds_read_b128 a[232:235], v190 offset:8192
    ds_read_b128 a[236:239], v191 offset:8192
    s_waitcnt lgkmcnt(0)
    ds_read_b128 a[240:243], v192 offset:0
    ds_read_b128 a[244:247], v193 offset:0
    ds_read_b128 a[248:251], v192 offset:8192
    ds_read_b128 a[252:255], v193 offset:8192
    s_waitcnt lgkmcnt(0)
    s_add_u32 s21, s33, 0
    s_add_u32 m0, s24, 0
    s_nop 0
    buffer_load_dwordx4 v214, s[12:15], s21 offen offset:0 nt lds
    buffer_load_dwordx4 v215, s[12:15], s21 offen offset:1024 nt lds
    buffer_load_dwordx4 v214, s[12:15], s21 offen offset:2048 nt lds
    buffer_load_dwordx4 v215, s[12:15], s21 offen offset:3072 nt lds
    s_add_u32 s21, s33, 4096
    s_add_u32 m0, s24, 4096
    s_nop 0
    buffer_load_dwordx4 v214, s[12:15], s21 offen offset:0 nt lds
    buffer_load_dwordx4 v215, s[12:15], s21 offen offset:1024 nt lds
    buffer_load_dwordx4 v214, s[12:15], s21 offen offset:2048 nt lds
    buffer_load_dwordx4 v215, s[12:15], s21 offen offset:3072 nt lds
    s_add_u32 s21, s33, 8192
    s_add_u32 m0, s24, 8192
    s_nop 0
    buffer_load_dwordx4 v214, s[12:15], s21 offen offset:0 nt lds
    buffer_load_dwordx4 v215, s[12:15], s21 offen offset:1024 nt lds
    buffer_load_dwordx4 v214, s[12:15], s21 offen offset:2048 nt lds
    buffer_load_dwordx4 v215, s[12:15], s21 offen offset:3072 nt lds
    s_add_u32 s21, s33, 12288
    s_add_u32 m0, s24, 12288
    s_nop 0
    buffer_load_dwordx4 v214, s[12:15], s21 offen offset:0 nt lds
    buffer_load_dwordx4 v215, s[12:15], s21 offen offset:1024 nt lds
    buffer_load_dwordx4 v214, s[12:15], s21 offen offset:2048 nt lds
    buffer_load_dwordx4 v215, s[12:15], s21 offen offset:3072 nt lds
    s_waitcnt vmcnt(0)
    v_mfma_f32_16x16x32_bf16 v[96:99], a[192:195], v[0:3], 0
    v_mfma_f32_16x16x32_bf16 v[96:99], a[196:199], v[4:7], v[96:99]
    v_mfma_f32_16x16x32_bf16 v[96:99], a[200:203], v[8:11], v[96:99]
    v_mfma_f32_16x16x32_bf16 v[96:99], a[204:207], v[12:15], v[96:99]
    v_mfma_f32_16x16x32_bf16 v[100:103], a[208:211], v[0:3], 0
    v_mfma_f32_16x16x32_bf16 v[100:103], a[212:215], v[4:7], v[100:103]
    v_mfma_f32_16x16x32_bf16 v[100:103], a[216:219], v[8:11], v[100:103]
    v_mfma_f32_16x16x32_bf16 v[100:103], a[220:223], v[12:15], v[100:103]
    v_mfma_f32_16x16x32_bf16 v[104:107], a[224:227], v[0:3], 0
    v_mfma_f32_16x16x32_bf16 v[104:107], a[228:231], v[4:7], v[104:107]
    v_mfma_f32_16x16x32_bf16 v[104:107], a[232:235], v[8:11], v[104:107]
    v_mfma_f32_16x16x32_bf16 v[104:107], a[236:239], v[12:15], v[104:107]
    v_mfma_f32_16x16x32_bf16 v[108:111], a[240:243], v[0:3], 0
    v_mfma_f32_16x16x32_bf16 v[108:111], a[244:247], v[4:7], v[108:111]
    v_mfma_f32_16x16x32_bf16 v[108:111], a[248:251], v[8:11], v[108:111]
    v_mfma_f32_16x16x32_bf16 v[108:111], a[252:255], v[12:15], v[108:111]
    s_nop 9
    v_max3_f32 v160, v96, v97, v98
    v_max3_f32 v160, v160, v99, v100
    v_max3_f32 v160, v160, v101, v102
    v_max3_f32 v160, v160, v103, v104
    v_max3_f32 v160, v160, v105, v106
    v_max3_f32 v160, v160, v107, v108
    v_max3_f32 v160, v160, v109, v110
    v_max_f32 v160, v160, v111
    v_mov_b32 v162, v160
    s_nop 1
    v_permlane32_swap_b32 v160, v162
    s_nop 1
    v_max_f32 v160, v160, v162
    v_mov_b32 v162, v160
    s_nop 1
    v_permlane16_swap_b32 v160, v162
    s_nop 1
    v_max_f32 v160, v160, v162
    v_max_f32 v160, v160, v164
    v_sub_f32 v161, v164, v160
    v_exp_f32 v161, v161
    v_mov_b32 v164, v160
    v_sub_f32 v96, v96, v160
    v_sub_f32 v97, v97, v160
    v_sub_f32 v98, v98, v160
    v_sub_f32 v99, v99, v160
    v_sub_f32 v100, v100, v160
    v_sub_f32 v101, v101, v160
    v_sub_f32 v102, v102, v160
    v_sub_f32 v103, v103, v160
    v_sub_f32 v104, v104, v160
    v_sub_f32 v105, v105, v160
    v_sub_f32 v106, v106, v160
    v_sub_f32 v107, v107, v160
    v_sub_f32 v108, v108, v160
    v_sub_f32 v109, v109, v160
    v_sub_f32 v110, v110, v160
    v_sub_f32 v111, v111, v160
    v_exp_f32 v96, v96
    v_exp_f32 v97, v97
    v_exp_f32 v98, v98
    v_exp_f32 v99, v99
    v_exp_f32 v100, v100
    v_exp_f32 v101, v101
    v_exp_f32 v102, v102
    v_exp_f32 v103, v103
    v_exp_f32 v104, v104
    v_exp_f32 v105, v105
    v_exp_f32 v106, v106
    v_exp_f32 v107, v107
    v_exp_f32 v108, v108
    v_exp_f32 v109, v109
    v_exp_f32 v110, v110
    v_exp_f32 v111, v111
    v_mul_f32 v180, v180, v161
    v_add_f32 v180, v180, v96
    v_add_f32 v180, v180, v97
    v_add_f32 v180, v180, v98
    v_add_f32 v180, v180, v99
    v_add_f32 v180, v180, v100
    v_add_f32 v180, v180, v101
    v_add_f32 v180, v180, v102
    v_add_f32 v180, v180, v103
    v_add_f32 v180, v180, v104
    v_add_f32 v180, v180, v105
    v_add_f32 v180, v180, v106
    v_add_f32 v180, v180, v107
    v_add_f32 v180, v180, v108
    v_add_f32 v180, v180, v109
    v_add_f32 v180, v180, v110
    v_add_f32 v180, v180, v111
    v_cvt_pk_bf16_f32 v112, v96, v97
    v_cvt_pk_bf16_f32 v113, v98, v99
    v_cvt_pk_bf16_f32 v114, v100, v101
    v_cvt_pk_bf16_f32 v115, v102, v103
    v_cvt_pk_bf16_f32 v116, v104, v105
    v_cvt_pk_bf16_f32 v117, v106, v107
    v_cvt_pk_bf16_f32 v118, v108, v109
    v_cvt_pk_bf16_f32 v119, v110, v111
    v_accvgpr_read_b32 v244, a0
    v_mul_f32 v244, v244, v161
    v_accvgpr_write_b32 a0, v244
    v_accvgpr_read_b32 v245, a1
    v_mul_f32 v245, v245, v161
    v_accvgpr_write_b32 a1, v245
    v_accvgpr_read_b32 v246, a2
    v_mul_f32 v246, v246, v161
    v_accvgpr_write_b32 a2, v246
    v_accvgpr_read_b32 v247, a3
    v_mul_f32 v247, v247, v161
    v_accvgpr_write_b32 a3, v247
    v_accvgpr_read_b32 v248, a4
    v_mul_f32 v248, v248, v161
    v_accvgpr_write_b32 a4, v248
    v_accvgpr_read_b32 v249, a5
    v_mul_f32 v249, v249, v161
    v_accvgpr_write_b32 a5, v249
    v_accvgpr_read_b32 v250, a6
    v_mul_f32 v250, v250, v161
    v_accvgpr_write_b32 a6, v250
    v_accvgpr_read_b32 v251, a7
    v_mul_f32 v251, v251, v161
    v_accvgpr_write_b32 a7, v251
    v_accvgpr_read_b32 v244, a8
    v_mul_f32 v244, v244, v161
    v_accvgpr_write_b32 a8, v244
    v_accvgpr_read_b32 v245, a9
    v_mul_f32 v245, v245, v161
    v_accvgpr_write_b32 a9, v245
    v_accvgpr_read_b32 v246, a10
    v_mul_f32 v246, v246, v161
    v_accvgpr_write_b32 a10, v246
    v_accvgpr_read_b32 v247, a11
    v_mul_f32 v247, v247, v161
    v_accvgpr_write_b32 a11, v247
    v_accvgpr_read_b32 v248, a12
    v_mul_f32 v248, v248, v161
    v_accvgpr_write_b32 a12, v248
    v_accvgpr_read_b32 v249, a13
    v_mul_f32 v249, v249, v161
    v_accvgpr_write_b32 a13, v249
    v_accvgpr_read_b32 v250, a14
    v_mul_f32 v250, v250, v161
    v_accvgpr_write_b32 a14, v250
    v_accvgpr_read_b32 v251, a15
    v_mul_f32 v251, v251, v161
    v_accvgpr_write_b32 a15, v251
    v_accvgpr_read_b32 v244, a16
    v_mul_f32 v244, v244, v161
    v_accvgpr_write_b32 a16, v244
    v_accvgpr_read_b32 v245, a17
    v_mul_f32 v245, v245, v161
    v_accvgpr_write_b32 a17, v245
    v_accvgpr_read_b32 v246, a18
    v_mul_f32 v246, v246, v161
    v_accvgpr_write_b32 a18, v246
    v_accvgpr_read_b32 v247, a19
    v_mul_f32 v247, v247, v161
    v_accvgpr_write_b32 a19, v247
    v_accvgpr_read_b32 v248, a20
    v_mul_f32 v248, v248, v161
    v_accvgpr_write_b32 a20, v248
    v_accvgpr_read_b32 v249, a21
    v_mul_f32 v249, v249, v161
    v_accvgpr_write_b32 a21, v249
    v_accvgpr_read_b32 v250, a22
    v_mul_f32 v250, v250, v161
    v_accvgpr_write_b32 a22, v250
    v_accvgpr_read_b32 v251, a23
    v_mul_f32 v251, v251, v161
    v_accvgpr_write_b32 a23, v251
    v_accvgpr_read_b32 v244, a24
    v_mul_f32 v244, v244, v161
    v_accvgpr_write_b32 a24, v244
    v_accvgpr_read_b32 v245, a25
    v_mul_f32 v245, v245, v161
    v_accvgpr_write_b32 a25, v245
    v_accvgpr_read_b32 v246, a26
    v_mul_f32 v246, v246, v161
    v_accvgpr_write_b32 a26, v246
    v_accvgpr_read_b32 v247, a27
    v_mul_f32 v247, v247, v161
    v_accvgpr_write_b32 a27, v247
    v_accvgpr_read_b32 v248, a28
    v_mul_f32 v248, v248, v161
    v_accvgpr_write_b32 a28, v248
    v_accvgpr_read_b32 v249, a29
    v_mul_f32 v249, v249, v161
    v_accvgpr_write_b32 a29, v249
    v_accvgpr_read_b32 v250, a30
    v_mul_f32 v250, v250, v161
    v_accvgpr_write_b32 a30, v250
    v_accvgpr_read_b32 v251, a31
    v_mul_f32 v251, v251, v161
    v_accvgpr_write_b32 a31, v251
    v_mfma_f32_16x16x32_bf16 v[96:99], a[192:195], v[16:19], 0
    v_mfma_f32_16x16x32_bf16 v[96:99], a[196:199], v[20:23], v[96:99]
    v_mfma_f32_16x16x32_bf16 v[96:99], a[200:203], v[24:27], v[96:99]
    v_mfma_f32_16x16x32_bf16 v[96:99], a[204:207], v[28:31], v[96:99]
    v_mfma_f32_16x16x32_bf16 v[100:103], a[208:211], v[16:19], 0
    v_mfma_f32_16x16x32_bf16 v[100:103], a[212:215], v[20:23], v[100:103]
    v_mfma_f32_16x16x32_bf16 v[100:103], a[216:219], v[24:27], v[100:103]
    v_mfma_f32_16x16x32_bf16 v[100:103], a[220:223], v[28:31], v[100:103]
    v_mfma_f32_16x16x32_bf16 v[104:107], a[224:227], v[16:19], 0
    v_mfma_f32_16x16x32_bf16 v[104:107], a[228:231], v[20:23], v[104:107]
    v_mfma_f32_16x16x32_bf16 v[104:107], a[232:235], v[24:27], v[104:107]
    v_mfma_f32_16x16x32_bf16 v[104:107], a[236:239], v[28:31], v[104:107]
    v_mfma_f32_16x16x32_bf16 v[108:111], a[240:243], v[16:19], 0
    v_mfma_f32_16x16x32_bf16 v[108:111], a[244:247], v[20:23], v[108:111]
    v_mfma_f32_16x16x32_bf16 v[108:111], a[248:251], v[24:27], v[108:111]
    v_mfma_f32_16x16x32_bf16 v[108:111], a[252:255], v[28:31], v[108:111]
    s_nop 9
    v_max3_f32 v160, v96, v97, v98
    v_max3_f32 v160, v160, v99, v100
    v_max3_f32 v160, v160, v101, v102
    v_max3_f32 v160, v160, v103, v104
    v_max3_f32 v160, v160, v105, v106
    v_max3_f32 v160, v160, v107, v108
    v_max3_f32 v160, v160, v109, v110
    v_max_f32 v160, v160, v111
    v_mov_b32 v162, v160
    s_nop 1
    v_permlane32_swap_b32 v160, v162
    s_nop 1
    v_max_f32 v160, v160, v162
    v_mov_b32 v162, v160
    s_nop 1
    v_permlane16_swap_b32 v160, v162
    s_nop 1
    v_max_f32 v160, v160, v162
    v_max_f32 v160, v160, v165
    v_sub_f32 v161, v165, v160
    v_exp_f32 v161, v161
    v_mov_b32 v165, v160
    v_sub_f32 v96, v96, v160
    v_sub_f32 v97, v97, v160
    v_sub_f32 v98, v98, v160
    v_sub_f32 v99, v99, v160
    v_sub_f32 v100, v100, v160
    v_sub_f32 v101, v101, v160
    v_sub_f32 v102, v102, v160
    v_sub_f32 v103, v103, v160
    v_sub_f32 v104, v104, v160
    v_sub_f32 v105, v105, v160
    v_sub_f32 v106, v106, v160
    v_sub_f32 v107, v107, v160
    v_sub_f32 v108, v108, v160
    v_sub_f32 v109, v109, v160
    v_sub_f32 v110, v110, v160
    v_sub_f32 v111, v111, v160
    v_exp_f32 v96, v96
    v_exp_f32 v97, v97
    v_exp_f32 v98, v98
    v_exp_f32 v99, v99
    v_exp_f32 v100, v100
    v_exp_f32 v101, v101
    v_exp_f32 v102, v102
    v_exp_f32 v103, v103
    v_exp_f32 v104, v104
    v_exp_f32 v105, v105
    v_exp_f32 v106, v106
    v_exp_f32 v107, v107
    v_exp_f32 v108, v108
    v_exp_f32 v109, v109
    v_exp_f32 v110, v110
    v_exp_f32 v111, v111
    v_mul_f32 v181, v181, v161
    v_add_f32 v181, v181, v96
    v_add_f32 v181, v181, v97
    v_add_f32 v181, v181, v98
    v_add_f32 v181, v181, v99
    v_add_f32 v181, v181, v100
    v_add_f32 v181, v181, v101
    v_add_f32 v181, v181, v102
    v_add_f32 v181, v181, v103
    v_add_f32 v181, v181, v104
    v_add_f32 v181, v181, v105
    v_add_f32 v181, v181, v106
    v_add_f32 v181, v181, v107
    v_add_f32 v181, v181, v108
    v_add_f32 v181, v181, v109
    v_add_f32 v181, v181, v110
    v_add_f32 v181, v181, v111
    v_cvt_pk_bf16_f32 v120, v96, v97
    v_cvt_pk_bf16_f32 v121, v98, v99
    v_cvt_pk_bf16_f32 v122, v100, v101
    v_cvt_pk_bf16_f32 v123, v102, v103
    v_cvt_pk_bf16_f32 v124, v104, v105
    v_cvt_pk_bf16_f32 v125, v106, v107
    v_cvt_pk_bf16_f32 v126, v108, v109
    v_cvt_pk_bf16_f32 v127, v110, v111
    v_accvgpr_read_b32 v244, a32
    v_mul_f32 v244, v244, v161
    v_accvgpr_write_b32 a32, v244
    v_accvgpr_read_b32 v245, a33
    v_mul_f32 v245, v245, v161
    v_accvgpr_write_b32 a33, v245
    v_accvgpr_read_b32 v246, a34
    v_mul_f32 v246, v246, v161
    v_accvgpr_write_b32 a34, v246
    v_accvgpr_read_b32 v247, a35
    v_mul_f32 v247, v247, v161
    v_accvgpr_write_b32 a35, v247
    v_accvgpr_read_b32 v248, a36
    v_mul_f32 v248, v248, v161
    v_accvgpr_write_b32 a36, v248
    v_accvgpr_read_b32 v249, a37
    v_mul_f32 v249, v249, v161
    v_accvgpr_write_b32 a37, v249
    v_accvgpr_read_b32 v250, a38
    v_mul_f32 v250, v250, v161
    v_accvgpr_write_b32 a38, v250
    v_accvgpr_read_b32 v251, a39
    v_mul_f32 v251, v251, v161
    v_accvgpr_write_b32 a39, v251
    v_accvgpr_read_b32 v244, a40
    v_mul_f32 v244, v244, v161
    v_accvgpr_write_b32 a40, v244
    v_accvgpr_read_b32 v245, a41
    v_mul_f32 v245, v245, v161
    v_accvgpr_write_b32 a41, v245
    v_accvgpr_read_b32 v246, a42
    v_mul_f32 v246, v246, v161
    v_accvgpr_write_b32 a42, v246
    v_accvgpr_read_b32 v247, a43
    v_mul_f32 v247, v247, v161
    v_accvgpr_write_b32 a43, v247
    v_accvgpr_read_b32 v248, a44
    v_mul_f32 v248, v248, v161
    v_accvgpr_write_b32 a44, v248
    v_accvgpr_read_b32 v249, a45
    v_mul_f32 v249, v249, v161
    v_accvgpr_write_b32 a45, v249
    v_accvgpr_read_b32 v250, a46
    v_mul_f32 v250, v250, v161
    v_accvgpr_write_b32 a46, v250
    v_accvgpr_read_b32 v251, a47
    v_mul_f32 v251, v251, v161
    v_accvgpr_write_b32 a47, v251
    v_accvgpr_read_b32 v244, a48
    v_mul_f32 v244, v244, v161
    v_accvgpr_write_b32 a48, v244
    v_accvgpr_read_b32 v245, a49
    v_mul_f32 v245, v245, v161
    v_accvgpr_write_b32 a49, v245
    v_accvgpr_read_b32 v246, a50
    v_mul_f32 v246, v246, v161
    v_accvgpr_write_b32 a50, v246
    v_accvgpr_read_b32 v247, a51
    v_mul_f32 v247, v247, v161
    v_accvgpr_write_b32 a51, v247
    v_accvgpr_read_b32 v248, a52
    v_mul_f32 v248, v248, v161
    v_accvgpr_write_b32 a52, v248
    v_accvgpr_read_b32 v249, a53
    v_mul_f32 v249, v249, v161
    v_accvgpr_write_b32 a53, v249
    v_accvgpr_read_b32 v250, a54
    v_mul_f32 v250, v250, v161
    v_accvgpr_write_b32 a54, v250
    v_accvgpr_read_b32 v251, a55
    v_mul_f32 v251, v251, v161
    v_accvgpr_write_b32 a55, v251
    v_accvgpr_read_b32 v244, a56
    v_mul_f32 v244, v244, v161
    v_accvgpr_write_b32 a56, v244
    v_accvgpr_read_b32 v245, a57
    v_mul_f32 v245, v245, v161
    v_accvgpr_write_b32 a57, v245
    v_accvgpr_read_b32 v246, a58
    v_mul_f32 v246, v246, v161
    v_accvgpr_write_b32 a58, v246
    v_accvgpr_read_b32 v247, a59
    v_mul_f32 v247, v247, v161
    v_accvgpr_write_b32 a59, v247
    v_accvgpr_read_b32 v248, a60
    v_mul_f32 v248, v248, v161
    v_accvgpr_write_b32 a60, v248
    v_accvgpr_read_b32 v249, a61
    v_mul_f32 v249, v249, v161
    v_accvgpr_write_b32 a61, v249
    v_accvgpr_read_b32 v250, a62
    v_mul_f32 v250, v250, v161
    v_accvgpr_write_b32 a62, v250
    v_accvgpr_read_b32 v251, a63
    v_mul_f32 v251, v251, v161
    v_accvgpr_write_b32 a63, v251
    v_mfma_f32_16x16x32_bf16 v[96:99], a[192:195], v[32:35], 0
    v_mfma_f32_16x16x32_bf16 v[96:99], a[196:199], v[36:39], v[96:99]
    v_mfma_f32_16x16x32_bf16 v[96:99], a[200:203], v[40:43], v[96:99]
    v_mfma_f32_16x16x32_bf16 v[96:99], a[204:207], v[44:47], v[96:99]
    v_mfma_f32_16x16x32_bf16 v[100:103], a[208:211], v[32:35], 0
    v_mfma_f32_16x16x32_bf16 v[100:103], a[212:215], v[36:39], v[100:103]
    v_mfma_f32_16x16x32_bf16 v[100:103], a[216:219], v[40:43], v[100:103]
    v_mfma_f32_16x16x32_bf16 v[100:103], a[220:223], v[44:47], v[100:103]
    v_mfma_f32_16x16x32_bf16 v[104:107], a[224:227], v[32:35], 0
    v_mfma_f32_16x16x32_bf16 v[104:107], a[228:231], v[36:39], v[104:107]
    v_mfma_f32_16x16x32_bf16 v[104:107], a[232:235], v[40:43], v[104:107]
    v_mfma_f32_16x16x32_bf16 v[104:107], a[236:239], v[44:47], v[104:107]
    v_mfma_f32_16x16x32_bf16 v[108:111], a[240:243], v[32:35], 0
    v_mfma_f32_16x16x32_bf16 v[108:111], a[244:247], v[36:39], v[108:111]
    v_mfma_f32_16x16x32_bf16 v[108:111], a[248:251], v[40:43], v[108:111]
    v_mfma_f32_16x16x32_bf16 v[108:111], a[252:255], v[44:47], v[108:111]
    s_nop 9
    v_max3_f32 v160, v96, v97, v98
    v_max3_f32 v160, v160, v99, v100
    v_max3_f32 v160, v160, v101, v102
    v_max3_f32 v160, v160, v103, v104
    v_max3_f32 v160, v160, v105, v106
    v_max3_f32 v160, v160, v107, v108
    v_max3_f32 v160, v160, v109, v110
    v_max_f32 v160, v160, v111
    v_mov_b32 v162, v160
    s_nop 1
    v_permlane32_swap_b32 v160, v162
    s_nop 1
    v_max_f32 v160, v160, v162
    v_mov_b32 v162, v160
    s_nop 1
    v_permlane16_swap_b32 v160, v162
    s_nop 1
    v_max_f32 v160, v160, v162
    v_max_f32 v160, v160, v166
    v_sub_f32 v161, v166, v160
    v_exp_f32 v161, v161
    v_mov_b32 v166, v160
    v_sub_f32 v96, v96, v160
    v_sub_f32 v97, v97, v160
    v_sub_f32 v98, v98, v160
    v_sub_f32 v99, v99, v160
    v_sub_f32 v100, v100, v160
    v_sub_f32 v101, v101, v160
    v_sub_f32 v102, v102, v160
    v_sub_f32 v103, v103, v160
    v_sub_f32 v104, v104, v160
    v_sub_f32 v105, v105, v160
    v_sub_f32 v106, v106, v160
    v_sub_f32 v107, v107, v160
    v_sub_f32 v108, v108, v160
    v_sub_f32 v109, v109, v160
    v_sub_f32 v110, v110, v160
    v_sub_f32 v111, v111, v160
    v_exp_f32 v96, v96
    v_exp_f32 v97, v97
    v_exp_f32 v98, v98
    v_exp_f32 v99, v99
    v_exp_f32 v100, v100
    v_exp_f32 v101, v101
    v_exp_f32 v102, v102
    v_exp_f32 v103, v103
    v_exp_f32 v104, v104
    v_exp_f32 v105, v105
    v_exp_f32 v106, v106
    v_exp_f32 v107, v107
    v_exp_f32 v108, v108
    v_exp_f32 v109, v109
    v_exp_f32 v110, v110
    v_exp_f32 v111, v111
    v_mul_f32 v182, v182, v161
    v_add_f32 v182, v182, v96
    v_add_f32 v182, v182, v97
    v_add_f32 v182, v182, v98
    v_add_f32 v182, v182, v99
    v_add_f32 v182, v182, v100
    v_add_f32 v182, v182, v101
    v_add_f32 v182, v182, v102
    v_add_f32 v182, v182, v103
    v_add_f32 v182, v182, v104
    v_add_f32 v182, v182, v105
    v_add_f32 v182, v182, v106
    v_add_f32 v182, v182, v107
    v_add_f32 v182, v182, v108
    v_add_f32 v182, v182, v109
    v_add_f32 v182, v182, v110
    v_add_f32 v182, v182, v111
    v_cvt_pk_bf16_f32 v128, v96, v97
    v_cvt_pk_bf16_f32 v129, v98, v99
    v_cvt_pk_bf16_f32 v130, v100, v101
    v_cvt_pk_bf16_f32 v131, v102, v103
    v_cvt_pk_bf16_f32 v132, v104, v105
    v_cvt_pk_bf16_f32 v133, v106, v107
    v_cvt_pk_bf16_f32 v134, v108, v109
    v_cvt_pk_bf16_f32 v135, v110, v111
    v_accvgpr_read_b32 v244, a64
    v_mul_f32 v244, v244, v161
    v_accvgpr_write_b32 a64, v244
    v_accvgpr_read_b32 v245, a65
    v_mul_f32 v245, v245, v161
    v_accvgpr_write_b32 a65, v245
    v_accvgpr_read_b32 v246, a66
    v_mul_f32 v246, v246, v161
    v_accvgpr_write_b32 a66, v246
    v_accvgpr_read_b32 v247, a67
    v_mul_f32 v247, v247, v161
    v_accvgpr_write_b32 a67, v247
    v_accvgpr_read_b32 v248, a68
    v_mul_f32 v248, v248, v161
    v_accvgpr_write_b32 a68, v248
    v_accvgpr_read_b32 v249, a69
    v_mul_f32 v249, v249, v161
    v_accvgpr_write_b32 a69, v249
    v_accvgpr_read_b32 v250, a70
    v_mul_f32 v250, v250, v161
    v_accvgpr_write_b32 a70, v250
    v_accvgpr_read_b32 v251, a71
    v_mul_f32 v251, v251, v161
    v_accvgpr_write_b32 a71, v251
    v_accvgpr_read_b32 v244, a72
    v_mul_f32 v244, v244, v161
    v_accvgpr_write_b32 a72, v244
    v_accvgpr_read_b32 v245, a73
    v_mul_f32 v245, v245, v161
    v_accvgpr_write_b32 a73, v245
    v_accvgpr_read_b32 v246, a74
    v_mul_f32 v246, v246, v161
    v_accvgpr_write_b32 a74, v246
    v_accvgpr_read_b32 v247, a75
    v_mul_f32 v247, v247, v161
    v_accvgpr_write_b32 a75, v247
    v_accvgpr_read_b32 v248, a76
    v_mul_f32 v248, v248, v161
    v_accvgpr_write_b32 a76, v248
    v_accvgpr_read_b32 v249, a77
    v_mul_f32 v249, v249, v161
    v_accvgpr_write_b32 a77, v249
    v_accvgpr_read_b32 v250, a78
    v_mul_f32 v250, v250, v161
    v_accvgpr_write_b32 a78, v250
    v_accvgpr_read_b32 v251, a79
    v_mul_f32 v251, v251, v161
    v_accvgpr_write_b32 a79, v251
    v_accvgpr_read_b32 v244, a80
    v_mul_f32 v244, v244, v161
    v_accvgpr_write_b32 a80, v244
    v_accvgpr_read_b32 v245, a81
    v_mul_f32 v245, v245, v161
    v_accvgpr_write_b32 a81, v245
    v_accvgpr_read_b32 v246, a82
    v_mul_f32 v246, v246, v161
    v_accvgpr_write_b32 a82, v246
    v_accvgpr_read_b32 v247, a83
    v_mul_f32 v247, v247, v161
    v_accvgpr_write_b32 a83, v247
    v_accvgpr_read_b32 v248, a84
    v_mul_f32 v248, v248, v161
    v_accvgpr_write_b32 a84, v248
    v_accvgpr_read_b32 v249, a85
    v_mul_f32 v249, v249, v161
    v_accvgpr_write_b32 a85, v249
    v_accvgpr_read_b32 v250, a86
    v_mul_f32 v250, v250, v161
    v_accvgpr_write_b32 a86, v250
    v_accvgpr_read_b32 v251, a87
    v_mul_f32 v251, v251, v161
    v_accvgpr_write_b32 a87, v251
    v_accvgpr_read_b32 v244, a88
    v_mul_f32 v244, v244, v161
    v_accvgpr_write_b32 a88, v244
    v_accvgpr_read_b32 v245, a89
    v_mul_f32 v245, v245, v161
    v_accvgpr_write_b32 a89, v245
    v_accvgpr_read_b32 v246, a90
    v_mul_f32 v246, v246, v161
    v_accvgpr_write_b32 a90, v246
    v_accvgpr_read_b32 v247, a91
    v_mul_f32 v247, v247, v161
    v_accvgpr_write_b32 a91, v247
    v_accvgpr_read_b32 v248, a92
    v_mul_f32 v248, v248, v161
    v_accvgpr_write_b32 a92, v248
    v_accvgpr_read_b32 v249, a93
    v_mul_f32 v249, v249, v161
    v_accvgpr_write_b32 a93, v249
    v_accvgpr_read_b32 v250, a94
    v_mul_f32 v250, v250, v161
    v_accvgpr_write_b32 a94, v250
    v_accvgpr_read_b32 v251, a95
    v_mul_f32 v251, v251, v161
    v_accvgpr_write_b32 a95, v251
    v_mfma_f32_16x16x32_bf16 v[96:99], a[192:195], v[48:51], 0
    v_mfma_f32_16x16x32_bf16 v[96:99], a[196:199], v[52:55], v[96:99]
    v_mfma_f32_16x16x32_bf16 v[96:99], a[200:203], v[56:59], v[96:99]
    v_mfma_f32_16x16x32_bf16 v[96:99], a[204:207], v[60:63], v[96:99]
    v_mfma_f32_16x16x32_bf16 v[100:103], a[208:211], v[48:51], 0
    v_mfma_f32_16x16x32_bf16 v[100:103], a[212:215], v[52:55], v[100:103]
    v_mfma_f32_16x16x32_bf16 v[100:103], a[216:219], v[56:59], v[100:103]
    v_mfma_f32_16x16x32_bf16 v[100:103], a[220:223], v[60:63], v[100:103]
    v_mfma_f32_16x16x32_bf16 v[104:107], a[224:227], v[48:51], 0
    v_mfma_f32_16x16x32_bf16 v[104:107], a[228:231], v[52:55], v[104:107]
    v_mfma_f32_16x16x32_bf16 v[104:107], a[232:235], v[56:59], v[104:107]
    v_mfma_f32_16x16x32_bf16 v[104:107], a[236:239], v[60:63], v[104:107]
    v_mfma_f32_16x16x32_bf16 v[108:111], a[240:243], v[48:51], 0
    v_mfma_f32_16x16x32_bf16 v[108:111], a[244:247], v[52:55], v[108:111]
    v_mfma_f32_16x16x32_bf16 v[108:111], a[248:251], v[56:59], v[108:111]
    v_mfma_f32_16x16x32_bf16 v[108:111], a[252:255], v[60:63], v[108:111]
    s_nop 9
    v_max3_f32 v160, v96, v97, v98
    v_max3_f32 v160, v160, v99, v100
    v_max3_f32 v160, v160, v101, v102
    v_max3_f32 v160, v160, v103, v104
    v_max3_f32 v160, v160, v105, v106
    v_max3_f32 v160, v160, v107, v108
    v_max3_f32 v160, v160, v109, v110
    v_max_f32 v160, v160, v111
    v_mov_b32 v162, v160
    s_nop 1
    v_permlane32_swap_b32 v160, v162
    s_nop 1
    v_max_f32 v160, v160, v162
    v_mov_b32 v162, v160
    s_nop 1
    v_permlane16_swap_b32 v160, v162
    s_nop 1
    v_max_f32 v160, v160, v162
    v_max_f32 v160, v160, v167
    v_sub_f32 v161, v167, v160
    v_exp_f32 v161, v161
    v_mov_b32 v167, v160
    v_sub_f32 v96, v96, v160
    v_sub_f32 v97, v97, v160
    v_sub_f32 v98, v98, v160
    v_sub_f32 v99, v99, v160
    v_sub_f32 v100, v100, v160
    v_sub_f32 v101, v101, v160
    v_sub_f32 v102, v102, v160
    v_sub_f32 v103, v103, v160
    v_sub_f32 v104, v104, v160
    v_sub_f32 v105, v105, v160
    v_sub_f32 v106, v106, v160
    v_sub_f32 v107, v107, v160
    v_sub_f32 v108, v108, v160
    v_sub_f32 v109, v109, v160
    v_sub_f32 v110, v110, v160
    v_sub_f32 v111, v111, v160
    v_exp_f32 v96, v96
    v_exp_f32 v97, v97
    v_exp_f32 v98, v98
    v_exp_f32 v99, v99
    v_exp_f32 v100, v100
    v_exp_f32 v101, v101
    v_exp_f32 v102, v102
    v_exp_f32 v103, v103
    v_exp_f32 v104, v104
    v_exp_f32 v105, v105
    v_exp_f32 v106, v106
    v_exp_f32 v107, v107
    v_exp_f32 v108, v108
    v_exp_f32 v109, v109
    v_exp_f32 v110, v110
    v_exp_f32 v111, v111
    v_mul_f32 v183, v183, v161
    v_add_f32 v183, v183, v96
    v_add_f32 v183, v183, v97
    v_add_f32 v183, v183, v98
    v_add_f32 v183, v183, v99
    v_add_f32 v183, v183, v100
    v_add_f32 v183, v183, v101
    v_add_f32 v183, v183, v102
    v_add_f32 v183, v183, v103
    v_add_f32 v183, v183, v104
    v_add_f32 v183, v183, v105
    v_add_f32 v183, v183, v106
    v_add_f32 v183, v183, v107
    v_add_f32 v183, v183, v108
    v_add_f32 v183, v183, v109
    v_add_f32 v183, v183, v110
    v_add_f32 v183, v183, v111
    v_cvt_pk_bf16_f32 v136, v96, v97
    v_cvt_pk_bf16_f32 v137, v98, v99
    v_cvt_pk_bf16_f32 v138, v100, v101
    v_cvt_pk_bf16_f32 v139, v102, v103
    v_cvt_pk_bf16_f32 v140, v104, v105
    v_cvt_pk_bf16_f32 v141, v106, v107
    v_cvt_pk_bf16_f32 v142, v108, v109
    v_cvt_pk_bf16_f32 v143, v110, v111
    v_accvgpr_read_b32 v244, a96
    v_mul_f32 v244, v244, v161
    v_accvgpr_write_b32 a96, v244
    v_accvgpr_read_b32 v245, a97
    v_mul_f32 v245, v245, v161
    v_accvgpr_write_b32 a97, v245
    v_accvgpr_read_b32 v246, a98
    v_mul_f32 v246, v246, v161
    v_accvgpr_write_b32 a98, v246
    v_accvgpr_read_b32 v247, a99
    v_mul_f32 v247, v247, v161
    v_accvgpr_write_b32 a99, v247
    v_accvgpr_read_b32 v248, a100
    v_mul_f32 v248, v248, v161
    v_accvgpr_write_b32 a100, v248
    v_accvgpr_read_b32 v249, a101
    v_mul_f32 v249, v249, v161
    v_accvgpr_write_b32 a101, v249
    v_accvgpr_read_b32 v250, a102
    v_mul_f32 v250, v250, v161
    v_accvgpr_write_b32 a102, v250
    v_accvgpr_read_b32 v251, a103
    v_mul_f32 v251, v251, v161
    v_accvgpr_write_b32 a103, v251
    v_accvgpr_read_b32 v244, a104
    v_mul_f32 v244, v244, v161
    v_accvgpr_write_b32 a104, v244
    v_accvgpr_read_b32 v245, a105
    v_mul_f32 v245, v245, v161
    v_accvgpr_write_b32 a105, v245
    v_accvgpr_read_b32 v246, a106
    v_mul_f32 v246, v246, v161
    v_accvgpr_write_b32 a106, v246
    v_accvgpr_read_b32 v247, a107
    v_mul_f32 v247, v247, v161
    v_accvgpr_write_b32 a107, v247
    v_accvgpr_read_b32 v248, a108
    v_mul_f32 v248, v248, v161
    v_accvgpr_write_b32 a108, v248
    v_accvgpr_read_b32 v249, a109
    v_mul_f32 v249, v249, v161
    v_accvgpr_write_b32 a109, v249
    v_accvgpr_read_b32 v250, a110
    v_mul_f32 v250, v250, v161
    v_accvgpr_write_b32 a110, v250
    v_accvgpr_read_b32 v251, a111
    v_mul_f32 v251, v251, v161
    v_accvgpr_write_b32 a111, v251
    v_accvgpr_read_b32 v244, a112
    v_mul_f32 v244, v244, v161
    v_accvgpr_write_b32 a112, v244
    v_accvgpr_read_b32 v245, a113
    v_mul_f32 v245, v245, v161
    v_accvgpr_write_b32 a113, v245
    v_accvgpr_read_b32 v246, a114
    v_mul_f32 v246, v246, v161
    v_accvgpr_write_b32 a114, v246
    v_accvgpr_read_b32 v247, a115
    v_mul_f32 v247, v247, v161
    v_accvgpr_write_b32 a115, v247
    v_accvgpr_read_b32 v248, a116
    v_mul_f32 v248, v248, v161
    v_accvgpr_write_b32 a116, v248
    v_accvgpr_read_b32 v249, a117
    v_mul_f32 v249, v249, v161
    v_accvgpr_write_b32 a117, v249
    v_accvgpr_read_b32 v250, a118
    v_mul_f32 v250, v250, v161
    v_accvgpr_write_b32 a118, v250
    v_accvgpr_read_b32 v251, a119
    v_mul_f32 v251, v251, v161
    v_accvgpr_write_b32 a119, v251
    v_accvgpr_read_b32 v244, a120
    v_mul_f32 v244, v244, v161
    v_accvgpr_write_b32 a120, v244
    v_accvgpr_read_b32 v245, a121
    v_mul_f32 v245, v245, v161
    v_accvgpr_write_b32 a121, v245
    v_accvgpr_read_b32 v246, a122
    v_mul_f32 v246, v246, v161
    v_accvgpr_write_b32 a122, v246
    v_accvgpr_read_b32 v247, a123
    v_mul_f32 v247, v247, v161
    v_accvgpr_write_b32 a123, v247
    v_accvgpr_read_b32 v248, a124
    v_mul_f32 v248, v248, v161
    v_accvgpr_write_b32 a124, v248
    v_accvgpr_read_b32 v249, a125
    v_mul_f32 v249, v249, v161
    v_accvgpr_write_b32 a125, v249
    v_accvgpr_read_b32 v250, a126
    v_mul_f32 v250, v250, v161
    v_accvgpr_write_b32 a126, v250
    v_accvgpr_read_b32 v251, a127
    v_mul_f32 v251, v251, v161
    v_accvgpr_write_b32 a127, v251
    v_mfma_f32_16x16x32_bf16 v[96:99], a[192:195], v[64:67], 0
    v_mfma_f32_16x16x32_bf16 v[96:99], a[196:199], v[68:71], v[96:99]
    v_mfma_f32_16x16x32_bf16 v[96:99], a[200:203], v[72:75], v[96:99]
    v_mfma_f32_16x16x32_bf16 v[96:99], a[204:207], v[76:79], v[96:99]
    v_mfma_f32_16x16x32_bf16 v[100:103], a[208:211], v[64:67], 0
    v_mfma_f32_16x16x32_bf16 v[100:103], a[212:215], v[68:71], v[100:103]
    v_mfma_f32_16x16x32_bf16 v[100:103], a[216:219], v[72:75], v[100:103]
    v_mfma_f32_16x16x32_bf16 v[100:103], a[220:223], v[76:79], v[100:103]
    v_mfma_f32_16x16x32_bf16 v[104:107], a[224:227], v[64:67], 0
    v_mfma_f32_16x16x32_bf16 v[104:107], a[228:231], v[68:71], v[104:107]
    v_mfma_f32_16x16x32_bf16 v[104:107], a[232:235], v[72:75], v[104:107]
    v_mfma_f32_16x16x32_bf16 v[104:107], a[236:239], v[76:79], v[104:107]
    v_mfma_f32_16x16x32_bf16 v[108:111], a[240:243], v[64:67], 0
    v_mfma_f32_16x16x32_bf16 v[108:111], a[244:247], v[68:71], v[108:111]
    v_mfma_f32_16x16x32_bf16 v[108:111], a[248:251], v[72:75], v[108:111]
    v_mfma_f32_16x16x32_bf16 v[108:111], a[252:255], v[76:79], v[108:111]
    s_nop 9
    v_max3_f32 v160, v96, v97, v98
    v_max3_f32 v160, v160, v99, v100
    v_max3_f32 v160, v160, v101, v102
    v_max3_f32 v160, v160, v103, v104
    v_max3_f32 v160, v160, v105, v106
    v_max3_f32 v160, v160, v107, v108
    v_max3_f32 v160, v160, v109, v110
    v_max_f32 v160, v160, v111
    v_mov_b32 v162, v160
    s_nop 1
    v_permlane32_swap_b32 v160, v162
    s_nop 1
    v_max_f32 v160, v160, v162
    v_mov_b32 v162, v160
    s_nop 1
    v_permlane16_swap_b32 v160, v162
    s_nop 1
    v_max_f32 v160, v160, v162
    v_max_f32 v160, v160, v168
    v_sub_f32 v161, v168, v160
    v_exp_f32 v161, v161
    v_mov_b32 v168, v160
    v_sub_f32 v96, v96, v160
    v_sub_f32 v97, v97, v160
    v_sub_f32 v98, v98, v160
    v_sub_f32 v99, v99, v160
    v_sub_f32 v100, v100, v160
    v_sub_f32 v101, v101, v160
    v_sub_f32 v102, v102, v160
    v_sub_f32 v103, v103, v160
    v_sub_f32 v104, v104, v160
    v_sub_f32 v105, v105, v160
    v_sub_f32 v106, v106, v160
    v_sub_f32 v107, v107, v160
    v_sub_f32 v108, v108, v160
    v_sub_f32 v109, v109, v160
    v_sub_f32 v110, v110, v160
    v_sub_f32 v111, v111, v160
    v_exp_f32 v96, v96
    v_exp_f32 v97, v97
    v_exp_f32 v98, v98
    v_exp_f32 v99, v99
    v_exp_f32 v100, v100
    v_exp_f32 v101, v101
    v_exp_f32 v102, v102
    v_exp_f32 v103, v103
    v_exp_f32 v104, v104
    v_exp_f32 v105, v105
    v_exp_f32 v106, v106
    v_exp_f32 v107, v107
    v_exp_f32 v108, v108
    v_exp_f32 v109, v109
    v_exp_f32 v110, v110
    v_exp_f32 v111, v111
    v_mul_f32 v184, v184, v161
    v_add_f32 v184, v184, v96
    v_add_f32 v184, v184, v97
    v_add_f32 v184, v184, v98
    v_add_f32 v184, v184, v99
    v_add_f32 v184, v184, v100
    v_add_f32 v184, v184, v101
    v_add_f32 v184, v184, v102
    v_add_f32 v184, v184, v103
    v_add_f32 v184, v184, v104
    v_add_f32 v184, v184, v105
    v_add_f32 v184, v184, v106
    v_add_f32 v184, v184, v107
    v_add_f32 v184, v184, v108
    v_add_f32 v184, v184, v109
    v_add_f32 v184, v184, v110
    v_add_f32 v184, v184, v111
    v_cvt_pk_bf16_f32 v144, v96, v97
    v_cvt_pk_bf16_f32 v145, v98, v99
    v_cvt_pk_bf16_f32 v146, v100, v101
    v_cvt_pk_bf16_f32 v147, v102, v103
    v_cvt_pk_bf16_f32 v148, v104, v105
    v_cvt_pk_bf16_f32 v149, v106, v107
    v_cvt_pk_bf16_f32 v150, v108, v109
    v_cvt_pk_bf16_f32 v151, v110, v111
    v_accvgpr_read_b32 v244, a128
    v_mul_f32 v244, v244, v161
    v_accvgpr_write_b32 a128, v244
    v_accvgpr_read_b32 v245, a129
    v_mul_f32 v245, v245, v161
    v_accvgpr_write_b32 a129, v245
    v_accvgpr_read_b32 v246, a130
    v_mul_f32 v246, v246, v161
    v_accvgpr_write_b32 a130, v246
    v_accvgpr_read_b32 v247, a131
    v_mul_f32 v247, v247, v161
    v_accvgpr_write_b32 a131, v247
    v_accvgpr_read_b32 v248, a132
    v_mul_f32 v248, v248, v161
    v_accvgpr_write_b32 a132, v248
    v_accvgpr_read_b32 v249, a133
    v_mul_f32 v249, v249, v161
    v_accvgpr_write_b32 a133, v249
    v_accvgpr_read_b32 v250, a134
    v_mul_f32 v250, v250, v161
    v_accvgpr_write_b32 a134, v250
    v_accvgpr_read_b32 v251, a135
    v_mul_f32 v251, v251, v161
    v_accvgpr_write_b32 a135, v251
    v_accvgpr_read_b32 v244, a136
    v_mul_f32 v244, v244, v161
    v_accvgpr_write_b32 a136, v244
    v_accvgpr_read_b32 v245, a137
    v_mul_f32 v245, v245, v161
    v_accvgpr_write_b32 a137, v245
    v_accvgpr_read_b32 v246, a138
    v_mul_f32 v246, v246, v161
    v_accvgpr_write_b32 a138, v246
    v_accvgpr_read_b32 v247, a139
    v_mul_f32 v247, v247, v161
    v_accvgpr_write_b32 a139, v247
    v_accvgpr_read_b32 v248, a140
    v_mul_f32 v248, v248, v161
    v_accvgpr_write_b32 a140, v248
    v_accvgpr_read_b32 v249, a141
    v_mul_f32 v249, v249, v161
    v_accvgpr_write_b32 a141, v249
    v_accvgpr_read_b32 v250, a142
    v_mul_f32 v250, v250, v161
    v_accvgpr_write_b32 a142, v250
    v_accvgpr_read_b32 v251, a143
    v_mul_f32 v251, v251, v161
    v_accvgpr_write_b32 a143, v251
    v_accvgpr_read_b32 v244, a144
    v_mul_f32 v244, v244, v161
    v_accvgpr_write_b32 a144, v244
    v_accvgpr_read_b32 v245, a145
    v_mul_f32 v245, v245, v161
    v_accvgpr_write_b32 a145, v245
    v_accvgpr_read_b32 v246, a146
    v_mul_f32 v246, v246, v161
    v_accvgpr_write_b32 a146, v246
    v_accvgpr_read_b32 v247, a147
    v_mul_f32 v247, v247, v161
    v_accvgpr_write_b32 a147, v247
    v_accvgpr_read_b32 v248, a148
    v_mul_f32 v248, v248, v161
    v_accvgpr_write_b32 a148, v248
    v_accvgpr_read_b32 v249, a149
    v_mul_f32 v249, v249, v161
    v_accvgpr_write_b32 a149, v249
    v_accvgpr_read_b32 v250, a150
    v_mul_f32 v250, v250, v161
    v_accvgpr_write_b32 a150, v250
    v_accvgpr_read_b32 v251, a151
    v_mul_f32 v251, v251, v161
    v_accvgpr_write_b32 a151, v251
    v_accvgpr_read_b32 v244, a152
    v_mul_f32 v244, v244, v161
    v_accvgpr_write_b32 a152, v244
    v_accvgpr_read_b32 v245, a153
    v_mul_f32 v245, v245, v161
    v_accvgpr_write_b32 a153, v245
    v_accvgpr_read_b32 v246, a154
    v_mul_f32 v246, v246, v161
    v_accvgpr_write_b32 a154, v246
    v_accvgpr_read_b32 v247, a155
    v_mul_f32 v247, v247, v161
    v_accvgpr_write_b32 a155, v247
    v_accvgpr_read_b32 v248, a156
    v_mul_f32 v248, v248, v161
    v_accvgpr_write_b32 a156, v248
    v_accvgpr_read_b32 v249, a157
    v_mul_f32 v249, v249, v161
    v_accvgpr_write_b32 a157, v249
    v_accvgpr_read_b32 v250, a158
    v_mul_f32 v250, v250, v161
    v_accvgpr_write_b32 a158, v250
    v_accvgpr_read_b32 v251, a159
    v_mul_f32 v251, v251, v161
    v_accvgpr_write_b32 a159, v251
    v_mfma_f32_16x16x32_bf16 v[96:99], a[192:195], v[80:83], 0
    v_mfma_f32_16x16x32_bf16 v[96:99], a[196:199], v[84:87], v[96:99]
    v_mfma_f32_16x16x32_bf16 v[96:99], a[200:203], v[88:91], v[96:99]
    v_mfma_f32_16x16x32_bf16 v[96:99], a[204:207], v[92:95], v[96:99]
    v_mfma_f32_16x16x32_bf16 v[100:103], a[208:211], v[80:83], 0
    v_mfma_f32_16x16x32_bf16 v[100:103], a[212:215], v[84:87], v[100:103]
    v_mfma_f32_16x16x32_bf16 v[100:103], a[216:219], v[88:91], v[100:103]
    v_mfma_f32_16x16x32_bf16 v[100:103], a[220:223], v[92:95], v[100:103]
    v_mfma_f32_16x16x32_bf16 v[104:107], a[224:227], v[80:83], 0
    v_mfma_f32_16x16x32_bf16 v[104:107], a[228:231], v[84:87], v[104:107]
    v_mfma_f32_16x16x32_bf16 v[104:107], a[232:235], v[88:91], v[104:107]
    v_mfma_f32_16x16x32_bf16 v[104:107], a[236:239], v[92:95], v[104:107]
    v_mfma_f32_16x16x32_bf16 v[108:111], a[240:243], v[80:83], 0
    v_mfma_f32_16x16x32_bf16 v[108:111], a[244:247], v[84:87], v[108:111]
    v_mfma_f32_16x16x32_bf16 v[108:111], a[248:251], v[88:91], v[108:111]
    v_mfma_f32_16x16x32_bf16 v[108:111], a[252:255], v[92:95], v[108:111]
    s_nop 9
    v_max3_f32 v160, v96, v97, v98
    v_max3_f32 v160, v160, v99, v100
    v_max3_f32 v160, v160, v101, v102
    v_max3_f32 v160, v160, v103, v104
    v_max3_f32 v160, v160, v105, v106
    v_max3_f32 v160, v160, v107, v108
    v_max3_f32 v160, v160, v109, v110
    v_max_f32 v160, v160, v111
    v_mov_b32 v162, v160
    s_nop 1
    v_permlane32_swap_b32 v160, v162
    s_nop 1
    v_max_f32 v160, v160, v162
    v_mov_b32 v162, v160
    s_nop 1
    v_permlane16_swap_b32 v160, v162
    s_nop 1
    v_max_f32 v160, v160, v162
    v_max_f32 v160, v160, v169
    v_sub_f32 v161, v169, v160
    v_exp_f32 v161, v161
    v_mov_b32 v169, v160
    v_sub_f32 v96, v96, v160
    v_sub_f32 v97, v97, v160
    v_sub_f32 v98, v98, v160
    v_sub_f32 v99, v99, v160
    v_sub_f32 v100, v100, v160
    v_sub_f32 v101, v101, v160
    v_sub_f32 v102, v102, v160
    v_sub_f32 v103, v103, v160
    v_sub_f32 v104, v104, v160
    v_sub_f32 v105, v105, v160
    v_sub_f32 v106, v106, v160
    v_sub_f32 v107, v107, v160
    v_sub_f32 v108, v108, v160
    v_sub_f32 v109, v109, v160
    v_sub_f32 v110, v110, v160
    v_sub_f32 v111, v111, v160
    v_exp_f32 v96, v96
    v_exp_f32 v97, v97
    v_exp_f32 v98, v98
    v_exp_f32 v99, v99
    v_exp_f32 v100, v100
    v_exp_f32 v101, v101
    v_exp_f32 v102, v102
    v_exp_f32 v103, v103
    v_exp_f32 v104, v104
    v_exp_f32 v105, v105
    v_exp_f32 v106, v106
    v_exp_f32 v107, v107
    v_exp_f32 v108, v108
    v_exp_f32 v109, v109
    v_exp_f32 v110, v110
    v_exp_f32 v111, v111
    v_mul_f32 v185, v185, v161
    v_add_f32 v185, v185, v96
    v_add_f32 v185, v185, v97
    v_add_f32 v185, v185, v98
    v_add_f32 v185, v185, v99
    v_add_f32 v185, v185, v100
    v_add_f32 v185, v185, v101
    v_add_f32 v185, v185, v102
    v_add_f32 v185, v185, v103
    v_add_f32 v185, v185, v104
    v_add_f32 v185, v185, v105
    v_add_f32 v185, v185, v106
    v_add_f32 v185, v185, v107
    v_add_f32 v185, v185, v108
    v_add_f32 v185, v185, v109
    v_add_f32 v185, v185, v110
    v_add_f32 v185, v185, v111
    v_cvt_pk_bf16_f32 v152, v96, v97
    v_cvt_pk_bf16_f32 v153, v98, v99
    v_cvt_pk_bf16_f32 v154, v100, v101
    v_cvt_pk_bf16_f32 v155, v102, v103
    v_cvt_pk_bf16_f32 v156, v104, v105
    v_cvt_pk_bf16_f32 v157, v106, v107
    v_cvt_pk_bf16_f32 v158, v108, v109
    v_cvt_pk_bf16_f32 v159, v110, v111
    v_accvgpr_read_b32 v244, a160
    v_mul_f32 v244, v244, v161
    v_accvgpr_write_b32 a160, v244
    v_accvgpr_read_b32 v245, a161
    v_mul_f32 v245, v245, v161
    v_accvgpr_write_b32 a161, v245
    v_accvgpr_read_b32 v246, a162
    v_mul_f32 v246, v246, v161
    v_accvgpr_write_b32 a162, v246
    v_accvgpr_read_b32 v247, a163
    v_mul_f32 v247, v247, v161
    v_accvgpr_write_b32 a163, v247
    v_accvgpr_read_b32 v248, a164
    v_mul_f32 v248, v248, v161
    v_accvgpr_write_b32 a164, v248
    v_accvgpr_read_b32 v249, a165
    v_mul_f32 v249, v249, v161
    v_accvgpr_write_b32 a165, v249
    v_accvgpr_read_b32 v250, a166
    v_mul_f32 v250, v250, v161
    v_accvgpr_write_b32 a166, v250
    v_accvgpr_read_b32 v251, a167
    v_mul_f32 v251, v251, v161
    v_accvgpr_write_b32 a167, v251
    v_accvgpr_read_b32 v244, a168
    v_mul_f32 v244, v244, v161
    v_accvgpr_write_b32 a168, v244
    v_accvgpr_read_b32 v245, a169
    v_mul_f32 v245, v245, v161
    v_accvgpr_write_b32 a169, v245
    v_accvgpr_read_b32 v246, a170
    v_mul_f32 v246, v246, v161
    v_accvgpr_write_b32 a170, v246
    v_accvgpr_read_b32 v247, a171
    v_mul_f32 v247, v247, v161
    v_accvgpr_write_b32 a171, v247
    v_accvgpr_read_b32 v248, a172
    v_mul_f32 v248, v248, v161
    v_accvgpr_write_b32 a172, v248
    v_accvgpr_read_b32 v249, a173
    v_mul_f32 v249, v249, v161
    v_accvgpr_write_b32 a173, v249
    v_accvgpr_read_b32 v250, a174
    v_mul_f32 v250, v250, v161
    v_accvgpr_write_b32 a174, v250
    v_accvgpr_read_b32 v251, a175
    v_mul_f32 v251, v251, v161
    v_accvgpr_write_b32 a175, v251
    v_accvgpr_read_b32 v244, a176
    v_mul_f32 v244, v244, v161
    v_accvgpr_write_b32 a176, v244
    v_accvgpr_read_b32 v245, a177
    v_mul_f32 v245, v245, v161
    v_accvgpr_write_b32 a177, v245
    v_accvgpr_read_b32 v246, a178
    v_mul_f32 v246, v246, v161
    v_accvgpr_write_b32 a178, v246
    v_accvgpr_read_b32 v247, a179
    v_mul_f32 v247, v247, v161
    v_accvgpr_write_b32 a179, v247
    v_accvgpr_read_b32 v248, a180
    v_mul_f32 v248, v248, v161
    v_accvgpr_write_b32 a180, v248
    v_accvgpr_read_b32 v249, a181
    v_mul_f32 v249, v249, v161
    v_accvgpr_write_b32 a181, v249
    v_accvgpr_read_b32 v250, a182
    v_mul_f32 v250, v250, v161
    v_accvgpr_write_b32 a182, v250
    v_accvgpr_read_b32 v251, a183
    v_mul_f32 v251, v251, v161
    v_accvgpr_write_b32 a183, v251
    v_accvgpr_read_b32 v244, a184
    v_mul_f32 v244, v244, v161
    v_accvgpr_write_b32 a184, v244
    v_accvgpr_read_b32 v245, a185
    v_mul_f32 v245, v245, v161
    v_accvgpr_write_b32 a185, v245
    v_accvgpr_read_b32 v246, a186
    v_mul_f32 v246, v246, v161
    v_accvgpr_write_b32 a186, v246
    v_accvgpr_read_b32 v247, a187
    v_mul_f32 v247, v247, v161
    v_accvgpr_write_b32 a187, v247
    v_accvgpr_read_b32 v248, a188
    v_mul_f32 v248, v248, v161
    v_accvgpr_write_b32 a188, v248
    v_accvgpr_read_b32 v249, a189
    v_mul_f32 v249, v249, v161
    v_accvgpr_write_b32 a189, v249
    v_accvgpr_read_b32 v250, a190
    v_mul_f32 v250, v250, v161
    v_accvgpr_write_b32 a190, v250
    v_accvgpr_read_b32 v251, a191
    v_mul_f32 v251, v251, v161
    v_accvgpr_write_b32 a191, v251
    s_nop 9
    ds_read_b64_tr_b16 a[192:193], v194 offset:0
    ds_read_b64_tr_b16 a[194:195], v198 offset:0
    ds_read_b64_tr_b16 a[196:197], v195 offset:0
    ds_read_b64_tr_b16 a[198:199], v199 offset:0
    ds_read_b64_tr_b16 a[200:201], v196 offset:0
    ds_read_b64_tr_b16 a[202:203], v200 offset:0
    ds_read_b64_tr_b16 a[204:205], v197 offset:0
    ds_read_b64_tr_b16 a[206:207], v201 offset:0
    s_waitcnt lgkmcnt(0)
    ds_read_b64_tr_b16 a[208:209], v194 offset:512
    ds_read_b64_tr_b16 a[210:211], v198 offset:512
    ds_read_b64_tr_b16 a[212:213], v195 offset:512
    ds_read_b64_tr_b16 a[214:215], v199 offset:512
    ds_read_b64_tr_b16 a[216:217], v196 offset:512
    ds_read_b64_tr_b16 a[218:219], v200 offset:512
    ds_read_b64_tr_b16 a[220:221], v197 offset:512
    ds_read_b64_tr_b16 a[222:223], v201 offset:512
    s_waitcnt lgkmcnt(0)
    ds_read_b64_tr_b16 a[224:225], v202 offset:0
    ds_read_b64_tr_b16 a[226:227], v206 offset:0
    ds_read_b64_tr_b16 a[228:229], v203 offset:0
    ds_read_b64_tr_b16 a[230:231], v207 offset:0
    ds_read_b64_tr_b16 a[232:233], v204 offset:0
    ds_read_b64_tr_b16 a[234:235], v208 offset:0
    ds_read_b64_tr_b16 a[236:237], v205 offset:0
    ds_read_b64_tr_b16 a[238:239], v209 offset:0
    s_waitcnt lgkmcnt(0)
    ds_read_b64_tr_b16 a[240:241], v202 offset:512
    ds_read_b64_tr_b16 a[242:243], v206 offset:512
    ds_read_b64_tr_b16 a[244:245], v203 offset:512
    ds_read_b64_tr_b16 a[246:247], v207 offset:512
    ds_read_b64_tr_b16 a[248:249], v204 offset:512
    ds_read_b64_tr_b16 a[250:251], v208 offset:512
    ds_read_b64_tr_b16 a[252:253], v205 offset:512
    ds_read_b64_tr_b16 a[254:255], v209 offset:512
    s_waitcnt lgkmcnt(0)
    v_mfma_f32_16x16x32_bf16 a[0:3], a[192:195], v[112:115], a[0:3]
    v_mfma_f32_16x16x32_bf16 a[4:7], a[196:199], v[112:115], a[4:7]
    v_mfma_f32_16x16x32_bf16 a[8:11], a[200:203], v[112:115], a[8:11]
    v_mfma_f32_16x16x32_bf16 a[12:15], a[204:207], v[112:115], a[12:15]
    v_mfma_f32_16x16x32_bf16 a[16:19], a[208:211], v[112:115], a[16:19]
    v_mfma_f32_16x16x32_bf16 a[20:23], a[212:215], v[112:115], a[20:23]
    v_mfma_f32_16x16x32_bf16 a[24:27], a[216:219], v[112:115], a[24:27]
    v_mfma_f32_16x16x32_bf16 a[28:31], a[220:223], v[112:115], a[28:31]
    v_mfma_f32_16x16x32_bf16 a[0:3], a[224:227], v[116:119], a[0:3]
    v_mfma_f32_16x16x32_bf16 a[4:7], a[228:231], v[116:119], a[4:7]
    v_mfma_f32_16x16x32_bf16 a[8:11], a[232:235], v[116:119], a[8:11]
    v_mfma_f32_16x16x32_bf16 a[12:15], a[236:239], v[116:119], a[12:15]
    v_mfma_f32_16x16x32_bf16 a[16:19], a[240:243], v[116:119], a[16:19]
    v_mfma_f32_16x16x32_bf16 a[20:23], a[244:247], v[116:119], a[20:23]
    v_mfma_f32_16x16x32_bf16 a[24:27], a[248:251], v[116:119], a[24:27]
    v_mfma_f32_16x16x32_bf16 a[28:31], a[252:255], v[116:119], a[28:31]
    v_mfma_f32_16x16x32_bf16 a[32:35], a[192:195], v[120:123], a[32:35]
    v_mfma_f32_16x16x32_bf16 a[36:39], a[196:199], v[120:123], a[36:39]
    v_mfma_f32_16x16x32_bf16 a[40:43], a[200:203], v[120:123], a[40:43]
    v_mfma_f32_16x16x32_bf16 a[44:47], a[204:207], v[120:123], a[44:47]
    v_mfma_f32_16x16x32_bf16 a[48:51], a[208:211], v[120:123], a[48:51]
    v_mfma_f32_16x16x32_bf16 a[52:55], a[212:215], v[120:123], a[52:55]
    v_mfma_f32_16x16x32_bf16 a[56:59], a[216:219], v[120:123], a[56:59]
    v_mfma_f32_16x16x32_bf16 a[60:63], a[220:223], v[120:123], a[60:63]
    v_mfma_f32_16x16x32_bf16 a[32:35], a[224:227], v[124:127], a[32:35]
    v_mfma_f32_16x16x32_bf16 a[36:39], a[228:231], v[124:127], a[36:39]
    v_mfma_f32_16x16x32_bf16 a[40:43], a[232:235], v[124:127], a[40:43]
    v_mfma_f32_16x16x32_bf16 a[44:47], a[236:239], v[124:127], a[44:47]
    v_mfma_f32_16x16x32_bf16 a[48:51], a[240:243], v[124:127], a[48:51]
    v_mfma_f32_16x16x32_bf16 a[52:55], a[244:247], v[124:127], a[52:55]
    v_mfma_f32_16x16x32_bf16 a[56:59], a[248:251], v[124:127], a[56:59]
    v_mfma_f32_16x16x32_bf16 a[60:63], a[252:255], v[124:127], a[60:63]
    v_mfma_f32_16x16x32_bf16 a[64:67], a[192:195], v[128:131], a[64:67]
    v_mfma_f32_16x16x32_bf16 a[68:71], a[196:199], v[128:131], a[68:71]
    v_mfma_f32_16x16x32_bf16 a[72:75], a[200:203], v[128:131], a[72:75]
    v_mfma_f32_16x16x32_bf16 a[76:79], a[204:207], v[128:131], a[76:79]
    v_mfma_f32_16x16x32_bf16 a[80:83], a[208:211], v[128:131], a[80:83]
    v_mfma_f32_16x16x32_bf16 a[84:87], a[212:215], v[128:131], a[84:87]
    v_mfma_f32_16x16x32_bf16 a[88:91], a[216:219], v[128:131], a[88:91]
    v_mfma_f32_16x16x32_bf16 a[92:95], a[220:223], v[128:131], a[92:95]
    v_mfma_f32_16x16x32_bf16 a[64:67], a[224:227], v[132:135], a[64:67]
    v_mfma_f32_16x16x32_bf16 a[68:71], a[228:231], v[132:135], a[68:71]
    v_mfma_f32_16x16x32_bf16 a[72:75], a[232:235], v[132:135], a[72:75]
    v_mfma_f32_16x16x32_bf16 a[76:79], a[236:239], v[132:135], a[76:79]
    v_mfma_f32_16x16x32_bf16 a[80:83], a[240:243], v[132:135], a[80:83]
    v_mfma_f32_16x16x32_bf16 a[84:87], a[244:247], v[132:135], a[84:87]
    v_mfma_f32_16x16x32_bf16 a[88:91], a[248:251], v[132:135], a[88:91]
    v_mfma_f32_16x16x32_bf16 a[92:95], a[252:255], v[132:135], a[92:95]
    v_mfma_f32_16x16x32_bf16 a[96:99], a[192:195], v[136:139], a[96:99]
    v_mfma_f32_16x16x32_bf16 a[100:103], a[196:199], v[136:139], a[100:103]
    v_mfma_f32_16x16x32_bf16 a[104:107], a[200:203], v[136:139], a[104:107]
    v_mfma_f32_16x16x32_bf16 a[108:111], a[204:207], v[136:139], a[108:111]
    v_mfma_f32_16x16x32_bf16 a[112:115], a[208:211], v[136:139], a[112:115]
    v_mfma_f32_16x16x32_bf16 a[116:119], a[212:215], v[136:139], a[116:119]
    v_mfma_f32_16x16x32_bf16 a[120:123], a[216:219], v[136:139], a[120:123]
    v_mfma_f32_16x16x32_bf16 a[124:127], a[220:223], v[136:139], a[124:127]
    v_mfma_f32_16x16x32_bf16 a[96:99], a[224:227], v[140:143], a[96:99]
    v_mfma_f32_16x16x32_bf16 a[100:103], a[228:231], v[140:143], a[100:103]
    v_mfma_f32_16x16x32_bf16 a[104:107], a[232:235], v[140:143], a[104:107]
    v_mfma_f32_16x16x32_bf16 a[108:111], a[236:239], v[140:143], a[108:111]
    v_mfma_f32_16x16x32_bf16 a[112:115], a[240:243], v[140:143], a[112:115]
    v_mfma_f32_16x16x32_bf16 a[116:119], a[244:247], v[140:143], a[116:119]
    v_mfma_f32_16x16x32_bf16 a[120:123], a[248:251], v[140:143], a[120:123]
    v_mfma_f32_16x16x32_bf16 a[124:127], a[252:255], v[140:143], a[124:127]
    v_mfma_f32_16x16x32_bf16 a[128:131], a[192:195], v[144:147], a[128:131]
    v_mfma_f32_16x16x32_bf16 a[132:135], a[196:199], v[144:147], a[132:135]
    v_mfma_f32_16x16x32_bf16 a[136:139], a[200:203], v[144:147], a[136:139]
    v_mfma_f32_16x16x32_bf16 a[140:143], a[204:207], v[144:147], a[140:143]
    v_mfma_f32_16x16x32_bf16 a[144:147], a[208:211], v[144:147], a[144:147]
    v_mfma_f32_16x16x32_bf16 a[148:151], a[212:215], v[144:147], a[148:151]
    v_mfma_f32_16x16x32_bf16 a[152:155], a[216:219], v[144:147], a[152:155]
    v_mfma_f32_16x16x32_bf16 a[156:159], a[220:223], v[144:147], a[156:159]
    v_mfma_f32_16x16x32_bf16 a[128:131], a[224:227], v[148:151], a[128:131]
    v_mfma_f32_16x16x32_bf16 a[132:135], a[228:231], v[148:151], a[132:135]
    v_mfma_f32_16x16x32_bf16 a[136:139], a[232:235], v[148:151], a[136:139]
    v_mfma_f32_16x16x32_bf16 a[140:143], a[236:239], v[148:151], a[140:143]
    v_mfma_f32_16x16x32_bf16 a[144:147], a[240:243], v[148:151], a[144:147]
    v_mfma_f32_16x16x32_bf16 a[148:151], a[244:247], v[148:151], a[148:151]
    v_mfma_f32_16x16x32_bf16 a[152:155], a[248:251], v[148:151], a[152:155]
    v_mfma_f32_16x16x32_bf16 a[156:159], a[252:255], v[148:151], a[156:159]
    v_mfma_f32_16x16x32_bf16 a[160:163], a[192:195], v[152:155], a[160:163]
    v_mfma_f32_16x16x32_bf16 a[164:167], a[196:199], v[152:155], a[164:167]
    v_mfma_f32_16x16x32_bf16 a[168:171], a[200:203], v[152:155], a[168:171]
    v_mfma_f32_16x16x32_bf16 a[172:175], a[204:207], v[152:155], a[172:175]
    v_mfma_f32_16x16x32_bf16 a[176:179], a[208:211], v[152:155], a[176:179]
    v_mfma_f32_16x16x32_bf16 a[180:183], a[212:215], v[152:155], a[180:183]
    v_mfma_f32_16x16x32_bf16 a[184:187], a[216:219], v[152:155], a[184:187]
    v_mfma_f32_16x16x32_bf16 a[188:191], a[220:223], v[152:155], a[188:191]
    v_mfma_f32_16x16x32_bf16 a[160:163], a[224:227], v[156:159], a[160:163]
    v_mfma_f32_16x16x32_bf16 a[164:167], a[228:231], v[156:159], a[164:167]
    v_mfma_f32_16x16x32_bf16 a[168:171], a[232:235], v[156:159], a[168:171]
    v_mfma_f32_16x16x32_bf16 a[172:175], a[236:239], v[156:159], a[172:175]
    v_mfma_f32_16x16x32_bf16 a[176:179], a[240:243], v[156:159], a[176:179]
    v_mfma_f32_16x16x32_bf16 a[180:183], a[244:247], v[156:159], a[180:183]
    v_mfma_f32_16x16x32_bf16 a[184:187], a[248:251], v[156:159], a[184:187]
    v_mfma_f32_16x16x32_bf16 a[188:191], a[252:255], v[156:159], a[188:191]
    s_nop 9
    s_add_u32 s33, s33, 16384
    s_sub_u32 s23, s23, 1
    s_cmp_lg_u32 s23, 0
    s_cbranch_scc1 L_slow_loop
    v_mov_b32 v162, v180
    s_nop 1
    v_permlane32_swap_b32 v180, v162
    v_add_f32 v180, v180, v162
    v_mov_b32 v162, v180
    s_nop 1
    v_permlane16_swap_b32 v180, v162
    v_add_f32 v180, v180, v162
    v_rcp_f32 v160, v180
    v_accvgpr_read_b32 v0, a0
    v_accvgpr_read_b32 v1, a1
    v_accvgpr_read_b32 v2, a2
    v_accvgpr_read_b32 v3, a3
    v_mul_f32 v0, v160, v0
    v_mul_f32 v1, v160, v1
    v_mul_f32 v2, v160, v2
    v_mul_f32 v3, v160, v3
    v_cvt_pk_bf16_f32 v0, v0, v1
    v_cvt_pk_bf16_f32 v1, v2, v3
    ds_write_b64 v216, v[0:1] offset:0
    v_accvgpr_read_b32 v4, a4
    v_accvgpr_read_b32 v5, a5
    v_accvgpr_read_b32 v6, a6
    v_accvgpr_read_b32 v7, a7
    v_mul_f32 v4, v160, v4
    v_mul_f32 v5, v160, v5
    v_mul_f32 v6, v160, v6
    v_mul_f32 v7, v160, v7
    v_cvt_pk_bf16_f32 v4, v4, v5
    v_cvt_pk_bf16_f32 v5, v6, v7
    ds_write_b64 v217, v[4:5] offset:0
    v_accvgpr_read_b32 v8, a8
    v_accvgpr_read_b32 v9, a9
    v_accvgpr_read_b32 v10, a10
    v_accvgpr_read_b32 v11, a11
    v_mul_f32 v8, v160, v8
    v_mul_f32 v9, v160, v9
    v_mul_f32 v10, v160, v10
    v_mul_f32 v11, v160, v11
    v_cvt_pk_bf16_f32 v8, v8, v9
    v_cvt_pk_bf16_f32 v9, v10, v11
    ds_write_b64 v222, v[8:9] offset:0
    v_accvgpr_read_b32 v12, a12
    v_accvgpr_read_b32 v13, a13
    v_accvgpr_read_b32 v14, a14
    v_accvgpr_read_b32 v15, a15
    v_mul_f32 v12, v160, v12
    v_mul_f32 v13, v160, v13
    v_mul_f32 v14, v160, v14
    v_mul_f32 v15, v160, v15
    v_cvt_pk_bf16_f32 v12, v12, v13
    v_cvt_pk_bf16_f32 v13, v14, v15
    ds_write_b64 v223, v[12:13] offset:0
    v_accvgpr_read_b32 v16, a16
    v_accvgpr_read_b32 v17, a17
    v_accvgpr_read_b32 v18, a18
    v_accvgpr_read_b32 v19, a19
    v_mul_f32 v16, v160, v16
    v_mul_f32 v17, v160, v17
    v_mul_f32 v18, v160, v18
    v_mul_f32 v19, v160, v19
    v_cvt_pk_bf16_f32 v16, v16, v17
    v_cvt_pk_bf16_f32 v17, v18, v19
    ds_write_b64 v216, v[16:17] offset:32
    v_accvgpr_read_b32 v20, a20
    v_accvgpr_read_b32 v21, a21
    v_accvgpr_read_b32 v22, a22
    v_accvgpr_read_b32 v23, a23
    v_mul_f32 v20, v160, v20
    v_mul_f32 v21, v160, v21
    v_mul_f32 v22, v160, v22
    v_mul_f32 v23, v160, v23
    v_cvt_pk_bf16_f32 v20, v20, v21
    v_cvt_pk_bf16_f32 v21, v22, v23
    ds_write_b64 v217, v[20:21] offset:32
    v_accvgpr_read_b32 v24, a24
    v_accvgpr_read_b32 v25, a25
    v_accvgpr_read_b32 v26, a26
    v_accvgpr_read_b32 v27, a27
    v_mul_f32 v24, v160, v24
    v_mul_f32 v25, v160, v25
    v_mul_f32 v26, v160, v26
    v_mul_f32 v27, v160, v27
    v_cvt_pk_bf16_f32 v24, v24, v25
    v_cvt_pk_bf16_f32 v25, v26, v27
    ds_write_b64 v222, v[24:25] offset:32
    v_accvgpr_read_b32 v28, a28
    v_accvgpr_read_b32 v29, a29
    v_accvgpr_read_b32 v30, a30
    v_accvgpr_read_b32 v31, a31
    v_mul_f32 v28, v160, v28
    v_mul_f32 v29, v160, v29
    v_mul_f32 v30, v160, v30
    v_mul_f32 v31, v160, v31
    v_cvt_pk_bf16_f32 v28, v28, v29
    v_cvt_pk_bf16_f32 v29, v30, v31
    ds_write_b64 v223, v[28:29] offset:32
    ds_read_b128 v[32:35], v236 offset:0
    ds_read_b128 v[36:39], v236 offset:1088
    ds_read_b128 v[40:43], v236 offset:2176
    ds_read_b128 v[44:47], v236 offset:3264
    s_waitcnt lgkmcnt(0)
    buffer_store_dwordx4 v[32:35], v237, s[16:19], s56 offen offset:0 sc1
    v_mfma_f32_16x16x32_bf16 v[228:231], v[224:227], v[32:35], v[228:231]
    buffer_store_dwordx4 v[36:39], v237, s[16:19], s56 offen offset:1024 sc1
    v_mfma_f32_16x16x32_bf16 v[228:231], v[224:227], v[36:39], v[228:231]
    buffer_store_dwordx4 v[40:43], v237, s[16:19], s56 offen offset:2048 sc1
    v_mfma_f32_16x16x32_bf16 v[228:231], v[224:227], v[40:43], v[228:231]
    buffer_store_dwordx4 v[44:47], v237, s[16:19], s56 offen offset:3072 sc1
    v_mfma_f32_16x16x32_bf16 v[228:231], v[224:227], v[44:47], v[228:231]
    s_waitcnt vmcnt(0)
    v_mov_b32 v162, v181
    s_nop 1
    v_permlane32_swap_b32 v181, v162
    v_add_f32 v181, v181, v162
    v_mov_b32 v162, v181
    s_nop 1
    v_permlane16_swap_b32 v181, v162
    v_add_f32 v181, v181, v162
    v_rcp_f32 v160, v181
    v_accvgpr_read_b32 v0, a32
    v_accvgpr_read_b32 v1, a33
    v_accvgpr_read_b32 v2, a34
    v_accvgpr_read_b32 v3, a35
    v_mul_f32 v0, v160, v0
    v_mul_f32 v1, v160, v1
    v_mul_f32 v2, v160, v2
    v_mul_f32 v3, v160, v3
    v_cvt_pk_bf16_f32 v0, v0, v1
    v_cvt_pk_bf16_f32 v1, v2, v3
    ds_write_b64 v216, v[0:1] offset:0
    v_accvgpr_read_b32 v4, a36
    v_accvgpr_read_b32 v5, a37
    v_accvgpr_read_b32 v6, a38
    v_accvgpr_read_b32 v7, a39
    v_mul_f32 v4, v160, v4
    v_mul_f32 v5, v160, v5
    v_mul_f32 v6, v160, v6
    v_mul_f32 v7, v160, v7
    v_cvt_pk_bf16_f32 v4, v4, v5
    v_cvt_pk_bf16_f32 v5, v6, v7
    ds_write_b64 v217, v[4:5] offset:0
    v_accvgpr_read_b32 v8, a40
    v_accvgpr_read_b32 v9, a41
    v_accvgpr_read_b32 v10, a42
    v_accvgpr_read_b32 v11, a43
    v_mul_f32 v8, v160, v8
    v_mul_f32 v9, v160, v9
    v_mul_f32 v10, v160, v10
    v_mul_f32 v11, v160, v11
    v_cvt_pk_bf16_f32 v8, v8, v9
    v_cvt_pk_bf16_f32 v9, v10, v11
    ds_write_b64 v222, v[8:9] offset:0
    v_accvgpr_read_b32 v12, a44
    v_accvgpr_read_b32 v13, a45
    v_accvgpr_read_b32 v14, a46
    v_accvgpr_read_b32 v15, a47
    v_mul_f32 v12, v160, v12
    v_mul_f32 v13, v160, v13
    v_mul_f32 v14, v160, v14
    v_mul_f32 v15, v160, v15
    v_cvt_pk_bf16_f32 v12, v12, v13
    v_cvt_pk_bf16_f32 v13, v14, v15
    ds_write_b64 v223, v[12:13] offset:0
    v_accvgpr_read_b32 v16, a48
    v_accvgpr_read_b32 v17, a49
    v_accvgpr_read_b32 v18, a50
    v_accvgpr_read_b32 v19, a51
    v_mul_f32 v16, v160, v16
    v_mul_f32 v17, v160, v17
    v_mul_f32 v18, v160, v18
    v_mul_f32 v19, v160, v19
    v_cvt_pk_bf16_f32 v16, v16, v17
    v_cvt_pk_bf16_f32 v17, v18, v19
    ds_write_b64 v216, v[16:17] offset:32
    v_accvgpr_read_b32 v20, a52
    v_accvgpr_read_b32 v21, a53
    v_accvgpr_read_b32 v22, a54
    v_accvgpr_read_b32 v23, a55
    v_mul_f32 v20, v160, v20
    v_mul_f32 v21, v160, v21
    v_mul_f32 v22, v160, v22
    v_mul_f32 v23, v160, v23
    v_cvt_pk_bf16_f32 v20, v20, v21
    v_cvt_pk_bf16_f32 v21, v22, v23
    ds_write_b64 v217, v[20:21] offset:32
    v_accvgpr_read_b32 v24, a56
    v_accvgpr_read_b32 v25, a57
    v_accvgpr_read_b32 v26, a58
    v_accvgpr_read_b32 v27, a59
    v_mul_f32 v24, v160, v24
    v_mul_f32 v25, v160, v25
    v_mul_f32 v26, v160, v26
    v_mul_f32 v27, v160, v27
    v_cvt_pk_bf16_f32 v24, v24, v25
    v_cvt_pk_bf16_f32 v25, v26, v27
    ds_write_b64 v222, v[24:25] offset:32
    v_accvgpr_read_b32 v28, a60
    v_accvgpr_read_b32 v29, a61
    v_accvgpr_read_b32 v30, a62
    v_accvgpr_read_b32 v31, a63
    v_mul_f32 v28, v160, v28
    v_mul_f32 v29, v160, v29
    v_mul_f32 v30, v160, v30
    v_mul_f32 v31, v160, v31
    v_cvt_pk_bf16_f32 v28, v28, v29
    v_cvt_pk_bf16_f32 v29, v30, v31
    ds_write_b64 v223, v[28:29] offset:32
    ds_read_b128 v[32:35], v236 offset:0
    ds_read_b128 v[36:39], v236 offset:1088
    ds_read_b128 v[40:43], v236 offset:2176
    ds_read_b128 v[44:47], v236 offset:3264
    s_waitcnt lgkmcnt(0)
    buffer_store_dwordx4 v[32:35], v237, s[16:19], s57 offen offset:0 sc1
    v_mfma_f32_16x16x32_bf16 v[228:231], v[224:227], v[32:35], v[228:231]
    buffer_store_dwordx4 v[36:39], v237, s[16:19], s57 offen offset:1024 sc1
    v_mfma_f32_16x16x32_bf16 v[228:231], v[224:227], v[36:39], v[228:231]
    buffer_store_dwordx4 v[40:43], v237, s[16:19], s57 offen offset:2048 sc1
    v_mfma_f32_16x16x32_bf16 v[228:231], v[224:227], v[40:43], v[228:231]
    buffer_store_dwordx4 v[44:47], v237, s[16:19], s57 offen offset:3072 sc1
    v_mfma_f32_16x16x32_bf16 v[228:231], v[224:227], v[44:47], v[228:231]
    s_waitcnt vmcnt(0)
    v_mov_b32 v162, v182
    s_nop 1
    v_permlane32_swap_b32 v182, v162
    v_add_f32 v182, v182, v162
    v_mov_b32 v162, v182
    s_nop 1
    v_permlane16_swap_b32 v182, v162
    v_add_f32 v182, v182, v162
    v_rcp_f32 v160, v182
    v_accvgpr_read_b32 v0, a64
    v_accvgpr_read_b32 v1, a65
    v_accvgpr_read_b32 v2, a66
    v_accvgpr_read_b32 v3, a67
    v_mul_f32 v0, v160, v0
    v_mul_f32 v1, v160, v1
    v_mul_f32 v2, v160, v2
    v_mul_f32 v3, v160, v3
    v_cvt_pk_bf16_f32 v0, v0, v1
    v_cvt_pk_bf16_f32 v1, v2, v3
    ds_write_b64 v216, v[0:1] offset:0
    v_accvgpr_read_b32 v4, a68
    v_accvgpr_read_b32 v5, a69
    v_accvgpr_read_b32 v6, a70
    v_accvgpr_read_b32 v7, a71
    v_mul_f32 v4, v160, v4
    v_mul_f32 v5, v160, v5
    v_mul_f32 v6, v160, v6
    v_mul_f32 v7, v160, v7
    v_cvt_pk_bf16_f32 v4, v4, v5
    v_cvt_pk_bf16_f32 v5, v6, v7
    ds_write_b64 v217, v[4:5] offset:0
    v_accvgpr_read_b32 v8, a72
    v_accvgpr_read_b32 v9, a73
    v_accvgpr_read_b32 v10, a74
    v_accvgpr_read_b32 v11, a75
    v_mul_f32 v8, v160, v8
    v_mul_f32 v9, v160, v9
    v_mul_f32 v10, v160, v10
    v_mul_f32 v11, v160, v11
    v_cvt_pk_bf16_f32 v8, v8, v9
    v_cvt_pk_bf16_f32 v9, v10, v11
    ds_write_b64 v222, v[8:9] offset:0
    v_accvgpr_read_b32 v12, a76
    v_accvgpr_read_b32 v13, a77
    v_accvgpr_read_b32 v14, a78
    v_accvgpr_read_b32 v15, a79
    v_mul_f32 v12, v160, v12
    v_mul_f32 v13, v160, v13
    v_mul_f32 v14, v160, v14
    v_mul_f32 v15, v160, v15
    v_cvt_pk_bf16_f32 v12, v12, v13
    v_cvt_pk_bf16_f32 v13, v14, v15
    ds_write_b64 v223, v[12:13] offset:0
    v_accvgpr_read_b32 v16, a80
    v_accvgpr_read_b32 v17, a81
    v_accvgpr_read_b32 v18, a82
    v_accvgpr_read_b32 v19, a83
    v_mul_f32 v16, v160, v16
    v_mul_f32 v17, v160, v17
    v_mul_f32 v18, v160, v18
    v_mul_f32 v19, v160, v19
    v_cvt_pk_bf16_f32 v16, v16, v17
    v_cvt_pk_bf16_f32 v17, v18, v19
    ds_write_b64 v216, v[16:17] offset:32
    v_accvgpr_read_b32 v20, a84
    v_accvgpr_read_b32 v21, a85
    v_accvgpr_read_b32 v22, a86
    v_accvgpr_read_b32 v23, a87
    v_mul_f32 v20, v160, v20
    v_mul_f32 v21, v160, v21
    v_mul_f32 v22, v160, v22
    v_mul_f32 v23, v160, v23
    v_cvt_pk_bf16_f32 v20, v20, v21
    v_cvt_pk_bf16_f32 v21, v22, v23
    ds_write_b64 v217, v[20:21] offset:32
    v_accvgpr_read_b32 v24, a88
    v_accvgpr_read_b32 v25, a89
    v_accvgpr_read_b32 v26, a90
    v_accvgpr_read_b32 v27, a91
    v_mul_f32 v24, v160, v24
    v_mul_f32 v25, v160, v25
    v_mul_f32 v26, v160, v26
    v_mul_f32 v27, v160, v27
    v_cvt_pk_bf16_f32 v24, v24, v25
    v_cvt_pk_bf16_f32 v25, v26, v27
    ds_write_b64 v222, v[24:25] offset:32
    v_accvgpr_read_b32 v28, a92
    v_accvgpr_read_b32 v29, a93
    v_accvgpr_read_b32 v30, a94
    v_accvgpr_read_b32 v31, a95
    v_mul_f32 v28, v160, v28
    v_mul_f32 v29, v160, v29
    v_mul_f32 v30, v160, v30
    v_mul_f32 v31, v160, v31
    v_cvt_pk_bf16_f32 v28, v28, v29
    v_cvt_pk_bf16_f32 v29, v30, v31
    ds_write_b64 v223, v[28:29] offset:32
    ds_read_b128 v[32:35], v236 offset:0
    ds_read_b128 v[36:39], v236 offset:1088
    ds_read_b128 v[40:43], v236 offset:2176
    ds_read_b128 v[44:47], v236 offset:3264
    s_waitcnt lgkmcnt(0)
    buffer_store_dwordx4 v[32:35], v237, s[16:19], s58 offen offset:0 sc1
    v_mfma_f32_16x16x32_bf16 v[228:231], v[224:227], v[32:35], v[228:231]
    buffer_store_dwordx4 v[36:39], v237, s[16:19], s58 offen offset:1024 sc1
    v_mfma_f32_16x16x32_bf16 v[228:231], v[224:227], v[36:39], v[228:231]
    buffer_store_dwordx4 v[40:43], v237, s[16:19], s58 offen offset:2048 sc1
    v_mfma_f32_16x16x32_bf16 v[228:231], v[224:227], v[40:43], v[228:231]
    buffer_store_dwordx4 v[44:47], v237, s[16:19], s58 offen offset:3072 sc1
    v_mfma_f32_16x16x32_bf16 v[228:231], v[224:227], v[44:47], v[228:231]
    s_waitcnt vmcnt(0)
    v_mov_b32 v162, v183
    s_nop 1
    v_permlane32_swap_b32 v183, v162
    v_add_f32 v183, v183, v162
    v_mov_b32 v162, v183
    s_nop 1
    v_permlane16_swap_b32 v183, v162
    v_add_f32 v183, v183, v162
    v_rcp_f32 v160, v183
    v_accvgpr_read_b32 v0, a96
    v_accvgpr_read_b32 v1, a97
    v_accvgpr_read_b32 v2, a98
    v_accvgpr_read_b32 v3, a99
    v_mul_f32 v0, v160, v0
    v_mul_f32 v1, v160, v1
    v_mul_f32 v2, v160, v2
    v_mul_f32 v3, v160, v3
    v_cvt_pk_bf16_f32 v0, v0, v1
    v_cvt_pk_bf16_f32 v1, v2, v3
    ds_write_b64 v216, v[0:1] offset:0
    v_accvgpr_read_b32 v4, a100
    v_accvgpr_read_b32 v5, a101
    v_accvgpr_read_b32 v6, a102
    v_accvgpr_read_b32 v7, a103
    v_mul_f32 v4, v160, v4
    v_mul_f32 v5, v160, v5
    v_mul_f32 v6, v160, v6
    v_mul_f32 v7, v160, v7
    v_cvt_pk_bf16_f32 v4, v4, v5
    v_cvt_pk_bf16_f32 v5, v6, v7
    ds_write_b64 v217, v[4:5] offset:0
    v_accvgpr_read_b32 v8, a104
    v_accvgpr_read_b32 v9, a105
    v_accvgpr_read_b32 v10, a106
    v_accvgpr_read_b32 v11, a107
    v_mul_f32 v8, v160, v8
    v_mul_f32 v9, v160, v9
    v_mul_f32 v10, v160, v10
    v_mul_f32 v11, v160, v11
    v_cvt_pk_bf16_f32 v8, v8, v9
    v_cvt_pk_bf16_f32 v9, v10, v11
    ds_write_b64 v222, v[8:9] offset:0
    v_accvgpr_read_b32 v12, a108
    v_accvgpr_read_b32 v13, a109
    v_accvgpr_read_b32 v14, a110
    v_accvgpr_read_b32 v15, a111
    v_mul_f32 v12, v160, v12
    v_mul_f32 v13, v160, v13
    v_mul_f32 v14, v160, v14
    v_mul_f32 v15, v160, v15
    v_cvt_pk_bf16_f32 v12, v12, v13
    v_cvt_pk_bf16_f32 v13, v14, v15
    ds_write_b64 v223, v[12:13] offset:0
    v_accvgpr_read_b32 v16, a112
    v_accvgpr_read_b32 v17, a113
    v_accvgpr_read_b32 v18, a114
    v_accvgpr_read_b32 v19, a115
    v_mul_f32 v16, v160, v16
    v_mul_f32 v17, v160, v17
    v_mul_f32 v18, v160, v18
    v_mul_f32 v19, v160, v19
    v_cvt_pk_bf16_f32 v16, v16, v17
    v_cvt_pk_bf16_f32 v17, v18, v19
    ds_write_b64 v216, v[16:17] offset:32
    v_accvgpr_read_b32 v20, a116
    v_accvgpr_read_b32 v21, a117
    v_accvgpr_read_b32 v22, a118
    v_accvgpr_read_b32 v23, a119
    v_mul_f32 v20, v160, v20
    v_mul_f32 v21, v160, v21
    v_mul_f32 v22, v160, v22
    v_mul_f32 v23, v160, v23
    v_cvt_pk_bf16_f32 v20, v20, v21
    v_cvt_pk_bf16_f32 v21, v22, v23
    ds_write_b64 v217, v[20:21] offset:32
    v_accvgpr_read_b32 v24, a120
    v_accvgpr_read_b32 v25, a121
    v_accvgpr_read_b32 v26, a122
    v_accvgpr_read_b32 v27, a123
    v_mul_f32 v24, v160, v24
    v_mul_f32 v25, v160, v25
    v_mul_f32 v26, v160, v26
    v_mul_f32 v27, v160, v27
    v_cvt_pk_bf16_f32 v24, v24, v25
    v_cvt_pk_bf16_f32 v25, v26, v27
    ds_write_b64 v222, v[24:25] offset:32
    v_accvgpr_read_b32 v28, a124
    v_accvgpr_read_b32 v29, a125
    v_accvgpr_read_b32 v30, a126
    v_accvgpr_read_b32 v31, a127
    v_mul_f32 v28, v160, v28
    v_mul_f32 v29, v160, v29
    v_mul_f32 v30, v160, v30
    v_mul_f32 v31, v160, v31
    v_cvt_pk_bf16_f32 v28, v28, v29
    v_cvt_pk_bf16_f32 v29, v30, v31
    ds_write_b64 v223, v[28:29] offset:32
    ds_read_b128 v[32:35], v236 offset:0
    ds_read_b128 v[36:39], v236 offset:1088
    ds_read_b128 v[40:43], v236 offset:2176
    ds_read_b128 v[44:47], v236 offset:3264
    s_waitcnt lgkmcnt(0)
    buffer_store_dwordx4 v[32:35], v237, s[16:19], s59 offen offset:0 sc1
    v_mfma_f32_16x16x32_bf16 v[228:231], v[224:227], v[32:35], v[228:231]
    buffer_store_dwordx4 v[36:39], v237, s[16:19], s59 offen offset:1024 sc1
    v_mfma_f32_16x16x32_bf16 v[228:231], v[224:227], v[36:39], v[228:231]
    buffer_store_dwordx4 v[40:43], v237, s[16:19], s59 offen offset:2048 sc1
    v_mfma_f32_16x16x32_bf16 v[228:231], v[224:227], v[40:43], v[228:231]
    buffer_store_dwordx4 v[44:47], v237, s[16:19], s59 offen offset:3072 sc1
    v_mfma_f32_16x16x32_bf16 v[228:231], v[224:227], v[44:47], v[228:231]
    s_waitcnt vmcnt(0)
    v_mov_b32 v162, v184
    s_nop 1
    v_permlane32_swap_b32 v184, v162
    v_add_f32 v184, v184, v162
    v_mov_b32 v162, v184
    s_nop 1
    v_permlane16_swap_b32 v184, v162
    v_add_f32 v184, v184, v162
    v_rcp_f32 v160, v184
    v_accvgpr_read_b32 v0, a128
    v_accvgpr_read_b32 v1, a129
    v_accvgpr_read_b32 v2, a130
    v_accvgpr_read_b32 v3, a131
    v_mul_f32 v0, v160, v0
    v_mul_f32 v1, v160, v1
    v_mul_f32 v2, v160, v2
    v_mul_f32 v3, v160, v3
    v_cvt_pk_bf16_f32 v0, v0, v1
    v_cvt_pk_bf16_f32 v1, v2, v3
    ds_write_b64 v216, v[0:1] offset:0
    v_accvgpr_read_b32 v4, a132
    v_accvgpr_read_b32 v5, a133
    v_accvgpr_read_b32 v6, a134
    v_accvgpr_read_b32 v7, a135
    v_mul_f32 v4, v160, v4
    v_mul_f32 v5, v160, v5
    v_mul_f32 v6, v160, v6
    v_mul_f32 v7, v160, v7
    v_cvt_pk_bf16_f32 v4, v4, v5
    v_cvt_pk_bf16_f32 v5, v6, v7
    ds_write_b64 v217, v[4:5] offset:0
    v_accvgpr_read_b32 v8, a136
    v_accvgpr_read_b32 v9, a137
    v_accvgpr_read_b32 v10, a138
    v_accvgpr_read_b32 v11, a139
    v_mul_f32 v8, v160, v8
    v_mul_f32 v9, v160, v9
    v_mul_f32 v10, v160, v10
    v_mul_f32 v11, v160, v11
    v_cvt_pk_bf16_f32 v8, v8, v9
    v_cvt_pk_bf16_f32 v9, v10, v11
    ds_write_b64 v222, v[8:9] offset:0
    v_accvgpr_read_b32 v12, a140
    v_accvgpr_read_b32 v13, a141
    v_accvgpr_read_b32 v14, a142
    v_accvgpr_read_b32 v15, a143
    v_mul_f32 v12, v160, v12
    v_mul_f32 v13, v160, v13
    v_mul_f32 v14, v160, v14
    v_mul_f32 v15, v160, v15
    v_cvt_pk_bf16_f32 v12, v12, v13
    v_cvt_pk_bf16_f32 v13, v14, v15
    ds_write_b64 v223, v[12:13] offset:0
    v_accvgpr_read_b32 v16, a144
    v_accvgpr_read_b32 v17, a145
    v_accvgpr_read_b32 v18, a146
    v_accvgpr_read_b32 v19, a147
    v_mul_f32 v16, v160, v16
    v_mul_f32 v17, v160, v17
    v_mul_f32 v18, v160, v18
    v_mul_f32 v19, v160, v19
    v_cvt_pk_bf16_f32 v16, v16, v17
    v_cvt_pk_bf16_f32 v17, v18, v19
    ds_write_b64 v216, v[16:17] offset:32
    v_accvgpr_read_b32 v20, a148
    v_accvgpr_read_b32 v21, a149
    v_accvgpr_read_b32 v22, a150
    v_accvgpr_read_b32 v23, a151
    v_mul_f32 v20, v160, v20
    v_mul_f32 v21, v160, v21
    v_mul_f32 v22, v160, v22
    v_mul_f32 v23, v160, v23
    v_cvt_pk_bf16_f32 v20, v20, v21
    v_cvt_pk_bf16_f32 v21, v22, v23
    ds_write_b64 v217, v[20:21] offset:32
    v_accvgpr_read_b32 v24, a152
    v_accvgpr_read_b32 v25, a153
    v_accvgpr_read_b32 v26, a154
    v_accvgpr_read_b32 v27, a155
    v_mul_f32 v24, v160, v24
    v_mul_f32 v25, v160, v25
    v_mul_f32 v26, v160, v26
    v_mul_f32 v27, v160, v27
    v_cvt_pk_bf16_f32 v24, v24, v25
    v_cvt_pk_bf16_f32 v25, v26, v27
    ds_write_b64 v222, v[24:25] offset:32
    v_accvgpr_read_b32 v28, a156
    v_accvgpr_read_b32 v29, a157
    v_accvgpr_read_b32 v30, a158
    v_accvgpr_read_b32 v31, a159
    v_mul_f32 v28, v160, v28
    v_mul_f32 v29, v160, v29
    v_mul_f32 v30, v160, v30
    v_mul_f32 v31, v160, v31
    v_cvt_pk_bf16_f32 v28, v28, v29
    v_cvt_pk_bf16_f32 v29, v30, v31
    ds_write_b64 v223, v[28:29] offset:32
    ds_read_b128 v[32:35], v236 offset:0
    ds_read_b128 v[36:39], v236 offset:1088
    ds_read_b128 v[40:43], v236 offset:2176
    ds_read_b128 v[44:47], v236 offset:3264
    s_waitcnt lgkmcnt(0)
    buffer_store_dwordx4 v[32:35], v237, s[16:19], s60 offen offset:0 sc1
    v_mfma_f32_16x16x32_bf16 v[228:231], v[224:227], v[32:35], v[228:231]
    buffer_store_dwordx4 v[36:39], v237, s[16:19], s60 offen offset:1024 sc1
    v_mfma_f32_16x16x32_bf16 v[228:231], v[224:227], v[36:39], v[228:231]
    buffer_store_dwordx4 v[40:43], v237, s[16:19], s60 offen offset:2048 sc1
    v_mfma_f32_16x16x32_bf16 v[228:231], v[224:227], v[40:43], v[228:231]
    buffer_store_dwordx4 v[44:47], v237, s[16:19], s60 offen offset:3072 sc1
    v_mfma_f32_16x16x32_bf16 v[228:231], v[224:227], v[44:47], v[228:231]
    s_waitcnt vmcnt(0)
    v_mov_b32 v162, v185
    s_nop 1
    v_permlane32_swap_b32 v185, v162
    v_add_f32 v185, v185, v162
    v_mov_b32 v162, v185
    s_nop 1
    v_permlane16_swap_b32 v185, v162
    v_add_f32 v185, v185, v162
    v_rcp_f32 v160, v185
    v_accvgpr_read_b32 v0, a160
    v_accvgpr_read_b32 v1, a161
    v_accvgpr_read_b32 v2, a162
    v_accvgpr_read_b32 v3, a163
    v_mul_f32 v0, v160, v0
    v_mul_f32 v1, v160, v1
    v_mul_f32 v2, v160, v2
    v_mul_f32 v3, v160, v3
    v_cvt_pk_bf16_f32 v0, v0, v1
    v_cvt_pk_bf16_f32 v1, v2, v3
    v_accvgpr_read_b32 v4, a176
    v_accvgpr_read_b32 v5, a177
    v_accvgpr_read_b32 v6, a178
    v_accvgpr_read_b32 v7, a179
    v_mul_f32 v4, v160, v4
    v_mul_f32 v5, v160, v5
    v_mul_f32 v6, v160, v6
    v_mul_f32 v7, v160, v7
    v_cvt_pk_bf16_f32 v2, v4, v5
    v_cvt_pk_bf16_f32 v3, v6, v7
    s_nop 0
    v_permlane16_swap_b32 v0, v2
    v_permlane16_swap_b32 v1, v3
    buffer_store_dwordx4 v[0:3], v238, s[16:19], s61 offen sc1
    s_nop 0
    v_mfma_f32_16x16x32_bf16 v[228:231], v[224:227], v[0:3], v[228:231]
    s_waitcnt vmcnt(0)
    s_waitcnt vmcnt(0)
    s_endpgm
.section .rodata,"a"
.p2align 6
.amdhsa_kernel standalone__gqa_softmax__near_ridge_kernel
  .amdhsa_next_free_vgpr 512
  .amdhsa_next_free_sgpr 64
  .amdhsa_accum_offset 256
  .amdhsa_group_segment_fixed_size 0
  .amdhsa_kernarg_size 48
  .amdhsa_user_sgpr_count 2
  .amdhsa_user_sgpr_kernarg_segment_ptr 1
  .amdhsa_system_sgpr_workgroup_id_x 1
.end_amdhsa_kernel
```
